```python
import torch

def _softmax(x, axis=-1):
    return torch.softmax(x, dim=axis)
def _gelu(x):
    return torch.nn.functional.gelu(x, approximate="tanh")
def _silu(x):
    return torch.nn.functional.silu(x)
def _sigmoid(x):
    return torch.sigmoid(x)
def _layernorm(x, axis=-1, eps=1e-5):
    m = x.mean(dim=axis, keepdim=True)
    v = x.var(dim=axis, keepdim=True, unbiased=False)
    return (x - m) / torch.sqrt(v + eps)
def _scatter_add(tgt, idx, src, axis=0):
    return tgt.clone().index_add_(axis, idx, src)
def _segment_sum(src, seg, n):
    out = torch.zeros((n,) + src.shape[1:], dtype=src.dtype)
    return out.index_add_(0, seg, src)
def _pad(x, pw):
    flat = tuple(v for pair in reversed(pw) for v in pair)
    return torch.nn.functional.pad(x, flat)

kernel_name = 'sequential_preLN__linear_kernel_hedgehog__mixer_channel_mlp__prompt'

def setup_inputs():

    _w = (lambda a: (lambda t: t.to(torch.bfloat16) if t.is_floating_point() else t)(torch.as_tensor(a)))
    def _A_setup():
        B, S, D, H = 1, 2048, 640, 32
        Dh = D // H
        return {
            "x": _w((lambda *s: torch.randn(*s, dtype=torch.bfloat16) * 0.05)(B, S, D)),
            "wqkv": _w((lambda *s: torch.randn(*s, dtype=torch.bfloat16) * 0.2)(D, 3 * D)),
            "w_phi": _w((lambda *s: torch.randn(*s, dtype=torch.bfloat16) * 0.2)(H, Dh, Dh) * (Dh ** -0.5)),
            "wo": _w((lambda *s: torch.randn(*s, dtype=torch.bfloat16) * 0.05)(D, D)),
        }
    _A_in = _A_setup()

    def _B_setup():
        B, S, D, F = 1, 2048, 640, 1536
        return {
            "x": _w((lambda *s: torch.randn(*s, dtype=torch.bfloat16) * 0.05)(B, S, D)),
            "w1": _w((lambda *s: torch.randn(*s, dtype=torch.bfloat16) * 3.2)(D, F) * (D ** -0.5)),
            "b1": _w((lambda *s: torch.randn(*s, dtype=torch.bfloat16) * 0.8)(F)),
            "w2": _w((lambda *s: torch.randn(*s, dtype=torch.bfloat16) * 0.1)(F, D) * (F ** -0.5)),
            "b2": _w((lambda *s: torch.randn(*s, dtype=torch.bfloat16) * 0.1)(D)),
        }
    _B_in = _B_setup()

    return {
        "A_x": _A_in["x"],
        "A_wqkv": _A_in["wqkv"],
        "A_w_phi": _A_in["w_phi"],
        "A_wo": _A_in["wo"],
        "B_x": _B_in["x"],
        "B_w1": _B_in["w1"],
        "B_b1": _B_in["b1"],
        "B_w2": _B_in["w2"],
        "B_b2": _B_in["b2"],
    }

def reference(A_x, A_wqkv, A_w_phi, A_wo, B_x, B_w1, B_b1, B_w2, B_b2):
    def _A_ref(x, wqkv, w_phi, wo):
        B, S, D = x.shape
        H = 32; Dh = D // H
        qkv = (lambda x, *d: x.permute(*d))((x @ wqkv).reshape(B, S, 3, H, Dh), 2, 0, 3, 1, 4)
        q, k, v = qkv[0], qkv[1], qkv[2]
        pq = torch.einsum("bhsd,hdf->bhsf", q, w_phi)
        pk = torch.einsum("bhsd,hdf->bhsf", k, w_phi)
        phi_q = torch.concatenate([_softmax(pq, axis=-1), _softmax(-pq, axis=-1)], axis=-1)
        phi_k = torch.concatenate([_softmax(pk, axis=-1), _softmax(-pk, axis=-1)], axis=-1)
        kv = torch.einsum("bhsf,bhsd->bhfd", phi_k, v)
        z  = torch.einsum("bhsf->bhf", phi_k)
        num = torch.einsum("bhqf,bhfd->bhqd", phi_q, kv)
        den = torch.einsum("bhqf,bhf->bhq", phi_q, z)[..., None] + 1e-6
        o = num / den
        return (lambda x, *d: x.permute(*d))(o, 0, 2, 1, 3).reshape(B, S, D) @ wo

    def _B_ref(x, w1, b1, w2, b2):
        y = _layernorm(x, axis=-1)
        h = _gelu(torch.einsum("bsd,df->bsf", y, w1) + b1)
        return torch.einsum("bsf,fd->bsd", h, w2) + b2

    x = A_x
    h = x + _A_ref(_layernorm(x, axis=-1), A_wqkv, A_w_phi, A_wo)
    h2 = h + _B_ref(_layernorm(h, axis=-1), B_w1, B_b1, B_w2, B_b2)
    return h2
```

```asm
; @launch grid=(256,1,1) block=(512,1,1) lds=163840
.amdgcn_target "amdgcn-amd-amdhsa--gfx950"
.text
.globl sequential_preLN__linear_kernel_hedgehog__mixer_channel_mlp__prompt_kernel
.p2align 8
.type sequential_preLN__linear_kernel_hedgehog__mixer_channel_mlp__prompt_kernel,@function
sequential_preLN__linear_kernel_hedgehog__mixer_channel_mlp__prompt_kernel:
    s_load_dwordx16 s[64:79], s[0:1], 0
    s_load_dwordx8 s[80:87], s[0:1], 64
    s_cmp_ge_u32 s2, 256
    s_cbranch_scc1 L_done
    v_lshrrev_b32 v7, 6, v0
    v_and_b32 v1, 63, v0
    v_readfirstlane_b32 s3, v7
s_nop 0
    s_cmp_lt_u32 s3, 4
    s_cbranch_scc1 L_roleA
    s_and_b32 s3, s3, 3
    s_setprio 3
    s_getpc_b64 s[24:25]
L_pc_5001:
    s_mov_b32 s26, L_end-L_pc_5001
    s_mov_b32 s27, 0x20000
    s_lshr_b32 s49, s2, 3
    s_lshl2_add_u32 s49, s49, s3
    s_lshl_b32 s49, s49, 7
    v_lshlrev_b32 v8, 14, v1
    buffer_load_dword v9, v8, s[24:27], s49 offen
    v_and_b32 v3, 15, v1
    v_lshrrev_b32 v4, 4, v1
    s_lshr_b32 s6, s2, 6
    s_bfe_u32 s4, s2, 0x30003
    s_and_b32 s7, s2, 7
    s_lshl2_add_u32 s5, s7, s6
    s_add_u32 s49, s6, s4
    s_add_u32 s7, s7, s49
    s_mul_i32 s50, s7, 52
    s_lshr_b32 s50, s50, 8
    s_mul_i32 s50, s50, 5
    s_sub_u32 s44, s7, s50
    v_xor_b32 v8, v3, v4
    v_mul_u32_u24 v7, 80, v4
    v_add_lshl_u32 v13, v7, v8, 4
    s_lshl2_add_u32 s62, s5, s3
    s_mul_i32 s62, s62, 20480
    s_mul_i32 s63, s3, 20480
    v_xor_b32 v14, 4160, v13
    v_xor_b32 v15, 8320, v13
    v_xor_b32 v16, 12480, v13
    s_mov_b32 s10, 2621440
    s_mov_b32 s11, 0x20000
    s_waitcnt lgkmcnt(0)
    s_mov_b64 s[8:9], s[64:65]
    s_lshl_b32 s52, s44, 8
    s_add_u32 m0, s63, 0
    s_add_u32 s52, s52, s62
    buffer_load_dwordx4 v13, s[8:11], s52 offen offset:0 lds
    buffer_load_dwordx4 v14, s[8:11], s52 offen offset:1024 lds
    buffer_load_dwordx4 v15, s[8:11], s52 offen offset:2048 lds
    buffer_load_dwordx4 v16, s[8:11], s52 offen offset:3072 lds
    s_mov_b32 s27, 0x20000
    s_cmp_ge_u32 s2, 176
    s_cbranch_scc1 L_rp_5004
    s_cmp_ge_u32 s2, 80
    s_cbranch_scc1 L_rp_5003
    s_cmp_ge_u32 s2, 40
    s_cbranch_scc1 L_rp_5002
    s_mov_b32 s52, s2
    s_lshr_b32 s101, s52, 1
    s_and_b32 s49, s52, 1
    s_lshl2_add_u32 s52, s49, s3
    s_mul_i32 s99, s52, 160
    s_mul_i32 s100, s52, 102400
    s_add_u32 s100, s100, 1048576
    s_mul_i32 s50, s101, 5120
    s_add_u32 s100, s100, s50
    s_lshl_b32 s94, s101, 5
    s_mov_b32 s95, 8
    s_mov_b32 s96, 16
    s_mov_b32 s97, 4
    s_mov_b32 s98, 3840
    s_mov_b32 s24, s66
    s_mov_b32 s25, s67
    s_mov_b32 s26, 2457600
    s_branch L_rp_5005
L_rp_5002:
    s_sub_u32 s52, s2, 40
    s_lshr_b32 s101, s52, 1
    s_and_b32 s49, s52, 1
    s_lshl2_add_u32 s52, s49, s3
    s_mul_i32 s99, s52, 160
    s_mul_i32 s100, s52, 102400
    s_add_u32 s100, s100, 2097152
    s_mul_i32 s49, s101, 52
    s_lshr_b32 s49, s49, 8
    s_mul_i32 s50, s49, 5
    s_sub_u32 s50, s101, s50
    s_mul_i32 s94, s49, 160
    s_mov_b32 s95, 20
    s_lshr_b32 s51, s52, 1
    s_sub_u32 s49, s49, s51
    s_and_b32 s49, s49, 3
    s_mul_i32 s101, s49, 5
    s_and_b32 s52, s52, 1
    s_lshl_b32 s52, s52, 1
    s_xor_b32 s52, s52, s50
    s_lshr_b32 s49, s50, 1
    s_mul_i32 s49, s49, 80
    s_and_b32 s51, s50, 1
    s_lshl_b32 s51, s51, 3
    s_add_u32 s49, s49, s51
    s_cmp_eq_u32 s50, 4
    s_cselect_b32 s49, 16, s49
    s_cselect_b32 s96, 80, 40
    s_cselect_b32 s97, 40, 4
    s_cselect_b32 s52, 4, s52
    s_add_u32 s94, s94, s49
    s_add_u32 s101, s101, s52
    s_mul_i32 s101, s101, 5120
    s_add_u32 s100, s100, s101
    s_mov_b32 s98, 1280
    s_mov_b32 s24, s70
    s_mov_b32 s25, s71
    s_mov_b32 s26, 819200
    s_branch L_rp_5005
L_rp_5003:
    s_sub_u32 s52, s2, 80
    s_lshr_b32 s101, s52, 1
    s_and_b32 s49, s52, 1
    s_lshl2_add_u32 s52, s49, s3
    s_mul_i32 s99, s52, 160
    s_mul_i32 s100, s52, 245760
    s_add_u32 s100, s100, 5242880
    s_mul_i32 s50, s101, 5120
    s_add_u32 s100, s100, s50
    s_mul_i32 s49, s101, 86
    s_lshr_b32 s49, s49, 8
    s_mul_i32 s50, s49, 3
    s_sub_u32 s50, s101, s50
    s_mul_i32 s94, s49, 96
    s_mul_i32 s49, s50, 48
    s_mov_b32 s95, 12
    s_cmp_eq_u32 s50, 2
    s_cselect_b32 s49, 8, s49
    s_cselect_b32 s96, 48, 24
    s_cselect_b32 s97, 24, 4
    s_add_u32 s94, s94, s49
    s_mov_b32 s98, 1280
    s_mov_b32 s24, s78
    s_mov_b32 s25, s79
    s_mov_b32 s26, 1966080
    s_branch L_rp_5005
L_rp_5004:
    s_sub_u32 s52, s2, 176
    s_lshr_b32 s101, s52, 2
    s_and_b32 s49, s52, 3
    s_lshl_b32 s49, s49, 2
    s_add_u32 s49, s49, s3
    s_mul_i32 s99, s49, 192
    s_mul_i32 s100, s49, 122880
    s_add_u32 s100, s100, 3145728
    s_lshr_b32 s52, s49, 1
    s_mul_i32 s49, s101, 52
    s_lshr_b32 s49, s49, 8
    s_mul_i32 s50, s49, 5
    s_sub_u32 s50, s101, s50
    s_mul_i32 s94, s49, 160
    s_mov_b32 s95, 20
    s_lshr_b32 s51, s52, 1
    s_sub_u32 s49, s49, s51
    s_and_b32 s49, s49, 3
    s_mul_i32 s101, s49, 5
    s_and_b32 s52, s52, 1
    s_lshl_b32 s52, s52, 1
    s_xor_b32 s52, s52, s50
    s_lshr_b32 s49, s50, 1
    s_mul_i32 s49, s49, 80
    s_and_b32 s51, s50, 1
    s_lshl_b32 s51, s51, 3
    s_add_u32 s49, s49, s51
    s_cmp_eq_u32 s50, 4
    s_cselect_b32 s49, 16, s49
    s_cselect_b32 s96, 80, 40
    s_cselect_b32 s97, 40, 4
    s_cselect_b32 s52, 4, s52
    s_add_u32 s94, s94, s49
    s_add_u32 s101, s101, s52
    s_mul_i32 s101, s101, 3072
    s_add_u32 s100, s100, s101
    s_mov_b32 s98, 3072
    s_mov_b32 s24, s74
    s_mov_b32 s25, s75
    s_mov_b32 s26, 1966080
L_rp_5005:
    s_mov_b32 s49, 6554
    s_movk_i32 s50, 0xff
    s_cmp_ge_u32 s2, 176
    s_cselect_b32 s60, 12, 10
    s_cselect_b32 s49, 5462, s49
    s_cselect_b32 s50, 0xffff, s50
    v_mul_u32_u24 v7, s49, v1
    s_lshl_b32 s61, s60, 4
    v_lshrrev_b32 v7, 16, v7
    s_sub_u32 s49, s98, s61
    v_mul_u32_u24 v7, s49, v7
    v_lshl_add_u32 v17, v1, 4, v7
    s_mul_i32 s94, s94, s98
    s_add_u32 s94, s94, s99
    s_mul_i32 s95, s95, s98
    s_mul_i32 s96, s96, s98
    s_mul_i32 s97, s97, s98
    s_lshl_b32 s51, s61, 2
    s_mov_b32 s58, s50
    s_mov_b32 s59, s51
    s_add_u32 m0, s63, 92160
    s_mov_b32 exec_hi, s58
    buffer_load_dwordx4 v17, s[24:27], s94 offen lds
    s_add_u32 m0, m0, s59
    s_add_u32 s101, s94, s95
    buffer_load_dwordx4 v17, s[24:27], s101 offen lds
    s_add_u32 m0, m0, s59
    s_add_u32 s99, s94, s96
    buffer_load_dwordx4 v17, s[24:27], s99 offen lds
    s_add_u32 m0, m0, s59
    s_add_u32 s101, s101, s96
    buffer_load_dwordx4 v17, s[24:27], s101 offen lds
    s_add_u32 m0, m0, s59
    s_add_u32 s94, s94, s97
    buffer_load_dwordx4 v17, s[24:27], s94 offen lds
    s_add_u32 m0, m0, s59
    s_add_u32 s101, s94, s95
    buffer_load_dwordx4 v17, s[24:27], s101 offen lds
    s_add_u32 m0, m0, s59
    s_add_u32 s99, s94, s96
    buffer_load_dwordx4 v17, s[24:27], s99 offen lds
    s_add_u32 m0, m0, s59
    s_add_u32 s101, s101, s96
    buffer_load_dwordx4 v17, s[24:27], s101 offen lds
    s_mov_b32 exec_hi, -1
    s_add_u32 s45, s44, 1
    s_cmp_eq_u32 s45, 5
    s_cselect_b32 s45, 0, s45
    s_add_u32 s46, s45, 1
    s_cmp_eq_u32 s46, 5
    s_cselect_b32 s46, 0, s46
    s_add_u32 s47, s46, 1
    s_cmp_eq_u32 s47, 5
    s_cselect_b32 s47, 0, s47
    s_add_u32 s48, s47, 1
    s_cmp_eq_u32 s48, 5
    s_cselect_b32 s48, 0, s48
    s_mov_b32 s16, s86
    s_mov_b32 s17, s87
    s_mov_b32 s18, 33554432
    s_mov_b32 s19, 0x20000
    s_lshl2_add_u32 s54, s2, s3
    s_cmp_eq_u32 s54, 1
    s_cbranch_scc1 L_z_5006
L_z_5007:
    s_mov_b32 s12, s66
    s_mov_b32 s13, s67
    s_mov_b32 s14, 2457600
    s_mov_b32 s15, 0x20000
    s_mov_b32 s20, s82
    s_mov_b32 s21, s83
    s_mov_b32 s22, 2621440
    s_mov_b32 s23, 0x20000
    s_mov_b32 s28, s68
    s_mov_b32 s29, s69
    s_mov_b32 s30, 25600
    s_mov_b32 s31, 0x20000
    s_mov_b32 s32, s76
    s_mov_b32 s33, s77
    s_mov_b32 s34, 3072
    s_mov_b32 s35, 0x20000
    s_mov_b32 s40, s84
    s_mov_b32 s41, s85
    s_mov_b32 s42, 256
    s_mov_b32 s43, 0x20000
    s_mov_b32 s65, 3072
    s_cmp_ge_u32 s2, 176
    s_cselect_b32 s51, 24, 40
    s_cselect_b32 s65, 61440, s65
    s_cselect_b32 s66, 0, 0x7ff00000
    s_cselect_b32 s50, 96, 24
    s_add_u32 s65, s65, s100
    s_add_u32 s66, s66, s65
    s_add_u32 s64, s63, 81920
    s_add_u32 s49, s64, 10240
    s_mul_i32 s67, s3, 5120
    v_lshrrev_b32 v8, 2, v1
    v_mul_u32_u24 v8, s61, v8
    v_and_b32 v7, 3, v1
    v_mul_u32_u24 v7, s51, v7
    v_add3_u32 v18, v8, v7, s49
    s_lshl_b32 s49, s61, 4
    v_add_u32 v19, s49, v18
    v_add_u32 v20, s50, v18
    v_add_u32 v21, s50, v19
    v_lshlrev_b32 v5, 4, v1
    v_mov_b32 v6, 0
    s_mov_b32 s55, 0xffff0000
    v_add_u32 v7, 0, v1
    v_mul_u32_u24 v8, 6554, v7
    v_lshrrev_b32 v8, 16, v8
    v_mul_u32_u24 v10, 10, v8
    v_sub_u32 v7, v7, v10
    v_bfe_u32 v26, v8, 2, 2
    v_lshrrev_b32 v10, 4, v8
    v_and_b32 v8, 3, v8
    v_lshl_add_u32 v8, v10, 2, v8
    v_lshl_add_u32 v8, v26, 3, v8
    v_mul_u32_u24 v8, 3840, v8
    v_lshl_add_u32 v26, v7, 4, v8
    v_add_u32 v7, 64, v1
    v_mul_u32_u24 v8, 6554, v7
    v_lshrrev_b32 v8, 16, v8
    v_mul_u32_u24 v10, 10, v8
    v_sub_u32 v7, v7, v10
    v_bfe_u32 v27, v8, 2, 2
    v_lshrrev_b32 v10, 4, v8
    v_and_b32 v8, 3, v8
    v_lshl_add_u32 v8, v10, 2, v8
    v_lshl_add_u32 v8, v27, 3, v8
    v_mul_u32_u24 v8, 3840, v8
    v_lshl_add_u32 v27, v7, 4, v8
    v_subrev_u32 v27, 1024, v27
    v_add_u32 v7, 128, v1
    v_mul_u32_u24 v8, 6554, v7
    v_lshrrev_b32 v8, 16, v8
    v_mul_u32_u24 v10, 10, v8
    v_sub_u32 v7, v7, v10
    v_bfe_u32 v28, v8, 2, 2
    v_lshrrev_b32 v10, 4, v8
    v_and_b32 v8, 3, v8
    v_lshl_add_u32 v8, v10, 2, v8
    v_lshl_add_u32 v8, v28, 3, v8
    v_mul_u32_u24 v8, 3840, v8
    v_lshl_add_u32 v28, v7, 4, v8
    v_subrev_u32 v28, 2048, v28
    v_add_u32 v7, 192, v1
    v_mul_u32_u24 v8, 6554, v7
    v_lshrrev_b32 v8, 16, v8
    v_mul_u32_u24 v10, 10, v8
    v_sub_u32 v7, v7, v10
    v_bfe_u32 v29, v8, 2, 2
    v_lshrrev_b32 v10, 4, v8
    v_and_b32 v8, 3, v8
    v_lshl_add_u32 v8, v10, 2, v8
    v_lshl_add_u32 v8, v29, 3, v8
    v_mul_u32_u24 v8, 3840, v8
    v_lshl_add_u32 v29, v7, 4, v8
    v_subrev_u32 v29, 3072, v29
    v_add_u32 v7, 256, v1
    v_mul_u32_u24 v8, 6554, v7
    v_lshrrev_b32 v8, 16, v8
    v_mul_u32_u24 v10, 10, v8
    v_sub_u32 v7, v7, v10
    v_bfe_u32 v30, v8, 2, 2
    v_lshrrev_b32 v10, 4, v8
    v_and_b32 v8, 3, v8
    v_lshl_add_u32 v8, v10, 2, v8
    v_lshl_add_u32 v8, v30, 3, v8
    v_mul_u32_u24 v8, 3840, v8
    v_lshl_add_u32 v30, v7, 4, v8
    s_mul_i32 s68, s3, 122880
    s_mul_i32 s49, s4, 160
    s_add_u32 s68, s68, s49
    s_add_u32 s68, s68, 1280
    s_mul_i32 s69, s4, 20
    s_add_u32 s69, s69, s3
    s_mul_i32 s69, s69, 5120
    s_add_u32 s69, s69, 1048576
    v_mov_b32 v32, -1
    v_mov_b32 v36, 0
    v_mov_b32 v33, -1
    v_mov_b32 v37, 0
    v_mov_b32 v34, -1
    v_mov_b32 v38, 0
    v_mov_b32 v35, -1
    v_mov_b32 v39, 0
    s_add_u32 s70, s64, 15360
    s_cmp_eq_u32 s3, 3
    s_cselect_b32 s70, 56320, s70
    v_and_b32 v8, 3, v1
    v_lshlrev_b32 v8, 2, v8
    v_add_u32 v12, 162816, v8
    s_lshl_b32 s49, s3, 2
    s_add_u32 s49, s49, 162816
    v_mov_b32 v11, s49
    s_setprio 0
    s_waitcnt vmcnt(8)
    s_barrier
    s_lshl_b32 s52, s45, 8
    s_add_u32 m0, s63, 4096
    s_add_u32 s52, s52, s62
    buffer_load_dwordx4 v13, s[8:11], s52 offen offset:0 lds
    buffer_load_dwordx4 v14, s[8:11], s52 offen offset:1024 lds
    buffer_load_dwordx4 v15, s[8:11], s52 offen offset:2048 lds
    buffer_load_dwordx4 v16, s[8:11], s52 offen offset:3072 lds
    s_lshl_b32 s52, s46, 8
    s_add_u32 m0, s63, 8192
    s_add_u32 s52, s52, s62
    buffer_load_dwordx4 v13, s[8:11], s52 offen offset:0 lds
    buffer_load_dwordx4 v14, s[8:11], s52 offen offset:1024 lds
    buffer_load_dwordx4 v15, s[8:11], s52 offen offset:2048 lds
    buffer_load_dwordx4 v16, s[8:11], s52 offen offset:3072 lds
    s_lshl_b32 s52, s47, 8
    s_add_u32 m0, s63, 12288
    s_add_u32 s52, s52, s62
    buffer_load_dwordx4 v13, s[8:11], s52 offen offset:0 lds
    buffer_load_dwordx4 v14, s[8:11], s52 offen offset:1024 lds
    s_waitcnt vmcnt(6)
    s_barrier
    buffer_load_dwordx4 v15, s[8:11], s52 offen offset:2048 lds
    buffer_load_dwordx4 v16, s[8:11], s52 offen offset:3072 lds
    s_lshl_b32 s52, s48, 8
    s_add_u32 m0, s63, 16384
    s_add_u32 s52, s52, s62
    buffer_load_dwordx4 v13, s[8:11], s52 offen offset:0 lds
    buffer_load_dwordx4 v14, s[8:11], s52 offen offset:1024 lds
    s_waitcnt vmcnt(6)
    s_cmp_eq_u32 s54, 1
    s_cbranch_scc1 L_z_5008
L_z_5009:
    s_barrier
    buffer_load_dwordx4 v15, s[8:11], s52 offen offset:2048 lds
    buffer_load_dwordx4 v16, s[8:11], s52 offen offset:3072 lds
    s_add_u32 m0, s64, 0
    s_mul_i32 s52, s44, 491520
    s_add_u32 s52, s52, s68
    buffer_load_dwordx4 v26, s[12:15], s52 offen offset:0 lds
    buffer_load_dwordx4 v27, s[12:15], s52 offen offset:1024 lds
    s_waitcnt vmcnt(6)
    s_barrier
    buffer_load_dwordx4 v28, s[12:15], s52 offen offset:2048 lds
    buffer_load_dwordx4 v29, s[12:15], s52 offen offset:3072 lds
    s_add_u32 m0, m0, 4096
s_nop 0
    buffer_load_dwordx4 v30, s[12:15], s52 offen offset:0 lds
    s_lshl3_add_u32 s71, s5, s4
    s_mul_i32 s71, s71, 12
    s_add_u32 s71, s71, s3
    s_lshl_b32 s71, s71, 11
    s_add_u32 s71, s71, 8388608
    buffer_store_dwordx4 v[32:35], v5, s[16:19], s71 offen offset:0 sc1
    s_waitcnt vmcnt(6)
    s_barrier
    s_barrier
    buffer_store_dwordx4 v[32:35], v5, s[16:19], s71 offen offset:1024 sc1
    s_mul_i32 s49, s3, 1536
    s_sub_u32 s71, s71, s49
    s_add_u32 s71, s71, 8192
    s_mov_b32 exec_hi, 0
    buffer_store_dwordx4 v[32:35], v5, s[16:19], s71 offen sc1
    s_mov_b32 exec_hi, -1
    s_mov_b64 exec, 0xffff
    s_cmp_lg_u32 s3, 0
    s_cbranch_scc1 L_pz_5010
    s_lshl_b32 s71, s2, 8
    s_add_u32 s71, s71, 65536
    buffer_store_dwordx4 v[36:39], v5, s[16:19], s71 offen sc1
L_pz_5010:
    s_cmp_lg_u32 s3, 1
    s_cbranch_scc1 L_pz_5011
    s_lshl_b32 s71, s4, 5
    s_add_u32 s71, s71, s5
    s_lshl_b32 s71, s71, 8
    s_add_u32 s71, s71, 7340032
    buffer_store_dwordx4 v[32:35], v5, s[16:19], s71 offen sc1
L_pz_5011:
    s_cmp_lg_u32 s3, 2
    s_cbranch_scc1 L_pz_5012
    s_lshl_b32 s71, s2, 9
    s_add_u32 s71, s71, 262144
    s_mov_b32 exec_lo, -1
    buffer_store_dwordx4 v[36:39], v5, s[16:19], s71 offen sc1
L_pz_5012:
    s_mov_b64 exec, -1
    s_add_u32 m0, s64, 5120
    s_mul_i32 s52, s45, 491520
    s_add_u32 s52, s52, s68
    buffer_load_dwordx4 v26, s[12:15], s52 offen offset:0 lds
    buffer_load_dwordx4 v27, s[12:15], s52 offen offset:1024 lds
    buffer_load_dwordx4 v28, s[12:15], s52 offen offset:2048 lds
    buffer_load_dwordx4 v29, s[12:15], s52 offen offset:3072 lds
    s_add_u32 m0, m0, 4096
s_nop 0
.p2align 3
    buffer_load_dwordx4 v30, s[12:15], s52 offen offset:0 lds
    ds_read_b64_tr_b16 v[40:41], v18 offset:0
    ds_read_b64_tr_b16 v[42:43], v19 offset:0
    ds_read_b64_tr_b16 v[44:45], v18 offset:8
    ds_read_b64_tr_b16 v[46:47], v19 offset:8
    ds_read_b64_tr_b16 v[48:49], v18 offset:16
    ds_read_b64_tr_b16 v[50:51], v19 offset:16
    ds_read_b64_tr_b16 v[52:53], v20 offset:0
    ds_read_b64_tr_b16 v[54:55], v21 offset:0
    ds_read_b64_tr_b16 v[56:57], v20 offset:8
    ds_read_b64_tr_b16 v[58:59], v21 offset:8
    ds_read_b64_tr_b16 v[60:61], v20 offset:16
    ds_read_b64_tr_b16 v[62:63], v21 offset:16
    s_waitcnt lgkmcnt(0)
.p2align 3
    buffer_store_dwordx4 v[40:43], v5, s[16:19], s100 offen offset:0 sc1
    buffer_store_dwordx4 v[44:47], v5, s[16:19], s100 offen offset:1024 sc1
    buffer_store_dwordx4 v[48:51], v5, s[16:19], s100 offen offset:2048 sc1
    buffer_store_dwordx4 v[52:55], v5, s[16:19], s65 offen offset:0 sc1
    buffer_store_dwordx4 v[56:59], v5, s[16:19], s65 offen offset:1024 sc1
    buffer_store_dwordx4 v[60:63], v5, s[16:19], s66 offen offset:2048 sc1
    s_cmp_lg_u32 s3, 1
    s_cbranch_scc1 L_w1_5013
    buffer_load_dword v23, v6, s[40:43], 0 offen sc1
L_w1_5013:
    s_add_u32 m0, s64, 10240
    s_mul_i32 s52, s46, 491520
    s_add_u32 s52, s52, s68
    buffer_load_dwordx4 v26, s[12:15], s52 offen offset:0 lds
    buffer_load_dwordx4 v27, s[12:15], s52 offen offset:1024 lds
    buffer_load_dwordx4 v28, s[12:15], s52 offen offset:2048 lds
    s_mul_i32 s62, s5, 196608
    s_add_u32 s62, s62, 8388608
    s_lshl_b32 s49, s4, 2
    s_add_u32 s49, s49, s3
    s_mul_i32 s49, s49, 61440
    s_add_u32 s72, s49, 3145728
    s_add_u32 s73, s49, 5273600
    s_mul_i32 s49, s3, 49152
    s_add_u32 s49, s49, s62
    s_add_u32 s74, s49, 24576
    s_mul_i32 s49, s4, 24576
    s_add_u32 s79, s49, s62
    s_lshr_b32 s49, s3, 1
    s_mul_i32 s49, s49, 3072
    s_add_u32 s49, s49, s79
    s_and_b32 s50, s3, 1
    s_lshl_b32 s50, s50, 10
    s_add_u32 s49, s49, s50
    s_add_u32 s75, s49, 0
    s_lshl_b32 s49, s5, 3
    s_add_u32 s50, s49, s4
    s_lshl_b32 s50, s50, 7
    s_lshl_b32 s51, s3, 2
    s_add_u32 s50, s50, s51
    s_add_u32 s76, s50, 98320
    s_lshl_b32 s50, s3, 1
    s_add_u32 s49, s49, s50
    s_lshl_b32 s49, s49, 7
    s_add_u32 s77, s49, 98432
    s_lshl_b32 s49, s5, 4
    s_add_u32 s49, s49, s3
    s_mul_i32 s49, s49, 5120
    s_mul_i32 s50, s4, 160
    s_add_u32 s78, s49, s50
    s_waitcnt vmcnt(17)
    s_barrier
    s_waitcnt vmcnt(9)
    s_barrier
    buffer_load_dwordx4 v29, s[12:15], s52 offen offset:3072 lds
    s_add_u32 m0, m0, 4096
s_nop 0
    buffer_load_dwordx4 v30, s[12:15], s52 offen offset:0 lds
    s_mul_i32 s52, s3, 800
    s_add_u32 m0, s52, 36864
    s_lshl_b32 s52, s4, 2
    s_add_u32 s52, s52, s3
    s_mul_i32 s52, s52, 800
    s_mov_b32 exec_hi, 0x3ffff
    buffer_load_dwordx4 v5, s[28:31], s52 offen lds
    s_mov_b32 exec_hi, -1
    s_add_u32 m0, s70, 0
    s_mul_i32 s52, s47, 491520
    s_add_u32 s52, s52, s68
    buffer_load_dwordx4 v26, s[12:15], s52 offen offset:0 lds
    buffer_load_dwordx4 v27, s[12:15], s52 offen offset:1024 lds
    buffer_load_dwordx4 v28, s[12:15], s52 offen offset:2048 lds
    buffer_load_dwordx4 v29, s[12:15], s52 offen offset:3072 lds
    s_add_u32 m0, m0, 4096
s_nop 0
    buffer_load_dwordx4 v30, s[12:15], s52 offen offset:0 lds
    s_add_u32 m0, s67, 61440
    s_mul_i32 s52, s48, 491520
    s_add_u32 s52, s52, s68
    buffer_load_dwordx4 v26, s[12:15], s52 offen offset:0 lds
    buffer_load_dwordx4 v27, s[12:15], s52 offen offset:1024 lds
    s_waitcnt vmcnt(8)
    s_barrier
    s_cmp_lg_u32 s3, 1
    s_cbranch_scc1 L_w1_5014
    v_cmp_gt_u32 vcc, 1, v23
    s_cbranch_vccnz L_spin_5015
L_ok_5016:
    s_getreg_b32 s50, hwreg(HW_REG_XCC_ID, 0, 3)
    s_lshl_b32 s50, s50, 2
    s_lshl_b32 s58, 1, s50
    s_lshl_b32 s60, 7, s50
    s_lshl_b32 s61, 8, s50
    s_mov_b32 s59, 1
    s_lshl_b32 s49, s5, 7
    s_atomic_add_x2 s[58:59], s[16:17], s49
L_w1_5014:
    buffer_load_dwordx4 v28, s[12:15], s52 offen offset:2048 lds
    buffer_load_dwordx4 v29, s[12:15], s52 offen offset:3072 lds
    s_add_u32 m0, m0, 4096
s_nop 0
    buffer_load_dwordx4 v30, s[12:15], s52 offen offset:0 lds
    s_add_u32 s68, s68, 1280
    s_add_u32 m0, s64, 0
    s_mul_i32 s52, s44, 491520
    s_add_u32 s52, s52, s68
    buffer_load_dwordx4 v26, s[12:15], s52 offen offset:0 lds
    buffer_load_dwordx4 v27, s[12:15], s52 offen offset:1024 lds
    buffer_load_dwordx4 v28, s[12:15], s52 offen offset:2048 lds
    s_waitcnt vmcnt(8)
    s_barrier
    buffer_load_dwordx4 v29, s[12:15], s52 offen offset:3072 lds
    s_add_u32 m0, m0, 4096
s_nop 0
    buffer_load_dwordx4 v30, s[12:15], s52 offen offset:0 lds
    s_add_u32 m0, s64, 5120
    s_mul_i32 s52, s45, 491520
    s_add_u32 s52, s52, s68
    buffer_load_dwordx4 v26, s[12:15], s52 offen offset:0 lds
    buffer_load_dwordx4 v27, s[12:15], s52 offen offset:1024 lds
    buffer_load_dwordx4 v28, s[12:15], s52 offen offset:2048 lds
    s_waitcnt vmcnt(8)
    s_barrier
    buffer_load_dwordx4 v29, s[12:15], s52 offen offset:3072 lds
    s_add_u32 m0, m0, 4096
s_nop 0
    buffer_load_dwordx4 v30, s[12:15], s52 offen offset:0 lds
    s_add_u32 m0, s64, 10240
    s_mul_i32 s52, s46, 491520
    s_add_u32 s52, s52, s68
    buffer_load_dwordx4 v26, s[12:15], s52 offen offset:0 lds
    s_barrier
    buffer_load_dwordx4 v27, s[12:15], s52 offen offset:1024 lds
    buffer_load_dwordx4 v28, s[12:15], s52 offen offset:2048 lds
    buffer_load_dwordx4 v29, s[12:15], s52 offen offset:3072 lds
    s_add_u32 m0, m0, 4096
s_nop 0
    buffer_load_dwordx4 v30, s[12:15], s52 offen offset:0 lds
    s_add_u32 m0, s70, 0
    s_mul_i32 s52, s47, 491520
    s_add_u32 s52, s52, s68
    buffer_load_dwordx4 v26, s[12:15], s52 offen offset:0 lds
    v_and_b32 v22, 31, v1
    v_lshlrev_b32 v22, 7, v22
    s_cmp_lg_u32 s3, 1
    s_cbranch_scc1 L_w1_5018
    buffer_load_dwordx2 v[24:25], v22, s[16:19], 0 offen sc1
L_w1_5018:
    s_waitcnt vmcnt(11)
    s_barrier
    buffer_load_dwordx4 v27, s[12:15], s52 offen offset:1024 lds
    buffer_load_dwordx4 v28, s[12:15], s52 offen offset:2048 lds
    buffer_load_dwordx4 v29, s[12:15], s52 offen offset:3072 lds
    s_add_u32 m0, m0, 4096
s_nop 0
    buffer_load_dwordx4 v30, s[12:15], s52 offen offset:0 lds
    s_add_u32 m0, s67, 61440
    s_mul_i32 s52, s48, 491520
    s_add_u32 s52, s52, s68
    buffer_load_dwordx4 v26, s[12:15], s52 offen offset:0 lds
    s_waitcnt vmcnt(11)
    s_barrier
    s_cmp_lg_u32 s3, 1
    s_cbranch_scc1 L_w1_5019
    s_waitcnt vmcnt(5)
    v_cmp_gt_u32 vcc, 8, v25
    s_cbranch_vccnz L_spin_5020
L_spx_5023:
    v_readlane_b32 s49, v24, s5
    s_nop 3
    s_cmp_eq_u32 s49, s61
    s_cselect_b32 s49, 1, 0
    v_mov_b32 v10, s49
L_ok_5021:
    s_mov_b64 exec, 1
    ds_write_b32 v11, v10 offset:44
    s_mov_b64 exec, -1
    s_waitcnt lgkmcnt(0)
L_w1_5019:
    buffer_load_dwordx4 v27, s[12:15], s52 offen offset:1024 lds
    buffer_load_dwordx4 v28, s[12:15], s52 offen offset:2048 lds
    buffer_load_dwordx4 v29, s[12:15], s52 offen offset:3072 lds
    s_add_u32 m0, m0, 4096
s_nop 0
    buffer_load_dwordx4 v30, s[12:15], s52 offen offset:0 lds
    s_waitcnt vmcnt(10)
    s_barrier
    s_add_u32 m0, s64, 0
    s_mul_i32 s52, s44, 20480
    s_add_u32 s52, s52, s69
    buffer_load_dwordx4 v5, s[16:19], s52 offen offset:0 sc1 lds
    buffer_load_dwordx4 v5, s[16:19], s52 offen offset:1024 sc1 lds
    buffer_load_dwordx4 v5, s[16:19], s52 offen offset:2048 sc1 lds
    buffer_load_dwordx4 v5, s[16:19], s52 offen offset:3072 sc1 lds
    s_add_u32 m0, m0, 4096
    s_add_u32 s52, s52, 4096
    buffer_load_dwordx4 v5, s[16:19], s52 offen offset:0 sc1 lds
    buffer_load_dwordx4 v[96:99], v5, s[16:19], s72 offen offset:0 sc1
    s_waitcnt vmcnt(11)
    s_barrier
    s_add_u32 m0, s64, 5120
    s_mul_i32 s52, s45, 20480
    s_add_u32 s52, s52, s69
    buffer_load_dwordx4 v5, s[16:19], s52 offen offset:0 sc1 lds
    buffer_load_dwordx4 v5, s[16:19], s52 offen offset:1024 sc1 lds
    buffer_load_dwordx4 v5, s[16:19], s52 offen offset:2048 sc1 lds
    buffer_load_dwordx4 v5, s[16:19], s52 offen offset:3072 sc1 lds
    s_add_u32 m0, m0, 4096
    s_add_u32 s52, s52, 4096
    buffer_load_dwordx4 v5, s[16:19], s52 offen offset:0 sc1 lds
    s_waitcnt vmcnt(11)
    s_barrier
    s_add_u32 m0, s64, 10240
    s_mul_i32 s52, s46, 20480
    s_add_u32 s52, s52, s69
    buffer_load_dwordx4 v5, s[16:19], s52 offen offset:0 sc1 lds
    buffer_load_dwordx4 v5, s[16:19], s52 offen offset:1024 sc1 lds
    buffer_load_dwordx4 v5, s[16:19], s52 offen offset:2048 sc1 lds
    buffer_load_dwordx4 v5, s[16:19], s52 offen offset:3072 sc1 lds
    s_add_u32 m0, m0, 4096
    s_add_u32 s52, s52, 4096
    buffer_load_dwordx4 v5, s[16:19], s52 offen offset:0 sc1 lds
    s_waitcnt vmcnt(8)
    buffer_load_dwordx4 v[100:103], v5, s[16:19], s72 offen offset:1024 sc1
    s_waitcnt vmcnt(8)
    s_add_u32 s72, s72, 3072
    buffer_load_dwordx4 v[104:107], v5, s[16:19], s72 offen offset:0 sc1
    s_waitcnt vmcnt(8)
    buffer_load_dwordx4 v[108:111], v5, s[16:19], s72 offen offset:1024 sc1
    s_waitcnt vmcnt(8)
    s_add_u32 s72, s72, 3072
    buffer_load_dwordx4 v[112:115], v5, s[16:19], s72 offen offset:0 sc1
    s_waitcnt vmcnt(8)
    buffer_load_dwordx4 v[116:119], v5, s[16:19], s72 offen offset:1024 sc1
    s_waitcnt vmcnt(8)
    s_add_u32 s72, s72, 3072
    buffer_load_dwordx4 v[120:123], v5, s[16:19], s72 offen offset:0 sc1
    s_waitcnt vmcnt(8)
    buffer_load_dwordx4 v[124:127], v5, s[16:19], s72 offen offset:1024 sc1
    s_waitcnt vmcnt(8)
    s_add_u32 s72, s72, 3072
    buffer_load_dwordx4 v[128:131], v5, s[16:19], s72 offen offset:0 sc1
    s_waitcnt vmcnt(8)
    buffer_load_dwordx4 v[132:135], v5, s[16:19], s72 offen offset:1024 sc1
    s_waitcnt vmcnt(8)
    s_add_u32 s72, s72, 3072
    buffer_load_dwordx4 v[136:139], v5, s[16:19], s72 offen offset:0 sc1
    s_waitcnt vmcnt(8)
    buffer_load_dwordx4 v[140:143], v5, s[16:19], s72 offen offset:1024 sc1
    s_waitcnt vmcnt(8)
    s_add_u32 s72, s72, 3072
    buffer_load_dwordx4 v[144:147], v5, s[16:19], s72 offen offset:0 sc1
    s_waitcnt vmcnt(8)
    buffer_load_dwordx4 v[148:151], v5, s[16:19], s72 offen offset:1024 sc1
    s_waitcnt vmcnt(8)
    s_add_u32 s72, s72, 3072
    buffer_load_dwordx4 v[152:155], v5, s[16:19], s72 offen offset:0 sc1
    s_waitcnt vmcnt(8)
    buffer_load_dwordx4 v[156:159], v5, s[16:19], s72 offen offset:1024 sc1
    s_mov_b32 s65, s73
    s_lshl_b32 s71, s3, 10
    v_mov_b32 v8, 162816
    ds_read_b32 v2, v8 offset:48
    s_waitcnt lgkmcnt(0)
    v_readfirstlane_b32 s54, v2
    s_lshl_b32 s80, s4, 5
    s_add_u32 s80, s80, s5
    s_lshl_b32 s82, s80, 8
    s_add_u32 s82, s82, 7340032
    s_mov_b32 s80, s79
    s_add_u32 s81, s80, 4096
    s_mov_b32 s83, s3
    s_mov_b32 s53, 262144
    v_and_b32 v7, 1, v1
    v_lshlrev_b32 v7, 4, v7
    v_mov_b32 v8, 0x3f80
    v_lshlrev_b32 v7, v7, v8
    v_bfe_u32 v8, v1, 1, 2
    v_cmp_eq_u32 vcc, 0, v8
s_nop 1
    v_cndmask_b32 v72, 0, v7, vcc
    v_cmp_eq_u32 vcc, 1, v8
s_nop 1
    v_cndmask_b32 v73, 0, v7, vcc
    v_cmp_eq_u32 vcc, 2, v8
s_nop 1
    v_cndmask_b32 v74, 0, v7, vcc
    v_cmp_eq_u32 vcc, 3, v8
s_nop 1
    v_cndmask_b32 v75, 0, v7, vcc
    v_mov_b32 v84, 0x3f803f80
    v_mov_b32 v85, 0x3f803f80
    v_mov_b32 v86, 0x3f803f80
    v_mov_b32 v87, 0x3f803f80
    v_mul_u32_u24 v92, 24, v4
    v_and_b32 v8, 7, v1
    v_lshlrev_b32 v0, 2, v8
    s_mul_i32 s49, s3, 5120
    s_add_u32 s49, s49, 0
    v_lshl_add_u32 v2, v1, 4, s49
    v_mul_u32_u24 v7, 21504, v4
    v_lshl_add_u32 v13, v3, 3, v7
    s_add_u32 s49, s71, 86016
    v_add_u32 v9, s49, v5
    s_mov_b32 s7, 4194304
L_lsp_5024:
    ds_read_b32 v7, v12 offset:0
    s_sub_u32 s7, s7, 1
    s_waitcnt lgkmcnt(0)
    s_cbranch_scc1 L_lok_5025
    v_cmp_gt_u32 vcc, 1, v7
    s_cbranch_vccz L_lok_5025
    s_sleep 2
    s_branch L_lsp_5024
L_lok_5025:
    v_mov_b32 v10, 1
    s_mov_b64 exec, 1
    ds_write_b32 v11, v10 offset:16
    s_mov_b64 exec, -1
    s_add_u32 m0, s70, 0
    s_mul_i32 s52, s47, 20480
    s_add_u32 s52, s52, s69
    buffer_load_dwordx4 v5, s[16:19], s52 offen offset:0 sc1 lds
    buffer_load_dwordx4 v5, s[16:19], s52 offen offset:1024 sc1 lds
    buffer_load_dwordx4 v5, s[16:19], s52 offen offset:2048 sc1 lds
    buffer_load_dwordx4 v5, s[16:19], s52 offen offset:3072 sc1 lds
    s_add_u32 m0, m0, 4096
    s_add_u32 s52, s52, 4096
    buffer_load_dwordx4 v5, s[16:19], s52 offen offset:0 sc1 lds
    s_add_u32 m0, s67, 61440
    s_mul_i32 s52, s48, 20480
    s_add_u32 s52, s52, s69
    buffer_load_dwordx4 v5, s[16:19], s52 offen offset:0 sc1 lds
    buffer_load_dwordx4 v5, s[16:19], s52 offen offset:1024 sc1 lds
    buffer_load_dwordx4 v5, s[16:19], s52 offen offset:2048 sc1 lds
    buffer_load_dwordx4 v5, s[16:19], s52 offen offset:3072 sc1 lds
    s_add_u32 m0, m0, 4096
    s_add_u32 s52, s52, 4096
    buffer_load_dwordx4 v5, s[16:19], s52 offen offset:0 sc1 lds
    s_waitcnt vmcnt(8)
    s_add_u32 s72, s72, 3072
    buffer_load_dwordx4 v[160:163], v5, s[16:19], s72 offen offset:0 sc1
    s_waitcnt vmcnt(8)
    buffer_load_dwordx4 v[164:167], v5, s[16:19], s72 offen offset:1024 sc1
    s_waitcnt vmcnt(8)
    s_add_u32 s72, s72, 3072
    buffer_load_dwordx4 v[168:171], v5, s[16:19], s72 offen offset:0 sc1
    s_waitcnt vmcnt(8)
    buffer_load_dwordx4 v[172:175], v5, s[16:19], s72 offen offset:1024 sc1
    s_waitcnt vmcnt(8)
    s_add_u32 s72, s72, 3072
    buffer_load_dwordx4 v[176:179], v5, s[16:19], s72 offen offset:0 sc1
    s_waitcnt vmcnt(8)
    buffer_load_dwordx4 v[180:183], v5, s[16:19], s72 offen offset:1024 sc1
    s_waitcnt vmcnt(6)
    v_mov_b32 v10, 2
    s_mov_b64 exec, 1
    ds_write_b32 v11, v10 offset:16
    s_mov_b64 exec, -1
    s_cmp_eq_u32 s83, 0
    s_cbranch_scc1 L_ha_5026
L_hab_5027:
    s_add_u32 s72, s72, 3072
    buffer_load_dwordx4 v[184:187], v5, s[16:19], s72 offen offset:0 sc1
    buffer_load_dwordx4 v[188:191], v5, s[16:19], s72 offen offset:1024 sc1
    s_add_u32 s72, s72, 3072
    buffer_load_dwordx4 v[192:195], v5, s[16:19], s72 offen offset:0 sc1
    s_waitcnt vmcnt(8)
    buffer_load_dwordx4 v[196:199], v5, s[16:19], s72 offen offset:1024 sc1
    s_cmp_eq_u32 s83, 0
    s_cbranch_scc1 L_ht_5028
L_htb_5029:
    s_waitcnt vmcnt(8)
    s_add_u32 s72, s72, 3072
    buffer_load_dwordx4 v[200:203], v5, s[16:19], s72 offen offset:0 sc1
    s_waitcnt vmcnt(8)
    buffer_load_dwordx4 v[204:207], v5, s[16:19], s72 offen offset:1024 sc1
    s_waitcnt vmcnt(8)
    s_add_u32 s72, s72, 3072
    buffer_load_dwordx4 v[208:211], v5, s[16:19], s72 offen offset:0 sc1
    s_waitcnt vmcnt(8)
    buffer_load_dwordx4 v[212:215], v5, s[16:19], s72 offen offset:1024 sc1
    s_waitcnt vmcnt(4)
    v_mov_b32 v10, 1
    s_mov_b64 exec, 1
    ds_write_b32 v11, v10 offset:32
    s_mov_b64 exec, -1
    s_add_u32 s72, s72, 3072
    buffer_load_dwordx4 v[216:219], v5, s[16:19], s72 offen offset:0 sc1
    buffer_load_dwordx4 v[220:223], v5, s[16:19], s72 offen offset:1024 sc1
    s_add_u32 s72, s72, 3072
    buffer_load_dwordx4 v[224:227], v5, s[16:19], s72 offen offset:0 sc1
    buffer_load_dwordx4 v[228:231], v5, s[16:19], s72 offen offset:1024 sc1
    s_add_u32 s72, s72, 3072
    buffer_load_dwordx4 v[232:235], v5, s[16:19], s72 offen offset:0 sc1
    s_mov_b32 s7, 4194304
L_lsp_5033:
    ds_read_b32 v7, v12 offset:0
    s_sub_u32 s7, s7, 1
    s_waitcnt lgkmcnt(0)
    s_cbranch_scc1 L_lok_5034
    v_cmp_gt_u32 vcc, 2, v7
    s_cbranch_vccz L_lok_5034
    s_sleep 2
    s_branch L_lsp_5033
L_lok_5034:
    s_cmp_eq_u32 s54, 0
    s_cbranch_scc1 L_pt_5035
    s_mul_i32 s49, s3, 512
    s_add_u32 s49, s49, s79
    s_add_u32 s49, s49, 8192
    v_lshlrev_b32 v94, 7, v1
    s_mov_b32 exec_lo, 0xf
    s_mov_b32 exec_hi, 0x0
    buffer_load_dword v93, v94, s[16:19], s49 offen sc1
    s_mov_b64 exec, -1
L_pt_5035:
    s_waitcnt vmcnt(8)
    s_add_u32 m0, s67, 0
    s_add_u32 s52, s69, 1048576
    buffer_load_dwordx4 v5, s[16:19], s52 offen offset:0 sc1 lds
    s_waitcnt vmcnt(8)
    buffer_load_dwordx4 v5, s[16:19], s52 offen offset:1024 sc1 lds
    s_waitcnt vmcnt(8)
    buffer_load_dwordx4 v5, s[16:19], s52 offen offset:2048 sc1 lds
    s_waitcnt vmcnt(8)
    buffer_load_dwordx4 v5, s[16:19], s52 offen offset:3072 sc1 lds
    s_waitcnt vmcnt(8)
    s_add_u32 m0, m0, 4096
    s_add_u32 s52, s52, 4096
    buffer_load_dwordx4 v5, s[16:19], s52 offen offset:0 sc1 lds
    s_waitcnt vmcnt(8)
    s_add_u32 m0, s67, 20480
    s_add_u32 s52, s69, 1069056
    buffer_load_dwordx4 v5, s[16:19], s52 offen offset:0 sc1 lds
    s_waitcnt vmcnt(8)
    buffer_load_dwordx4 v5, s[16:19], s52 offen offset:1024 sc1 lds
    s_waitcnt vmcnt(8)
    buffer_load_dwordx4 v5, s[16:19], s52 offen offset:2048 sc1 lds
    s_waitcnt vmcnt(8)
    buffer_load_dwordx4 v5, s[16:19], s52 offen offset:3072 sc1 lds
    s_waitcnt vmcnt(8)
    s_add_u32 m0, m0, 4096
    s_add_u32 s52, s52, 4096
    buffer_load_dwordx4 v5, s[16:19], s52 offen offset:0 sc1 lds
    s_waitcnt vmcnt(8)
    s_add_u32 m0, s67, 40960
    s_add_u32 s52, s69, 1089536
    buffer_load_dwordx4 v5, s[16:19], s52 offen offset:0 sc1 lds
    s_waitcnt vmcnt(8)
    buffer_load_dwordx4 v5, s[16:19], s52 offen offset:1024 sc1 lds
    s_waitcnt vmcnt(8)
    buffer_load_dwordx4 v5, s[16:19], s52 offen offset:2048 sc1 lds
    s_waitcnt vmcnt(8)
    buffer_load_dwordx4 v5, s[16:19], s52 offen offset:3072 sc1 lds
    s_waitcnt vmcnt(8)
    s_add_u32 m0, m0, 4096
    s_add_u32 s52, s52, 4096
    buffer_load_dwordx4 v5, s[16:19], s52 offen offset:0 sc1 lds
    s_waitcnt vmcnt(8)
    s_add_u32 m0, s67, 61440
    s_add_u32 s52, s69, 1110016
    buffer_load_dwordx4 v5, s[16:19], s52 offen offset:0 sc1 lds
    s_waitcnt vmcnt(8)
    buffer_load_dwordx4 v5, s[16:19], s52 offen offset:1024 sc1 lds
    s_waitcnt vmcnt(8)
    buffer_load_dwordx4 v5, s[16:19], s52 offen offset:2048 sc1 lds
    s_waitcnt vmcnt(8)
    buffer_load_dwordx4 v5, s[16:19], s52 offen offset:3072 sc1 lds
    s_waitcnt vmcnt(8)
    s_add_u32 m0, m0, 4096
    s_add_u32 s52, s52, 4096
    buffer_load_dwordx4 v5, s[16:19], s52 offen offset:0 sc1 lds
    s_waitcnt vmcnt(8)
    s_add_u32 m0, s67, 81920
    s_add_u32 s52, s69, 1130496
    buffer_load_dwordx4 v5, s[16:19], s52 offen offset:0 sc1 lds
    s_waitcnt vmcnt(8)
    buffer_load_dwordx4 v5, s[16:19], s52 offen offset:1024 sc1 lds
    s_waitcnt vmcnt(8)
    buffer_load_dwordx4 v5, s[16:19], s52 offen offset:2048 sc1 lds
    s_waitcnt vmcnt(8)
    buffer_load_dwordx4 v5, s[16:19], s52 offen offset:3072 sc1 lds
    s_waitcnt vmcnt(8)
    s_add_u32 m0, m0, 4096
    s_add_u32 s52, s52, 4096
    buffer_load_dwordx4 v5, s[16:19], s52 offen offset:0 sc1 lds
    s_waitcnt vmcnt(8)
    s_lshl_b32 s52, s4, 2
    s_add_u32 s52, s52, s3
    s_mul_i32 s52, s52, 96
    buffer_load_dwordx4 v[88:91], v92, s[32:35], s52 offen offset:0
    s_waitcnt vmcnt(8)
    buffer_load_dwordx4 v[236:239], v5, s[16:19], s72 offen offset:1024 sc1
    s_waitcnt vmcnt(8)
    s_add_u32 s72, s72, 3072
    buffer_load_dwordx4 v[240:243], v5, s[16:19], s72 offen offset:0 sc1
    s_waitcnt vmcnt(8)
    buffer_load_dwordx4 v[244:247], v5, s[16:19], s72 offen offset:1024 sc1
    s_waitcnt vmcnt(8)
    s_add_u32 s72, s72, 3072
    buffer_load_dwordx4 v[248:251], v5, s[16:19], s72 offen offset:0 sc1
    s_waitcnt vmcnt(8)
    buffer_load_dwordx4 v[252:255], v5, s[16:19], s72 offen offset:1024 sc1
    s_waitcnt vmcnt(8)
    s_add_u32 m0, s71, 110592
    s_add_u32 s66, s73, 0
    buffer_load_dwordx4 v5, s[16:19], s66 offen sc1 lds
    s_waitcnt vmcnt(7)
    v_mov_b32 v10, 3
    s_mov_b64 exec, 1
    ds_write_b32 v11, v10 offset:16
    s_mov_b64 exec, -1
    s_add_u32 m0, s71, 114688
    s_add_u32 s66, s73, 1024
    buffer_load_dwordx4 v5, s[16:19], s66 offen sc1 lds
    s_add_u32 m0, s71, 118784
    s_add_u32 s66, s73, 2048
    buffer_load_dwordx4 v5, s[16:19], s66 offen sc1 lds
    s_waitcnt vmcnt(8)
    s_add_u32 m0, s71, 122880
    s_add_u32 s66, s73, 3072
    buffer_load_dwordx4 v5, s[16:19], s66 offen sc1 lds
    s_waitcnt vmcnt(8)
    s_add_u32 m0, s71, 126976
    s_add_u32 s66, s73, 4096
    buffer_load_dwordx4 v5, s[16:19], s66 offen sc1 lds
    s_waitcnt vmcnt(8)
    s_add_u32 m0, s71, 131072
    s_add_u32 s66, s73, 5120
    buffer_load_dwordx4 v5, s[16:19], s66 offen sc1 lds
    s_waitcnt vmcnt(8)
    s_add_u32 m0, s71, 135168
    s_add_u32 s66, s73, 6144
    buffer_load_dwordx4 v5, s[16:19], s66 offen sc1 lds
    s_mov_b32 s7, 4194304
L_lsp_5036:
    ds_read_b32 v7, v12 offset:0
    s_sub_u32 s7, s7, 1
    s_waitcnt lgkmcnt(0)
    s_cbranch_scc1 L_lok_5037
    v_cmp_gt_u32 vcc, 3, v7
    s_cbranch_vccz L_lok_5037
    s_sleep 2
    s_branch L_lsp_5036
L_lok_5037:
    s_mov_b32 s7, 4194304
L_lsp_5038:
    ds_read_b32 v7, v12 offset:0
    s_sub_u32 s7, s7, 1
    s_waitcnt lgkmcnt(0)
    s_cbranch_scc1 L_lok_5039
    v_cmp_gt_u32 vcc, 4, v7
    s_cbranch_vccz L_lok_5039
    s_sleep 2
    s_branch L_lsp_5038
L_lok_5039:
    s_cmp_eq_u32 s54, 0
    s_cbranch_scc1 L_pt_5040
    s_mul_i32 s49, s3, 1024
    s_add_u32 s49, s49, s79
    s_add_u32 s49, s49, 10240
    v_lshlrev_b32 v94, 7, v1
    s_mov_b32 exec_lo, 0xff
    s_mov_b32 exec_hi, 0x0
    buffer_load_dword v93, v94, s[16:19], s49 offen sc1
    s_mov_b64 exec, -1
L_pt_5040:
    s_mov_b32 s7, 4194304
L_lsp_5041:
    ds_read_b32 v7, v12 offset:0
    s_sub_u32 s7, s7, 1
    s_waitcnt lgkmcnt(0)
    s_cbranch_scc1 L_lok_5042
    v_cmp_gt_u32 vcc, 5, v7
    s_cbranch_vccz L_lok_5042
    s_sleep 2
    s_branch L_lsp_5041
L_lok_5042:
    v_mfma_f32_16x16x32_bf16 v[32:35], v[96:99], v[84:87], 0
    v_mfma_f32_16x16x32_bf16 v[36:39], v[100:103], v[84:87], 0
    v_mfma_f32_16x16x32_bf16 v[32:35], v[104:107], v[84:87], v[32:35]
    v_mfma_f32_16x16x32_bf16 v[36:39], v[108:111], v[84:87], v[36:39]
    v_mfma_f32_16x16x32_bf16 v[32:35], v[112:115], v[84:87], v[32:35]
    v_mfma_f32_16x16x32_bf16 v[36:39], v[116:119], v[84:87], v[36:39]
    v_mfma_f32_16x16x32_bf16 v[32:35], v[120:123], v[84:87], v[32:35]
    v_mfma_f32_16x16x32_bf16 v[36:39], v[124:127], v[84:87], v[36:39]
    v_mfma_f32_16x16x32_bf16 v[32:35], v[128:131], v[84:87], v[32:35]
    v_mfma_f32_16x16x32_bf16 v[36:39], v[132:135], v[84:87], v[36:39]
    v_mfma_f32_16x16x32_bf16 v[32:35], v[136:139], v[84:87], v[32:35]
    v_mfma_f32_16x16x32_bf16 v[36:39], v[140:143], v[84:87], v[36:39]
    v_mfma_f32_16x16x32_bf16 v[32:35], v[144:147], v[84:87], v[32:35]
    v_mfma_f32_16x16x32_bf16 v[36:39], v[148:151], v[84:87], v[36:39]
    v_mfma_f32_16x16x32_bf16 v[32:35], v[152:155], v[84:87], v[32:35]
    v_mfma_f32_16x16x32_bf16 v[36:39], v[156:159], v[84:87], v[36:39]
    v_mfma_f32_16x16x32_bf16 v[32:35], v[160:163], v[84:87], v[32:35]
    v_mfma_f32_16x16x32_bf16 v[36:39], v[164:167], v[84:87], v[36:39]
    v_mfma_f32_16x16x32_bf16 v[32:35], v[168:171], v[84:87], v[32:35]
    v_mfma_f32_16x16x32_bf16 v[36:39], v[172:175], v[84:87], v[36:39]
    v_mfma_f32_16x16x32_bf16 v[32:35], v[176:179], v[84:87], v[32:35]
    v_mfma_f32_16x16x32_bf16 v[36:39], v[180:183], v[84:87], v[36:39]
    v_mfma_f32_16x16x32_bf16 v[32:35], v[184:187], v[84:87], v[32:35]
    v_mfma_f32_16x16x32_bf16 v[36:39], v[188:191], v[84:87], v[36:39]
    v_mfma_f32_16x16x32_bf16 v[32:35], v[192:195], v[84:87], v[32:35]
    v_mfma_f32_16x16x32_bf16 v[36:39], v[196:199], v[84:87], v[36:39]
    v_mfma_f32_16x16x32_bf16 v[32:35], v[200:203], v[84:87], v[32:35]
    v_mfma_f32_16x16x32_bf16 v[36:39], v[204:207], v[84:87], v[36:39]
    v_mfma_f32_16x16x32_bf16 v[32:35], v[208:211], v[84:87], v[32:35]
    v_mfma_f32_16x16x32_bf16 v[36:39], v[212:215], v[84:87], v[36:39]
    v_mfma_f32_16x16x32_bf16 v[32:35], v[216:219], v[84:87], v[32:35]
    v_mfma_f32_16x16x32_bf16 v[36:39], v[220:223], v[84:87], v[36:39]
    s_waitcnt vmcnt(7)
    v_mfma_f32_16x16x32_bf16 v[32:35], v[224:227], v[84:87], v[32:35]
    v_mfma_f32_16x16x32_bf16 v[36:39], v[228:231], v[84:87], v[36:39]
    v_mfma_f32_16x16x32_bf16 v[32:35], v[232:235], v[84:87], v[32:35]
    v_mfma_f32_16x16x32_bf16 v[36:39], v[236:239], v[84:87], v[36:39]
    v_mfma_f32_16x16x32_bf16 v[32:35], v[240:243], v[84:87], v[32:35]
    v_mfma_f32_16x16x32_bf16 v[36:39], v[244:247], v[84:87], v[36:39]
    v_mfma_f32_16x16x32_bf16 v[32:35], v[248:251], v[84:87], v[32:35]
    v_mfma_f32_16x16x32_bf16 v[36:39], v[252:255], v[84:87], v[36:39]
    v_lshlrev_b32 v24, 16, v88
    v_and_b32 v25, s55, v88
    v_lshlrev_b32 v26, 16, v89
    v_and_b32 v27, s55, v89
    v_lshlrev_b32 v28, 16, v90
    v_and_b32 v29, s55, v90
    v_lshlrev_b32 v30, 16, v91
    v_and_b32 v31, s55, v91
    s_waitcnt vmcnt(0)
    v_mov_b32 v3, 0xbdd2d3e8
    v_add_u32 v14, 43008, v5
    s_barrier
    ds_read_b128 v[40:43], v5 offset:0
    ds_read_b128 v[44:47], v5 offset:1024
    ds_read_b128 v[48:51], v5 offset:2048
    ds_read_b128 v[52:55], v5 offset:3072
    ds_read_b128 v[56:59], v5 offset:4096
    s_waitcnt lgkmcnt(4)
    v_mfma_f32_16x16x32_bf16 v[60:63], v[96:99], v[40:43], 0
    s_nop 0
    ds_read_b64 v[68:69], v13 offset:20480
    ds_read_b64 v[70:71], v13 offset:20608
    v_mfma_f32_16x16x32_bf16 v[64:67], v[100:103], v[40:43], 0
    s_waitcnt lgkmcnt(5)
    ds_read_b64 v[72:73], v13 offset:20736
    ds_read_b128 v[40:43], v5 offset:5120
    v_mfma_f32_16x16x32_bf16 v[60:63], v[104:107], v[44:47], v[60:63]
    ds_read_b64 v[74:75], v13 offset:20864
    v_mfma_f32_16x16x32_bf16 v[64:67], v[108:111], v[44:47], v[64:67]
    s_waitcnt lgkmcnt(7)
    ds_read_b64 v[76:77], v13 offset:20992
    ds_read_b64 v[78:79], v13 offset:21120
    ds_read_b128 v[44:47], v5 offset:6144
    v_mfma_f32_16x16x32_bf16 v[60:63], v[112:115], v[48:51], v[60:63]
    ds_read_b64 v[80:81], v13 offset:21248
    v_mfma_f32_16x16x32_bf16 v[64:67], v[116:119], v[48:51], v[64:67]
    s_waitcnt lgkmcnt(10)
    ds_read_b64 v[82:83], v13 offset:21376
    ds_read_b128 v[48:51], v5 offset:7168
    s_add_u32 m0, s71, 86016
    s_add_u32 s66, s73, 7168
    buffer_load_dwordx4 v5, s[16:19], s66 offen sc1 lds
    v_mfma_f32_16x16x32_bf16 v[60:63], v[120:123], v[52:55], v[60:63]
    v_mfma_f32_16x16x32_bf16 v[64:67], v[124:127], v[52:55], v[64:67]
    s_waitcnt lgkmcnt(11)
    ds_read_b128 v[52:55], v5 offset:8192
    v_mfma_f32_16x16x32_bf16 v[60:63], v[128:131], v[56:59], v[60:63]
    v_mfma_f32_16x16x32_bf16 v[64:67], v[132:135], v[56:59], v[64:67]
    s_waitcnt lgkmcnt(2)
    ds_read_b128 v[56:59], v5 offset:9216
    s_add_u32 m0, s71, 90112
    s_add_u32 s66, s73, 8192
    buffer_load_dwordx4 v5, s[16:19], s66 offen sc1 lds
    v_mfma_f32_16x16x32_bf16 v[60:63], v[136:139], v[40:43], v[60:63]
    v_add_f32 v68, v68, v70
    v_mfma_f32_16x16x32_bf16 v[64:67], v[140:143], v[40:43], v[64:67]
    s_nop 0
    ds_read_b128 v[40:43], v5 offset:10240
    v_add_f32 v69, v69, v71
    v_add_f32 v68, v68, v72
    v_mfma_f32_16x16x32_bf16 v[60:63], v[144:147], v[44:47], v[60:63]
    v_add_f32 v69, v69, v73
    v_mfma_f32_16x16x32_bf16 v[64:67], v[148:151], v[44:47], v[64:67]
    s_waitcnt lgkmcnt(3)
    ds_read_b128 v[44:47], v5 offset:11264
    s_add_u32 m0, s71, 94208
    s_add_u32 s66, s73, 9216
    buffer_load_dwordx4 v5, s[16:19], s66 offen sc1 lds
    v_add_f32 v68, v68, v74
    v_mfma_f32_16x16x32_bf16 v[60:63], v[152:155], v[48:51], v[60:63]
    v_add_f32 v69, v69, v75
    v_mfma_f32_16x16x32_bf16 v[64:67], v[156:159], v[48:51], v[64:67]
    s_waitcnt lgkmcnt(3)
    ds_read_b128 v[48:51], v5 offset:12288
    v_add_f32 v68, v68, v76
    v_add_f32 v69, v69, v77
    v_mfma_f32_16x16x32_bf16 v[60:63], v[160:163], v[52:55], v[60:63]
    v_add_f32 v68, v68, v78
    v_mfma_f32_16x16x32_bf16 v[64:67], v[164:167], v[52:55], v[64:67]
    s_waitcnt lgkmcnt(3)
    ds_read_b128 v[52:55], v5 offset:13312
    s_add_u32 m0, s71, 98304
    s_add_u32 s66, s73, 10240
    buffer_load_dwordx4 v5, s[16:19], s66 offen sc1 lds
    v_add_f32 v69, v69, v79
    v_mfma_f32_16x16x32_bf16 v[60:63], v[168:171], v[56:59], v[60:63]
    v_add_f32 v68, v68, v80
    v_mfma_f32_16x16x32_bf16 v[64:67], v[172:175], v[56:59], v[64:67]
    s_waitcnt lgkmcnt(3)
    ds_read_b128 v[56:59], v5 offset:14336
    v_add_f32 v69, v69, v81
    v_add_f32 v68, v68, v82
    v_mfma_f32_16x16x32_bf16 v[60:63], v[176:179], v[40:43], v[60:63]
    v_add_f32 v69, v69, v83
    v_mfma_f32_16x16x32_bf16 v[64:67], v[180:183], v[40:43], v[64:67]
    s_waitcnt lgkmcnt(3)
    ds_read_b128 v[40:43], v5 offset:15360
    s_add_u32 m0, s71, 102400
    s_add_u32 s66, s73, 11264
    buffer_load_dwordx4 v5, s[16:19], s66 offen sc1 lds
    v_mul_f32 v68, 0x3acccccd, v68
    v_mfma_f32_16x16x32_bf16 v[60:63], v[184:187], v[44:47], v[60:63]
    v_mul_f32 v69, 0x3acccccd, v69
    v_mfma_f32_16x16x32_bf16 v[64:67], v[188:191], v[44:47], v[64:67]
    s_waitcnt lgkmcnt(3)
    ds_read_b128 v[44:47], v5 offset:16384
    v_fma_f32 v69, -v68, v68, v69
    v_max_f32 v69, 0, v69
    v_mfma_f32_16x16x32_bf16 v[60:63], v[192:195], v[48:51], v[60:63]
    v_add_f32 v70, 0x3727c5ac, v69
    v_mfma_f32_16x16x32_bf16 v[64:67], v[196:199], v[48:51], v[64:67]
    s_waitcnt lgkmcnt(3)
    ds_read_b128 v[48:51], v5 offset:17408
    v_mul_f32 v70, 0x3727c5ac, v70
    v_mfma_f32_16x16x32_bf16 v[60:63], v[200:203], v[52:55], v[60:63]
    v_add_f32 v69, v69, v70
    v_mfma_f32_16x16x32_bf16 v[64:67], v[204:207], v[52:55], v[64:67]
    s_waitcnt lgkmcnt(3)
    ds_read_b128 v[52:55], v5 offset:18432
    s_add_u32 m0, s71, 106496
    s_add_u32 s66, s73, 12288
    buffer_load_dwordx4 v5, s[16:19], s66 offen sc1 lds
    v_rsq_f32 v88, v69
s_nop 0
    v_mul_f32 v68, v68, v88
    v_mfma_f32_16x16x32_bf16 v[60:63], v[208:211], v[56:59], v[60:63]
    v_sub_f32 v92, 0, v68
    v_mfma_f32_16x16x32_bf16 v[64:67], v[212:215], v[56:59], v[64:67]
    s_waitcnt lgkmcnt(3)
    ds_read_b128 v[56:59], v5 offset:19456
    v_mov_b32 v90, v88
    v_mfma_f32_16x16x32_bf16 v[60:63], v[216:219], v[40:43], v[60:63]
    v_mov_b32 v94, v92
    v_mfma_f32_16x16x32_bf16 v[64:67], v[220:223], v[40:43], v[64:67]
    s_barrier
    ds_read_b128 v[40:43], v5 offset:21504
    s_add_u32 s73, s73, 12288
    buffer_load_dwordx4 v[16:19], v5, s[16:19], s73 offen offset:1024 sc1
    s_waitcnt lgkmcnt(4)
    v_permlane32_swap_b32 v88, v90
    v_permlane32_swap_b32 v92, v94
    v_mfma_f32_16x16x32_bf16 v[60:63], v[224:227], v[44:47], v[60:63]
    v_mov_b32 v89, v88
    v_mfma_f32_16x16x32_bf16 v[64:67], v[228:231], v[44:47], v[64:67]
    s_waitcnt lgkmcnt(3)
    ds_read_b128 v[44:47], v5 offset:22528
    v_mov_b32 v91, v90
    v_mfma_f32_16x16x32_bf16 v[60:63], v[232:235], v[48:51], v[60:63]
    v_mov_b32 v93, v92
    v_mfma_f32_16x16x32_bf16 v[64:67], v[236:239], v[48:51], v[64:67]
    s_waitcnt lgkmcnt(3)
    ds_read_b128 v[48:51], v5 offset:23552
    buffer_load_dwordx4 v[20:23], v5, s[16:19], s73 offen offset:2048 sc1
    v_mov_b32 v95, v94
    v_permlane16_swap_b32 v88, v89
    v_mfma_f32_16x16x32_bf16 v[60:63], v[240:243], v[52:55], v[60:63]
    v_permlane16_swap_b32 v90, v91
    v_mfma_f32_16x16x32_bf16 v[64:67], v[244:247], v[52:55], v[64:67]
    s_waitcnt lgkmcnt(3)
    ds_read_b128 v[52:55], v5 offset:24576
    v_permlane16_swap_b32 v92, v93
    v_mfma_f32_16x16x32_bf16 v[60:63], v[248:251], v[56:59], v[60:63]
    v_permlane16_swap_b32 v94, v95
    v_mfma_f32_16x16x32_bf16 v[64:67], v[252:255], v[56:59], v[64:67]
    s_waitcnt lgkmcnt(3)
    ds_read_b128 v[56:59], v5 offset:25600
    v_mfma_f32_16x16x32_bf16 v[68:71], v[96:99], v[40:43], 0
    v_fma_f32 v76, v32, v92, v24
    v_fma_f32 v77, v33, v92, v25
    v_fma_f32 v78, v34, v92, v26
    v_mfma_f32_16x16x32_bf16 v[72:75], v[100:103], v[40:43], 0
    s_waitcnt lgkmcnt(3)
    ds_read_b128 v[40:43], v5 offset:26624
    v_fma_f32 v79, v35, v92, v27
    v_fmac_f32 v76, v60, v88
    v_mfma_f32_16x16x32_bf16 v[68:71], v[104:107], v[44:47], v[68:71]
    v_fmac_f32 v77, v61, v88
    v_fmac_f32 v78, v62, v88
    v_fmac_f32 v79, v63, v88
    v_mfma_f32_16x16x32_bf16 v[72:75], v[108:111], v[44:47], v[72:75]
    s_waitcnt lgkmcnt(3)
    ds_read_b128 v[44:47], v5 offset:27648
    v_mul_f32 v80, v76, v76
    v_mul_f32 v81, v77, v77
    v_mfma_f32_16x16x32_bf16 v[68:71], v[112:115], v[48:51], v[68:71]
    v_mul_f32 v82, v78, v78
    v_mul_f32 v83, v79, v79
    v_fmaak_f32 v80, v3, v80, 0xc0135761
    v_mfma_f32_16x16x32_bf16 v[72:75], v[116:119], v[48:51], v[72:75]
    s_waitcnt lgkmcnt(3)
    ds_read_b128 v[48:51], v5 offset:28672
    v_fmaak_f32 v81, v3, v81, 0xc0135761
    v_fmaak_f32 v82, v3, v82, 0xc0135761
    v_mfma_f32_16x16x32_bf16 v[68:71], v[120:123], v[52:55], v[68:71]
    v_fmaak_f32 v83, v3, v83, 0xc0135761
    v_mul_f32 v80, v80, v76
    v_mfma_f32_16x16x32_bf16 v[72:75], v[124:127], v[52:55], v[72:75]
    s_waitcnt lgkmcnt(3)
    ds_read_b128 v[52:55], v5 offset:29696
    v_mul_f32 v81, v81, v77
    v_mul_f32 v82, v82, v78
    v_mul_f32 v83, v83, v79
    v_mfma_f32_16x16x32_bf16 v[68:71], v[128:131], v[56:59], v[68:71]
    v_exp_f32 v80, v80
    v_mfma_f32_16x16x32_bf16 v[72:75], v[132:135], v[56:59], v[72:75]
    s_waitcnt lgkmcnt(3)
    ds_read_b128 v[56:59], v5 offset:30720
    v_exp_f32 v81, v81
    v_exp_f32 v82, v82
    v_mfma_f32_16x16x32_bf16 v[68:71], v[136:139], v[40:43], v[68:71]
    v_exp_f32 v83, v83
    v_mfma_f32_16x16x32_bf16 v[72:75], v[140:143], v[40:43], v[72:75]
    s_waitcnt lgkmcnt(3)
    ds_read_b128 v[40:43], v5 offset:31744
    v_add_f32 v80, 1.0, v80
    v_mfma_f32_16x16x32_bf16 v[68:71], v[144:147], v[44:47], v[68:71]
    v_add_f32 v81, 1.0, v81
    v_add_f32 v82, 1.0, v82
    v_add_f32 v83, 1.0, v83
    v_mfma_f32_16x16x32_bf16 v[72:75], v[148:151], v[44:47], v[72:75]
    s_waitcnt lgkmcnt(3)
    ds_read_b128 v[44:47], v5 offset:32768
    v_rcp_f32 v80, v80
    v_mfma_f32_16x16x32_bf16 v[68:71], v[152:155], v[48:51], v[68:71]
    v_rcp_f32 v81, v81
    v_rcp_f32 v82, v82
    v_mfma_f32_16x16x32_bf16 v[72:75], v[156:159], v[48:51], v[72:75]
    s_waitcnt lgkmcnt(3)
    ds_read_b128 v[48:51], v5 offset:33792
    v_rcp_f32 v83, v83
    v_mfma_f32_16x16x32_bf16 v[68:71], v[160:163], v[52:55], v[68:71]
    v_mul_f32 v76, v76, v80
    v_mfma_f32_16x16x32_bf16 v[72:75], v[164:167], v[52:55], v[72:75]
    s_waitcnt lgkmcnt(3)
    ds_read_b128 v[52:55], v5 offset:34816
    v_mul_f32 v77, v77, v81
    v_mul_f32 v78, v78, v82
    v_mul_f32 v79, v79, v83
    v_mfma_f32_16x16x32_bf16 v[68:71], v[168:171], v[56:59], v[68:71]
    v_cvt_pk_bf16_f32 v84, v76, v77
    v_cvt_pk_bf16_f32 v85, v78, v79
    v_mfma_f32_16x16x32_bf16 v[72:75], v[172:175], v[56:59], v[72:75]
    s_waitcnt lgkmcnt(3)
    ds_read_b128 v[56:59], v5 offset:35840
    v_fma_f32 v76, v36, v92, v28
    v_fma_f32 v77, v37, v92, v29
    v_fma_f32 v78, v38, v92, v30
    v_mfma_f32_16x16x32_bf16 v[68:71], v[176:179], v[40:43], v[68:71]
    v_fma_f32 v79, v39, v92, v31
    v_fmac_f32 v76, v64, v88
    v_mfma_f32_16x16x32_bf16 v[72:75], v[180:183], v[40:43], v[72:75]
    s_waitcnt lgkmcnt(3)
    ds_read_b128 v[40:43], v5 offset:36864
    v_fmac_f32 v77, v65, v88
    v_fmac_f32 v78, v66, v88
    v_fmac_f32 v79, v67, v88
    v_mfma_f32_16x16x32_bf16 v[68:71], v[184:187], v[44:47], v[68:71]
    v_mul_f32 v80, v76, v76
    v_mul_f32 v81, v77, v77
    v_mfma_f32_16x16x32_bf16 v[72:75], v[188:191], v[44:47], v[72:75]
    s_waitcnt lgkmcnt(3)
    ds_read_b128 v[44:47], v5 offset:37888
    v_mul_f32 v82, v78, v78
    v_mul_f32 v83, v79, v79
    v_mfma_f32_16x16x32_bf16 v[68:71], v[192:195], v[48:51], v[68:71]
    v_fmaak_f32 v80, v3, v80, 0xc0135761
    v_fmaak_f32 v81, v3, v81, 0xc0135761
    v_fmaak_f32 v82, v3, v82, 0xc0135761
    v_mfma_f32_16x16x32_bf16 v[72:75], v[196:199], v[48:51], v[72:75]
    s_waitcnt lgkmcnt(3)
    ds_read_b128 v[48:51], v5 offset:38912
    v_fmaak_f32 v83, v3, v83, 0xc0135761
    v_mul_f32 v80, v80, v76
    v_mfma_f32_16x16x32_bf16 v[68:71], v[200:203], v[52:55], v[68:71]
    v_mul_f32 v81, v81, v77
    v_mul_f32 v82, v82, v78
    v_mul_f32 v83, v83, v79
    v_mfma_f32_16x16x32_bf16 v[72:75], v[204:207], v[52:55], v[72:75]
    s_waitcnt lgkmcnt(3)
    ds_read_b128 v[52:55], v5 offset:39936
    v_exp_f32 v80, v80
    v_mfma_f32_16x16x32_bf16 v[68:71], v[208:211], v[56:59], v[68:71]
    v_exp_f32 v81, v81
    v_mfma_f32_16x16x32_bf16 v[72:75], v[212:215], v[56:59], v[72:75]
    s_waitcnt lgkmcnt(3)
    ds_read_b128 v[56:59], v5 offset:40960
    v_exp_f32 v82, v82
    v_exp_f32 v83, v83
    v_mfma_f32_16x16x32_bf16 v[68:71], v[216:219], v[40:43], v[68:71]
    v_add_f32 v80, 1.0, v80
    v_mfma_f32_16x16x32_bf16 v[72:75], v[220:223], v[40:43], v[72:75]
    s_barrier
    ds_read_b128 v[40:43], v14 offset:0
    s_waitcnt lgkmcnt(4)
    v_add_f32 v81, 1.0, v81
    v_add_f32 v82, 1.0, v82
    v_add_f32 v83, 1.0, v83
    v_mfma_f32_16x16x32_bf16 v[68:71], v[224:227], v[44:47], v[68:71]
    v_rcp_f32 v80, v80
    v_mfma_f32_16x16x32_bf16 v[72:75], v[228:231], v[44:47], v[72:75]
    s_waitcnt lgkmcnt(3)
    ds_read_b128 v[44:47], v14 offset:1024
    v_rcp_f32 v81, v81
    v_mfma_f32_16x16x32_bf16 v[68:71], v[232:235], v[48:51], v[68:71]
    v_rcp_f32 v82, v82
    v_rcp_f32 v83, v83
    v_mfma_f32_16x16x32_bf16 v[72:75], v[236:239], v[48:51], v[72:75]
    s_waitcnt lgkmcnt(3)
    ds_read_b128 v[48:51], v14 offset:2048
    v_mul_f32 v76, v76, v80
    v_mfma_f32_16x16x32_bf16 v[68:71], v[240:243], v[52:55], v[68:71]
    v_mul_f32 v77, v77, v81
    v_mul_f32 v78, v78, v82
    v_mul_f32 v79, v79, v83
    v_mfma_f32_16x16x32_bf16 v[72:75], v[244:247], v[52:55], v[72:75]
    s_waitcnt lgkmcnt(3)
    ds_read_b128 v[52:55], v14 offset:3072
    v_cvt_pk_bf16_f32 v86, v76, v77
    v_cvt_pk_bf16_f32 v87, v78, v79
    v_mfma_f32_16x16x32_bf16 v[68:71], v[248:251], v[56:59], v[68:71]
    s_nop 0
    buffer_store_dwordx4 v[84:87], v5, s[16:19], s75 offen nt
    s_add_u32 s75, s75, 6144
    v_mfma_f32_16x16x32_bf16 v[72:75], v[252:255], v[56:59], v[72:75]
    s_waitcnt lgkmcnt(3)
    ds_read_b128 v[56:59], v14 offset:4096
    v_mfma_f32_16x16x32_bf16 v[60:63], v[96:99], v[40:43], 0
    v_fma_f32 v76, v32, v93, v24
    v_fma_f32 v77, v33, v93, v25
    v_fma_f32 v78, v34, v93, v26
    v_mfma_f32_16x16x32_bf16 v[64:67], v[100:103], v[40:43], 0
    s_waitcnt lgkmcnt(3)
    ds_read_b128 v[40:43], v14 offset:5120
    v_fma_f32 v79, v35, v93, v27
    v_fmac_f32 v76, v68, v89
    v_mfma_f32_16x16x32_bf16 v[60:63], v[104:107], v[44:47], v[60:63]
    v_fmac_f32 v77, v69, v89
    v_fmac_f32 v78, v70, v89
    v_fmac_f32 v79, v71, v89
    v_mfma_f32_16x16x32_bf16 v[64:67], v[108:111], v[44:47], v[64:67]
    s_waitcnt lgkmcnt(3)
    ds_read_b128 v[44:47], v14 offset:6144
    v_mul_f32 v80, v76, v76
    v_mul_f32 v81, v77, v77
    v_mfma_f32_16x16x32_bf16 v[60:63], v[112:115], v[48:51], v[60:63]
    v_mul_f32 v82, v78, v78
    v_mul_f32 v83, v79, v79
    v_fmaak_f32 v80, v3, v80, 0xc0135761
    v_mfma_f32_16x16x32_bf16 v[64:67], v[116:119], v[48:51], v[64:67]
    s_waitcnt lgkmcnt(3)
    ds_read_b128 v[48:51], v14 offset:7168
    v_fmaak_f32 v81, v3, v81, 0xc0135761
    v_fmaak_f32 v82, v3, v82, 0xc0135761
    v_mfma_f32_16x16x32_bf16 v[60:63], v[120:123], v[52:55], v[60:63]
    v_fmaak_f32 v83, v3, v83, 0xc0135761
    v_mul_f32 v80, v80, v76
    v_mfma_f32_16x16x32_bf16 v[64:67], v[124:127], v[52:55], v[64:67]
    s_waitcnt lgkmcnt(3)
    ds_read_b128 v[52:55], v14 offset:8192
    v_mul_f32 v81, v81, v77
    v_mul_f32 v82, v82, v78
    v_mul_f32 v83, v83, v79
    v_mfma_f32_16x16x32_bf16 v[60:63], v[128:131], v[56:59], v[60:63]
    v_exp_f32 v80, v80
    v_mfma_f32_16x16x32_bf16 v[64:67], v[132:135], v[56:59], v[64:67]
    s_waitcnt lgkmcnt(3)
    ds_read_b128 v[56:59], v14 offset:9216
    v_exp_f32 v81, v81
    v_exp_f32 v82, v82
    v_mfma_f32_16x16x32_bf16 v[60:63], v[136:139], v[40:43], v[60:63]
    v_exp_f32 v83, v83
    v_mfma_f32_16x16x32_bf16 v[64:67], v[140:143], v[40:43], v[64:67]
    s_waitcnt lgkmcnt(3)
    ds_read_b128 v[40:43], v14 offset:10240
    v_add_f32 v80, 1.0, v80
    v_mfma_f32_16x16x32_bf16 v[60:63], v[144:147], v[44:47], v[60:63]
    v_add_f32 v81, 1.0, v81
    v_add_f32 v82, 1.0, v82
    v_add_f32 v83, 1.0, v83
    v_mfma_f32_16x16x32_bf16 v[64:67], v[148:151], v[44:47], v[64:67]
    s_waitcnt lgkmcnt(3)
    ds_read_b128 v[44:47], v14 offset:11264
    v_rcp_f32 v80, v80
    v_mfma_f32_16x16x32_bf16 v[60:63], v[152:155], v[48:51], v[60:63]
    v_rcp_f32 v81, v81
    v_rcp_f32 v82, v82
    v_mfma_f32_16x16x32_bf16 v[64:67], v[156:159], v[48:51], v[64:67]
    s_waitcnt lgkmcnt(3)
    ds_read_b128 v[48:51], v14 offset:12288
    v_rcp_f32 v83, v83
    v_mfma_f32_16x16x32_bf16 v[60:63], v[160:163], v[52:55], v[60:63]
    v_mul_f32 v76, v76, v80
    v_mfma_f32_16x16x32_bf16 v[64:67], v[164:167], v[52:55], v[64:67]
    s_waitcnt lgkmcnt(3)
    ds_read_b128 v[52:55], v14 offset:13312
    v_mul_f32 v77, v77, v81
    v_mul_f32 v78, v78, v82
    v_mul_f32 v79, v79, v83
    v_mfma_f32_16x16x32_bf16 v[60:63], v[168:171], v[56:59], v[60:63]
    v_cvt_pk_bf16_f32 v84, v76, v77
    v_cvt_pk_bf16_f32 v85, v78, v79
    v_mfma_f32_16x16x32_bf16 v[64:67], v[172:175], v[56:59], v[64:67]
    s_waitcnt lgkmcnt(3)
    ds_read_b128 v[56:59], v14 offset:14336
    v_fma_f32 v76, v36, v93, v28
    v_fma_f32 v77, v37, v93, v29
    v_fma_f32 v78, v38, v93, v30
    v_mfma_f32_16x16x32_bf16 v[60:63], v[176:179], v[40:43], v[60:63]
    v_fma_f32 v79, v39, v93, v31
    v_fmac_f32 v76, v72, v89
    v_mfma_f32_16x16x32_bf16 v[64:67], v[180:183], v[40:43], v[64:67]
    s_waitcnt lgkmcnt(3)
    ds_read_b128 v[40:43], v14 offset:15360
    v_fmac_f32 v77, v73, v89
    v_fmac_f32 v78, v74, v89
    v_fmac_f32 v79, v75, v89
    v_mfma_f32_16x16x32_bf16 v[60:63], v[184:187], v[44:47], v[60:63]
    v_mul_f32 v80, v76, v76
    v_mul_f32 v81, v77, v77
    v_mfma_f32_16x16x32_bf16 v[64:67], v[188:191], v[44:47], v[64:67]
    s_waitcnt lgkmcnt(3)
    ds_read_b128 v[44:47], v14 offset:16384
    v_mul_f32 v82, v78, v78
    v_mul_f32 v83, v79, v79
    v_mfma_f32_16x16x32_bf16 v[60:63], v[192:195], v[48:51], v[60:63]
    v_fmaak_f32 v80, v3, v80, 0xc0135761
    v_fmaak_f32 v81, v3, v81, 0xc0135761
    v_fmaak_f32 v82, v3, v82, 0xc0135761
    v_mfma_f32_16x16x32_bf16 v[64:67], v[196:199], v[48:51], v[64:67]
    v_fmaak_f32 v83, v3, v83, 0xc0135761
    v_mul_f32 v80, v80, v76
    ds_read_b128 v[48:51], v14 offset:17408
    s_waitcnt vmcnt(0)
    v_mov_b32 v7, 1
    s_mov_b64 exec, 1
    s_cmp_eq_u32 s54, 0
    s_cbranch_scc1 L_slow_5043
    buffer_store_dword v7, v6, s[16:19], s76 offen
L_back_5044:
    s_mov_b64 exec, -1
    s_waitcnt lgkmcnt(4)
    v_mfma_f32_16x16x32_bf16 v[60:63], v[200:203], v[52:55], v[60:63]
    v_mul_f32 v81, v81, v77
    v_mul_f32 v82, v82, v78
    v_mul_f32 v83, v83, v79
    v_mfma_f32_16x16x32_bf16 v[64:67], v[204:207], v[52:55], v[64:67]
    s_waitcnt lgkmcnt(3)
    ds_read_b128 v[52:55], v14 offset:18432
    v_exp_f32 v80, v80
    v_mfma_f32_16x16x32_bf16 v[60:63], v[208:211], v[56:59], v[60:63]
    v_exp_f32 v81, v81
    v_mfma_f32_16x16x32_bf16 v[64:67], v[212:215], v[56:59], v[64:67]
    s_waitcnt lgkmcnt(3)
    ds_read_b128 v[56:59], v14 offset:19456
    v_exp_f32 v82, v82
    v_exp_f32 v83, v83
    v_mfma_f32_16x16x32_bf16 v[60:63], v[216:219], v[40:43], v[60:63]
    v_add_f32 v80, 1.0, v80
    v_mfma_f32_16x16x32_bf16 v[64:67], v[220:223], v[40:43], v[64:67]
    s_waitcnt lgkmcnt(3)
    ds_read_b128 v[40:43], v14 offset:21504
    v_add_f32 v81, 1.0, v81
    v_add_f32 v82, 1.0, v82
    v_add_f32 v83, 1.0, v83
    v_mfma_f32_16x16x32_bf16 v[60:63], v[224:227], v[44:47], v[60:63]
    v_rcp_f32 v80, v80
    v_mfma_f32_16x16x32_bf16 v[64:67], v[228:231], v[44:47], v[64:67]
    s_waitcnt lgkmcnt(3)
    ds_read_b128 v[44:47], v14 offset:22528
    v_rcp_f32 v81, v81
    v_mfma_f32_16x16x32_bf16 v[60:63], v[232:235], v[48:51], v[60:63]
    v_rcp_f32 v82, v82
    v_rcp_f32 v83, v83
    v_mfma_f32_16x16x32_bf16 v[64:67], v[236:239], v[48:51], v[64:67]
    s_waitcnt lgkmcnt(3)
    ds_read_b128 v[48:51], v14 offset:23552
    v_mul_f32 v76, v76, v80
    v_mfma_f32_16x16x32_bf16 v[60:63], v[240:243], v[52:55], v[60:63]
    v_mul_f32 v77, v77, v81
    v_mul_f32 v78, v78, v82
    v_mul_f32 v79, v79, v83
    v_mfma_f32_16x16x32_bf16 v[64:67], v[244:247], v[52:55], v[64:67]
    s_waitcnt lgkmcnt(3)
    ds_read_b128 v[52:55], v14 offset:24576
    v_cvt_pk_bf16_f32 v86, v76, v77
    v_cvt_pk_bf16_f32 v87, v78, v79
    v_mfma_f32_16x16x32_bf16 v[60:63], v[248:251], v[56:59], v[60:63]
    s_nop 0
    buffer_store_dwordx4 v[84:87], v5, s[16:19], s75 offen nt
    s_add_u32 s75, s75, 6144
    v_mfma_f32_16x16x32_bf16 v[64:67], v[252:255], v[56:59], v[64:67]
    s_waitcnt lgkmcnt(3)
    ds_read_b128 v[56:59], v14 offset:25600
    v_mfma_f32_16x16x32_bf16 v[68:71], v[96:99], v[40:43], 0
    v_fma_f32 v76, v32, v94, v24
    v_fma_f32 v77, v33, v94, v25
    v_fma_f32 v78, v34, v94, v26
    v_mfma_f32_16x16x32_bf16 v[72:75], v[100:103], v[40:43], 0
    s_waitcnt lgkmcnt(3)
    ds_read_b128 v[40:43], v14 offset:26624
    buffer_load_dwordx4 v[96:99], v5, s[16:19], s73 offen offset:3072 sc1
    v_fma_f32 v79, v35, v94, v27
    v_fmac_f32 v76, v60, v90
    v_mfma_f32_16x16x32_bf16 v[68:71], v[104:107], v[44:47], v[68:71]
    v_fmac_f32 v77, v61, v90
    v_fmac_f32 v78, v62, v90
    v_fmac_f32 v79, v63, v90
    v_mfma_f32_16x16x32_bf16 v[72:75], v[108:111], v[44:47], v[72:75]
    s_waitcnt lgkmcnt(3)
    ds_read_b128 v[44:47], v14 offset:27648
    v_mul_f32 v80, v76, v76
    v_mul_f32 v81, v77, v77
    v_mfma_f32_16x16x32_bf16 v[68:71], v[112:115], v[48:51], v[68:71]
    v_mul_f32 v82, v78, v78
    v_mul_f32 v83, v79, v79
    v_fmaak_f32 v80, v3, v80, 0xc0135761
    v_mfma_f32_16x16x32_bf16 v[72:75], v[116:119], v[48:51], v[72:75]
    s_waitcnt lgkmcnt(3)
    ds_read_b128 v[48:51], v14 offset:28672
    s_add_u32 s73, s73, 4096
    buffer_load_dwordx4 v[100:103], v5, s[16:19], s73 offen offset:0 sc1
    v_fmaak_f32 v81, v3, v81, 0xc0135761
    v_fmaak_f32 v82, v3, v82, 0xc0135761
    v_mfma_f32_16x16x32_bf16 v[68:71], v[120:123], v[52:55], v[68:71]
    v_fmaak_f32 v83, v3, v83, 0xc0135761
    v_mul_f32 v80, v80, v76
    v_mfma_f32_16x16x32_bf16 v[72:75], v[124:127], v[52:55], v[72:75]
    s_nop 0
    ds_read_b128 v[52:55], v14 offset:29696
    buffer_load_dwordx4 v[104:107], v5, s[16:19], s73 offen offset:1024 sc1
    s_and_b32 s49, s77, 0xfffffc00
    v_mul_f32 v81, v81, v77
    v_mul_f32 v82, v82, v78
    v_mul_f32 v83, v83, v79
    v_lshrrev_b32 v7, 3, v1
    v_lshl_add_u32 v13, v7, 7, v0
    buffer_load_dword v4, v13, s[16:19], s49 offen sc1
    s_waitcnt lgkmcnt(4)
    v_mfma_f32_16x16x32_bf16 v[68:71], v[128:131], v[56:59], v[68:71]
    v_exp_f32 v80, v80
    v_mfma_f32_16x16x32_bf16 v[72:75], v[132:135], v[56:59], v[72:75]
    s_waitcnt lgkmcnt(3)
    ds_read_b128 v[56:59], v14 offset:30720
    v_exp_f32 v81, v81
    v_exp_f32 v82, v82
    v_mfma_f32_16x16x32_bf16 v[68:71], v[136:139], v[40:43], v[68:71]
    v_exp_f32 v83, v83
    v_mfma_f32_16x16x32_bf16 v[72:75], v[140:143], v[40:43], v[72:75]
    s_waitcnt lgkmcnt(3)
    ds_read_b128 v[40:43], v14 offset:31744
    buffer_load_dwordx4 v[108:111], v5, s[16:19], s73 offen offset:2048 sc1
    v_add_f32 v80, 1.0, v80
    v_mfma_f32_16x16x32_bf16 v[68:71], v[144:147], v[44:47], v[68:71]
    v_add_f32 v81, 1.0, v81
    v_add_f32 v82, 1.0, v82
    v_add_f32 v83, 1.0, v83
    v_mfma_f32_16x16x32_bf16 v[72:75], v[148:151], v[44:47], v[72:75]
    s_waitcnt lgkmcnt(3)
    ds_read_b128 v[44:47], v14 offset:32768
    v_rcp_f32 v80, v80
    v_mfma_f32_16x16x32_bf16 v[68:71], v[152:155], v[48:51], v[68:71]
    v_rcp_f32 v81, v81
    v_rcp_f32 v82, v82
    v_mfma_f32_16x16x32_bf16 v[72:75], v[156:159], v[48:51], v[72:75]
    s_waitcnt lgkmcnt(3)
    ds_read_b128 v[48:51], v14 offset:33792
    ds_read_b128 v[156:159], v9 offset:24576
    buffer_load_dwordx4 v[112:115], v5, s[16:19], s73 offen offset:3072 sc1
    v_rcp_f32 v83, v83
    v_mfma_f32_16x16x32_bf16 v[68:71], v[160:163], v[52:55], v[68:71]
    v_mul_f32 v76, v76, v80
    v_mfma_f32_16x16x32_bf16 v[72:75], v[164:167], v[52:55], v[72:75]
    s_waitcnt lgkmcnt(4)
    ds_read_b128 v[52:55], v14 offset:34816
    ds_read_b128 v[160:163], v9 offset:28672
    ds_read_b128 v[164:167], v9 offset:32768
    s_add_u32 s73, s73, 4096
    buffer_load_dwordx4 v[116:119], v5, s[16:19], s73 offen offset:0 sc1
    v_mul_f32 v77, v77, v81
    v_mul_f32 v78, v78, v82
    v_mul_f32 v79, v79, v83
    v_mfma_f32_16x16x32_bf16 v[68:71], v[168:171], v[56:59], v[68:71]
    v_cvt_pk_bf16_f32 v84, v76, v77
    v_cvt_pk_bf16_f32 v85, v78, v79
    v_mfma_f32_16x16x32_bf16 v[72:75], v[172:175], v[56:59], v[72:75]
    s_waitcnt lgkmcnt(6)
.p2align 3
    ds_read_b128 v[56:59], v14 offset:35840
    ds_read_b128 v[168:171], v9 offset:36864
    ds_read_b128 v[172:175], v9 offset:40960
    v_fma_f32 v76, v36, v94, v28
    v_fma_f32 v77, v37, v94, v29
    v_fma_f32 v78, v38, v94, v30
    v_mfma_f32_16x16x32_bf16 v[68:71], v[176:179], v[40:43], v[68:71]
    v_fma_f32 v79, v39, v94, v31
    v_fmac_f32 v76, v64, v90
    v_mfma_f32_16x16x32_bf16 v[72:75], v[180:183], v[40:43], v[72:75]
    s_waitcnt lgkmcnt(8)
    ds_read_b128 v[40:43], v14 offset:36864
    ds_read_b128 v[176:179], v9 offset:45056
    ds_read_b128 v[180:183], v9 offset:49152
    buffer_load_dwordx4 v[120:123], v5, s[16:19], s73 offen offset:1024 sc1
    v_fmac_f32 v77, v65, v90
    v_fmac_f32 v78, v66, v90
    v_fmac_f32 v79, v67, v90
    v_mfma_f32_16x16x32_bf16 v[68:71], v[184:187], v[44:47], v[68:71]
    v_mul_f32 v80, v76, v76
    v_mul_f32 v81, v77, v77
    v_mfma_f32_16x16x32_bf16 v[72:75], v[188:191], v[44:47], v[72:75]
    s_waitcnt lgkmcnt(10)
    ds_read_b128 v[44:47], v14 offset:37888
    ds_read_b128 v[184:187], v9 offset:0
    ds_read_b128 v[188:191], v9 offset:4096
    buffer_load_dwordx4 v[124:127], v5, s[16:19], s73 offen offset:2048 sc1
    v_mul_f32 v82, v78, v78
    v_mul_f32 v83, v79, v79
    v_mfma_f32_16x16x32_bf16 v[68:71], v[192:195], v[48:51], v[68:71]
    v_fmaak_f32 v80, v3, v80, 0xc0135761
    v_fmaak_f32 v81, v3, v81, 0xc0135761
    v_fmaak_f32 v82, v3, v82, 0xc0135761
    v_mfma_f32_16x16x32_bf16 v[72:75], v[196:199], v[48:51], v[72:75]
    s_waitcnt lgkmcnt(11)
    ds_read_b128 v[48:51], v14 offset:38912
    ds_read_b128 v[192:195], v9 offset:8192
    ds_read_b128 v[196:199], v9 offset:12288
    v_fmaak_f32 v83, v3, v83, 0xc0135761
    v_mul_f32 v80, v80, v76
    v_mfma_f32_16x16x32_bf16 v[68:71], v[200:203], v[52:55], v[68:71]
    v_mul_f32 v81, v81, v77
    v_mul_f32 v82, v82, v78
    v_mul_f32 v83, v83, v79
    v_mfma_f32_16x16x32_bf16 v[72:75], v[204:207], v[52:55], v[72:75]
    s_waitcnt lgkmcnt(11)
    ds_read_b128 v[52:55], v14 offset:39936
    ds_read_b128 v[200:203], v9 offset:16384
    ds_read_b128 v[204:207], v9 offset:20480
    buffer_load_dwordx4 v[128:131], v5, s[16:19], s73 offen offset:3072 sc1
    v_exp_f32 v80, v80
    v_mfma_f32_16x16x32_bf16 v[68:71], v[208:211], v[56:59], v[68:71]
    v_exp_f32 v81, v81
    v_mfma_f32_16x16x32_bf16 v[72:75], v[212:215], v[56:59], v[72:75]
    s_waitcnt lgkmcnt(11)
    ds_read_b128 v[56:59], v14 offset:40960
    v_exp_f32 v82, v82
    v_exp_f32 v83, v83
    v_mfma_f32_16x16x32_bf16 v[68:71], v[216:219], v[40:43], v[68:71]
    v_add_f32 v80, 1.0, v80
    v_mfma_f32_16x16x32_bf16 v[72:75], v[220:223], v[40:43], v[72:75]
    s_add_u32 s73, s73, 4096
    buffer_load_dwordx4 v[132:135], v5, s[16:19], s73 offen offset:0 sc1
    s_waitcnt lgkmcnt(9)
    v_add_f32 v81, 1.0, v81
    v_add_f32 v82, 1.0, v82
    v_add_f32 v83, 1.0, v83
    v_mfma_f32_16x16x32_bf16 v[68:71], v[224:227], v[44:47], v[68:71]
    v_rcp_f32 v80, v80
    v_mfma_f32_16x16x32_bf16 v[72:75], v[228:231], v[44:47], v[72:75]
    v_rcp_f32 v81, v81
    buffer_load_dwordx4 v[136:139], v5, s[16:19], s73 offen offset:1024 sc1
    s_waitcnt vmcnt(8)
    v_cmp_gt_u32 vcc, 1, v4
    s_cbranch_vccnz L_spin_5045
L_ok_5046:
    s_cmp_eq_u32 s54, 0
    s_cbranch_scc1 L_slow_5048
L_back_5049:
    v_mov_b32 v7, 2
    s_mov_b64 exec, 1
    s_cmp_eq_u32 s54, 0
    s_cbranch_scc1 L_slow_5050
    buffer_store_dword v7, v6, s[16:19], s76 offen
L_back_5051:
    s_mov_b64 exec, -1
    s_waitcnt lgkmcnt(6)
    v_mfma_f32_16x16x32_bf16 v[68:71], v[232:235], v[48:51], v[68:71]
    v_rcp_f32 v82, v82
    v_rcp_f32 v83, v83
    v_mfma_f32_16x16x32_bf16 v[72:75], v[236:239], v[48:51], v[72:75]
    s_waitcnt lgkmcnt(3)
    v_mul_f32 v76, v76, v80
    v_mfma_f32_16x16x32_bf16 v[68:71], v[240:243], v[52:55], v[68:71]
    v_mul_f32 v77, v77, v81
    v_mul_f32 v78, v78, v82
    v_mul_f32 v79, v79, v83
    v_mfma_f32_16x16x32_bf16 v[72:75], v[244:247], v[52:55], v[72:75]
    s_waitcnt lgkmcnt(0)
    buffer_load_dwordx4 v[140:143], v5, s[16:19], s73 offen offset:2048 sc1
    v_cvt_pk_bf16_f32 v86, v76, v77
    v_cvt_pk_bf16_f32 v87, v78, v79
    v_mfma_f32_16x16x32_bf16 v[68:71], v[248:251], v[56:59], v[68:71]
    s_nop 0
    buffer_store_dwordx4 v[84:87], v5, s[16:19], s75 offen nt
    s_add_u32 s75, s75, 6144
    v_mfma_f32_16x16x32_bf16 v[72:75], v[252:255], v[56:59], v[72:75]
    v_mov_b32 v10, 4
    s_mov_b64 exec, 1
    ds_write_b32 v11, v10 offset:16
    s_mov_b64 exec, -1
    buffer_load_dwordx4 v[144:147], v5, s[16:19], s73 offen offset:3072 sc1
    s_add_u32 s73, s73, 4096
.p2align 3
    buffer_load_dwordx4 v[148:151], v5, s[16:19], s73 offen offset:0 sc1
    buffer_load_dwordx4 v[152:155], v5, s[16:19], s73 offen offset:1024 sc1
    v_fma_f32 v76, v32, v95, v24
    v_fma_f32 v77, v33, v95, v25
    v_fma_f32 v78, v34, v95, v26
    v_fma_f32 v79, v35, v95, v27
    v_fmac_f32 v76, v68, v91
    v_fmac_f32 v77, v69, v91
    v_fmac_f32 v78, v70, v91
    v_fmac_f32 v79, v71, v91
    v_mul_f32 v80, v76, v76
    v_mul_f32 v81, v77, v77
    v_mul_f32 v82, v78, v78
    v_mul_f32 v83, v79, v79
    v_fmaak_f32 v80, v3, v80, 0xc0135761
    v_fmaak_f32 v81, v3, v81, 0xc0135761
    v_fmaak_f32 v82, v3, v82, 0xc0135761
    v_fmaak_f32 v83, v3, v83, 0xc0135761
    v_mul_f32 v80, v80, v76
    v_mul_f32 v81, v81, v77
    v_mul_f32 v82, v82, v78
    v_mul_f32 v83, v83, v79
    v_exp_f32 v80, v80
    v_exp_f32 v81, v81
    v_exp_f32 v82, v82
    v_exp_f32 v83, v83
    v_add_f32 v80, 1.0, v80
    v_add_f32 v81, 1.0, v81
    v_add_f32 v82, 1.0, v82
    v_add_f32 v83, 1.0, v83
    v_rcp_f32 v80, v80
    v_rcp_f32 v81, v81
    v_rcp_f32 v82, v82
    v_rcp_f32 v83, v83
    v_mul_f32 v76, v76, v80
    v_mul_f32 v77, v77, v81
    v_mul_f32 v78, v78, v82
    v_mul_f32 v79, v79, v83
.p2align 3
    v_cvt_pk_bf16_f32 v84, v76, v77
    v_cvt_pk_bf16_f32 v85, v78, v79
    v_fma_f32 v76, v36, v95, v28
    v_fma_f32 v77, v37, v95, v29
    v_fma_f32 v78, v38, v95, v30
    v_fma_f32 v79, v39, v95, v31
    v_fmac_f32 v76, v72, v91
    v_fmac_f32 v77, v73, v91
    v_fmac_f32 v78, v74, v91
    v_fmac_f32 v79, v75, v91
    v_mul_f32 v80, v76, v76
    v_mul_f32 v81, v77, v77
    v_mul_f32 v82, v78, v78
    v_mul_f32 v83, v79, v79
    v_fmaak_f32 v80, v3, v80, 0xc0135761
    v_fmaak_f32 v81, v3, v81, 0xc0135761
    v_fmaak_f32 v82, v3, v82, 0xc0135761
    v_fmaak_f32 v83, v3, v83, 0xc0135761
    v_mul_f32 v80, v80, v76
    v_mul_f32 v81, v81, v77
    v_mul_f32 v82, v82, v78
    v_mul_f32 v83, v83, v79
    v_exp_f32 v80, v80
    v_exp_f32 v81, v81
    v_exp_f32 v82, v82
    v_exp_f32 v83, v83
    v_add_f32 v80, 1.0, v80
    v_add_f32 v81, 1.0, v81
    v_add_f32 v82, 1.0, v82
    v_add_f32 v83, 1.0, v83
    v_rcp_f32 v80, v80
    v_rcp_f32 v81, v81
    v_rcp_f32 v82, v82
    v_rcp_f32 v83, v83
    v_mul_f32 v76, v76, v80
    v_mul_f32 v77, v77, v81
    v_mul_f32 v78, v78, v82
    v_mul_f32 v79, v79, v83
    v_cvt_pk_bf16_f32 v86, v76, v77
    v_cvt_pk_bf16_f32 v87, v78, v79
    buffer_load_dword v4, v0, s[16:19], s77 offen sc1
    buffer_store_dwordx4 v[84:87], v5, s[16:19], s75 offen nt
    s_add_u32 s75, s75, 6144
    s_waitcnt vmcnt(0)
    v_mov_b32 v7, 4
    s_mov_b64 exec, 1
    s_cmp_eq_u32 s54, 0
    s_cbranch_scc1 L_slow_5052
    buffer_store_dword v7, v6, s[16:19], s76 offen
L_back_5053:
    s_mov_b64 exec, -1
    v_cmp_gt_u32 vcc, 2, v4
    s_cbranch_vccnz L_spin_5054
L_ok_5055:
    s_cmp_eq_u32 s54, 0
    s_cbranch_scc1 L_slow_5057
L_back_5058:
    s_waitcnt lgkmcnt(0)
    v_add_u32 v80, 40960, v2
    v_and_b32 v85, 15, v1
    v_mul_u32_u24 v85, 160, v85
    s_mul_i32 s49, s3, 5120
    s_add_u32 s49, s49, 0
    v_add_u32 v85, s49, v85
    v_lshrrev_b32 v86, 4, v1
    v_mul_u32_u24 v86, 5, v86
    v_and_b32 v81, 1, v86
    v_mul_u32_u24 v81, 2552, v81
    v_lshl_add_u32 v81, v86, 3, v81
    v_add_u32 v81, v81, v85
    v_add_u32 v86, 1, v86
    v_and_b32 v83, 1, v86
    v_mul_u32_u24 v83, 2552, v83
    v_lshl_add_u32 v83, v86, 3, v83
    v_add_u32 v83, v83, v85
    v_add_u32 v82, 40960, v81
    v_add_u32 v84, 40960, v83
    v_mul_u32_u24 v85, 6554, v1
    v_lshrrev_b32 v85, 16, v85
    v_mul_u32_u24 v85, 1120, v85
    v_lshl_add_u32 v93, v1, 4, v85
    s_mul_i32 s49, s3, 640
    v_lshl_add_u32 v92, v1, 4, s49
    v_add_u32 v94, 141312, v92
    v_add_u32 v95, 40960, v92
    s_add_u32 s80, s74, 0
    buffer_load_dwordx4 v[208:211], v5, s[16:19], s80 offen offset:0 sc1
    buffer_load_dwordx4 v[212:215], v5, s[16:19], s80 offen offset:1024 sc1
    buffer_load_dwordx4 v[216:219], v5, s[16:19], s80 offen offset:2048 sc1
    buffer_load_dwordx4 v[220:223], v5, s[16:19], s80 offen offset:3072 sc1
    s_add_u32 s80, s74, 4096
    buffer_load_dwordx4 v[224:227], v5, s[16:19], s80 offen offset:0 sc1
    buffer_load_dwordx4 v[228:231], v5, s[16:19], s80 offen offset:1024 sc1
    s_add_u32 s80, s74, 6144
    buffer_load_dwordx4 v[232:235], v5, s[16:19], s80 offen offset:0 sc1
    buffer_load_dwordx4 v[236:239], v5, s[16:19], s80 offen offset:1024 sc1
    buffer_load_dwordx4 v[240:243], v5, s[16:19], s80 offen offset:2048 sc1
    buffer_load_dwordx4 v[244:247], v5, s[16:19], s80 offen offset:3072 sc1
    s_setprio 1
    s_mov_b32 s7, 4194304
L_lsp_5059:
    ds_read_b32 v3, v11 offset:0
    s_sub_u32 s7, s7, 1
    s_waitcnt lgkmcnt(0)
    s_cbranch_scc1 L_lok_5060
    v_cmp_gt_u32 vcc, 7, v3
    s_cbranch_vccz L_lok_5060
    s_sleep 1
    s_branch L_lsp_5059
L_lok_5060:
    ds_read_b128 v[40:43], v2 offset:0
    ds_read_b128 v[44:47], v2 offset:1024
    ds_read_b128 v[48:51], v2 offset:2048
    ds_read_b128 v[52:55], v2 offset:3072
    ds_read_b128 v[56:59], v2 offset:4096
    s_waitcnt vmcnt(9)
    s_waitcnt lgkmcnt(4)
    v_mfma_f32_16x16x32_bf16 v[40:43], v[156:159], v[208:211], v[40:43]
    s_waitcnt lgkmcnt(3)
    v_mfma_f32_16x16x32_bf16 v[44:47], v[160:163], v[208:211], v[44:47]
    s_waitcnt lgkmcnt(2)
    v_mfma_f32_16x16x32_bf16 v[48:51], v[164:167], v[208:211], v[48:51]
    s_waitcnt lgkmcnt(1)
    v_mfma_f32_16x16x32_bf16 v[52:55], v[168:171], v[208:211], v[52:55]
    s_waitcnt lgkmcnt(0)
    v_mfma_f32_16x16x32_bf16 v[56:59], v[172:175], v[208:211], v[56:59]
    s_add_u32 s80, s74, 10240
    buffer_load_dwordx4 v[248:251], v5, s[16:19], s80 offen offset:0 sc1
    s_waitcnt vmcnt(9)
    v_mfma_f32_16x16x32_bf16 v[40:43], v[176:179], v[212:215], v[40:43]
    v_mfma_f32_16x16x32_bf16 v[44:47], v[180:183], v[212:215], v[44:47]
    v_mfma_f32_16x16x32_bf16 v[48:51], v[184:187], v[212:215], v[48:51]
    v_mfma_f32_16x16x32_bf16 v[52:55], v[188:191], v[212:215], v[52:55]
    v_mfma_f32_16x16x32_bf16 v[56:59], v[192:195], v[212:215], v[56:59]
    s_waitcnt vmcnt(8)
    buffer_load_dwordx4 v[252:255], v5, s[16:19], s80 offen offset:1024 sc1
    v_mfma_f32_16x16x32_bf16 v[40:43], v[196:199], v[216:219], v[40:43]
    v_mfma_f32_16x16x32_bf16 v[44:47], v[200:203], v[216:219], v[44:47]
    v_mfma_f32_16x16x32_bf16 v[48:51], v[204:207], v[216:219], v[48:51]
    v_mfma_f32_16x16x32_bf16 v[52:55], v[16:19], v[216:219], v[52:55]
    v_mfma_f32_16x16x32_bf16 v[56:59], v[20:23], v[216:219], v[56:59]
    s_waitcnt vmcnt(8)
    ds_read_b32 v3, v11 offset:0
    v_mfma_f32_16x16x32_bf16 v[40:43], v[96:99], v[220:223], v[40:43]
    v_mfma_f32_16x16x32_bf16 v[44:47], v[100:103], v[220:223], v[44:47]
    v_mfma_f32_16x16x32_bf16 v[48:51], v[104:107], v[220:223], v[48:51]
    v_mfma_f32_16x16x32_bf16 v[52:55], v[108:111], v[220:223], v[52:55]
    s_waitcnt lgkmcnt(0)
    v_cmp_gt_u32 vcc, 8, v3
    s_cbranch_vccnz L_lsp_5061
L_lok_5062:
    ds_read_b128 v[60:63], v2 offset:20480
    v_mfma_f32_16x16x32_bf16 v[56:59], v[112:115], v[220:223], v[56:59]
    s_waitcnt vmcnt(7)
    ds_read_b128 v[64:67], v2 offset:21504
    buffer_load_dword v4, v0, s[16:19], s77 offen sc1
    v_mfma_f32_16x16x32_bf16 v[40:43], v[116:119], v[224:227], v[40:43]
    ds_read_b128 v[68:71], v2 offset:22528
    v_mfma_f32_16x16x32_bf16 v[44:47], v[120:123], v[224:227], v[44:47]
    ds_read_b128 v[72:75], v2 offset:23552
    v_mfma_f32_16x16x32_bf16 v[48:51], v[124:127], v[224:227], v[48:51]
    ds_read_b128 v[76:79], v2 offset:24576
    v_mfma_f32_16x16x32_bf16 v[52:55], v[128:131], v[224:227], v[52:55]
    v_mfma_f32_16x16x32_bf16 v[56:59], v[132:135], v[224:227], v[56:59]
    s_waitcnt vmcnt(7)
    v_mfma_f32_16x16x32_bf16 v[40:43], v[136:139], v[228:231], v[40:43]
    v_mfma_f32_16x16x32_bf16 v[44:47], v[140:143], v[228:231], v[44:47]
    v_mfma_f32_16x16x32_bf16 v[48:51], v[144:147], v[228:231], v[48:51]
    v_mfma_f32_16x16x32_bf16 v[52:55], v[148:151], v[228:231], v[52:55]
    v_mfma_f32_16x16x32_bf16 v[56:59], v[152:155], v[228:231], v[56:59]
    s_waitcnt vmcnt(6)
    s_waitcnt lgkmcnt(4)
    v_mfma_f32_16x16x32_bf16 v[60:63], v[156:159], v[232:235], v[60:63]
    s_waitcnt vmcnt(5)
    v_mfma_f32_16x16x32_bf16 v[60:63], v[176:179], v[236:239], v[60:63]
    s_waitcnt vmcnt(4)
    v_mfma_f32_16x16x32_bf16 v[60:63], v[196:199], v[240:243], v[60:63]
    s_waitcnt vmcnt(3)
    ds_write_b128 v81, v[40:43] offset:0
    v_mfma_f32_16x16x32_bf16 v[60:63], v[96:99], v[244:247], v[60:63]
    s_waitcnt vmcnt(2)
    v_mfma_f32_16x16x32_bf16 v[60:63], v[116:119], v[248:251], v[60:63]
    s_waitcnt vmcnt(1)
    v_mfma_f32_16x16x32_bf16 v[60:63], v[136:139], v[252:255], v[60:63]
    s_waitcnt lgkmcnt(4)
    v_mfma_f32_16x16x32_bf16 v[64:67], v[160:163], v[232:235], v[64:67]
    ds_write_b128 v83, v[44:47] offset:0
    v_mfma_f32_16x16x32_bf16 v[64:67], v[180:183], v[236:239], v[64:67]
    v_mfma_f32_16x16x32_bf16 v[64:67], v[200:203], v[240:243], v[64:67]
    v_mfma_f32_16x16x32_bf16 v[64:67], v[100:103], v[244:247], v[64:67]
    s_waitcnt vmcnt(0)
    v_cmp_gt_u32 vcc, 4, v4
    s_cbranch_vccnz L_spin_5063
L_ok_5064:
    s_cmp_eq_u32 s54, 0
    s_cbranch_scc1 L_slow_5066
L_back_5067:
    s_add_u32 s80, s74, 12288
    buffer_load_dwordx4 v[208:211], v5, s[16:19], s80 offen offset:0 sc1
    buffer_load_dwordx4 v[212:215], v5, s[16:19], s80 offen offset:1024 sc1
    buffer_load_dwordx4 v[216:219], v5, s[16:19], s80 offen offset:2048 sc1
    buffer_load_dwordx4 v[220:223], v5, s[16:19], s80 offen offset:3072 sc1
    s_add_u32 s80, s74, 16384
    buffer_load_dwordx4 v[224:227], v5, s[16:19], s80 offen offset:0 sc1
    buffer_load_dwordx4 v[228:231], v5, s[16:19], s80 offen offset:1024 sc1
    v_mfma_f32_16x16x32_bf16 v[64:67], v[120:123], v[248:251], v[64:67]
    s_nop 0
    ds_write_b128 v81, v[48:51] offset:16
    ds_write_b128 v81, v[60:63] offset:20480
    v_mfma_f32_16x16x32_bf16 v[64:67], v[140:143], v[252:255], v[64:67]
    s_waitcnt lgkmcnt(6)
    v_mfma_f32_16x16x32_bf16 v[68:71], v[164:167], v[232:235], v[68:71]
    v_mfma_f32_16x16x32_bf16 v[68:71], v[184:187], v[236:239], v[68:71]
    v_mfma_f32_16x16x32_bf16 v[68:71], v[204:207], v[240:243], v[68:71]
    ds_write_b128 v83, v[52:55] offset:16
    v_mfma_f32_16x16x32_bf16 v[68:71], v[104:107], v[244:247], v[68:71]
    v_mfma_f32_16x16x32_bf16 v[68:71], v[124:127], v[248:251], v[68:71]
s_nop 0
    ds_write_b128 v83, v[64:67] offset:20480
    v_mfma_f32_16x16x32_bf16 v[68:71], v[144:147], v[252:255], v[68:71]
    s_waitcnt lgkmcnt(7)
    v_mfma_f32_16x16x32_bf16 v[72:75], v[168:171], v[232:235], v[72:75]
    ds_write_b128 v81, v[56:59] offset:32
    v_mfma_f32_16x16x32_bf16 v[72:75], v[188:191], v[236:239], v[72:75]
    v_mov_b32 v10, 5
    s_mov_b64 exec, 1
    ds_write_b32 v11, v10 offset:16
    s_mov_b64 exec, -1
    v_mfma_f32_16x16x32_bf16 v[72:75], v[16:19], v[240:243], v[72:75]
    v_mfma_f32_16x16x32_bf16 v[72:75], v[108:111], v[244:247], v[72:75]
    v_mfma_f32_16x16x32_bf16 v[72:75], v[128:131], v[248:251], v[72:75]
    ds_write_b128 v81, v[68:71] offset:20496
    v_mfma_f32_16x16x32_bf16 v[72:75], v[148:151], v[252:255], v[72:75]
    s_waitcnt lgkmcnt(9)
    ds_read_b32 v3, v11 offset:0
    v_mfma_f32_16x16x32_bf16 v[76:79], v[172:175], v[232:235], v[76:79]
    s_add_u32 s80, s74, 18432
    buffer_load_dwordx4 v[232:235], v5, s[16:19], s80 offen offset:0 sc1
    v_mfma_f32_16x16x32_bf16 v[76:79], v[192:195], v[236:239], v[76:79]
    buffer_load_dwordx4 v[236:239], v5, s[16:19], s80 offen offset:1024 sc1
    v_mfma_f32_16x16x32_bf16 v[76:79], v[20:23], v[240:243], v[76:79]
    buffer_load_dwordx4 v[240:243], v5, s[16:19], s80 offen offset:2048 sc1
    v_mfma_f32_16x16x32_bf16 v[76:79], v[112:115], v[244:247], v[76:79]
    s_waitcnt lgkmcnt(0)
    v_cmp_gt_u32 vcc, 9, v3
    s_cbranch_vccnz L_lsp_5068
L_lok_5069:
    ds_read_b128 v[32:35], v80 offset:0
    v_mfma_f32_16x16x32_bf16 v[76:79], v[132:135], v[248:251], v[76:79]
    s_nop 0
    ds_write_b128 v83, v[72:75] offset:20496
    ds_read_b128 v[36:39], v80 offset:1024
    v_mfma_f32_16x16x32_bf16 v[76:79], v[152:155], v[252:255], v[76:79]
    s_waitcnt vmcnt(8)
    ds_read_b128 v[24:27], v80 offset:2048
    ds_read_b128 v[28:31], v80 offset:3072
    ds_read_b128 v[88:91], v80 offset:4096
    buffer_load_dwordx4 v[244:247], v5, s[16:19], s80 offen offset:3072 sc1
    s_waitcnt lgkmcnt(5)
    v_mfma_f32_16x16x32_bf16 v[32:35], v[156:159], v[208:211], v[32:35]
    s_waitcnt vmcnt(8)
    v_mfma_f32_16x16x32_bf16 v[32:35], v[176:179], v[212:215], v[32:35]
    s_waitcnt vmcnt(7)
    v_mfma_f32_16x16x32_bf16 v[32:35], v[196:199], v[216:219], v[32:35]
    s_waitcnt vmcnt(6)
    v_mfma_f32_16x16x32_bf16 v[32:35], v[96:99], v[220:223], v[32:35]
    s_waitcnt vmcnt(5)
    v_mfma_f32_16x16x32_bf16 v[32:35], v[116:119], v[224:227], v[32:35]
    s_waitcnt vmcnt(4)
    ds_write_b128 v81, v[76:79] offset:20512
    s_add_u32 s80, s74, 22528
    buffer_load_dwordx4 v[248:251], v5, s[16:19], s80 offen offset:0 sc1
    v_mfma_f32_16x16x32_bf16 v[32:35], v[136:139], v[228:231], v[32:35]
    v_mov_b32 v10, 6
    s_mov_b64 exec, 1
    ds_write_b32 v11, v10 offset:16
    s_mov_b64 exec, -1
    s_waitcnt lgkmcnt(5)
    v_mfma_f32_16x16x32_bf16 v[36:39], v[160:163], v[208:211], v[36:39]
    v_mfma_f32_16x16x32_bf16 v[36:39], v[180:183], v[212:215], v[36:39]
    v_mfma_f32_16x16x32_bf16 v[36:39], v[200:203], v[216:219], v[36:39]
    v_mfma_f32_16x16x32_bf16 v[36:39], v[100:103], v[220:223], v[36:39]
    buffer_load_dwordx4 v[252:255], v5, s[16:19], s80 offen offset:1024 sc1
    v_mfma_f32_16x16x32_bf16 v[36:39], v[120:123], v[224:227], v[36:39]
    ds_write_b128 v82, v[32:35] offset:0
    v_mfma_f32_16x16x32_bf16 v[36:39], v[140:143], v[228:231], v[36:39]
    s_waitcnt lgkmcnt(5)
    v_mfma_f32_16x16x32_bf16 v[24:27], v[164:167], v[208:211], v[24:27]
    v_mfma_f32_16x16x32_bf16 v[24:27], v[184:187], v[212:215], v[24:27]
    v_mfma_f32_16x16x32_bf16 v[24:27], v[204:207], v[216:219], v[24:27]
    v_mfma_f32_16x16x32_bf16 v[24:27], v[104:107], v[220:223], v[24:27]
    v_mfma_f32_16x16x32_bf16 v[24:27], v[124:127], v[224:227], v[24:27]
s_nop 1
    ds_write_b128 v84, v[36:39] offset:0
    v_mfma_f32_16x16x32_bf16 v[24:27], v[144:147], v[228:231], v[24:27]
    s_waitcnt lgkmcnt(5)
    v_mfma_f32_16x16x32_bf16 v[28:31], v[168:171], v[208:211], v[28:31]
    v_mfma_f32_16x16x32_bf16 v[28:31], v[188:191], v[212:215], v[28:31]
    v_mfma_f32_16x16x32_bf16 v[28:31], v[16:19], v[216:219], v[28:31]
    v_mfma_f32_16x16x32_bf16 v[28:31], v[108:111], v[220:223], v[28:31]
    v_mfma_f32_16x16x32_bf16 v[28:31], v[128:131], v[224:227], v[28:31]
s_nop 1
    ds_write_b128 v82, v[24:27] offset:16
    v_mfma_f32_16x16x32_bf16 v[28:31], v[148:151], v[228:231], v[28:31]
    s_waitcnt lgkmcnt(5)
    ds_read_b32 v3, v11 offset:0
    v_mfma_f32_16x16x32_bf16 v[88:91], v[172:175], v[208:211], v[88:91]
    v_mfma_f32_16x16x32_bf16 v[88:91], v[192:195], v[212:215], v[88:91]
    v_mfma_f32_16x16x32_bf16 v[88:91], v[20:23], v[216:219], v[88:91]
    v_mfma_f32_16x16x32_bf16 v[88:91], v[112:115], v[220:223], v[88:91]
    s_waitcnt lgkmcnt(0)
    v_cmp_gt_u32 vcc, 10, v3
    s_cbranch_vccnz L_lsp_5070
L_lok_5071:
    ds_read_b128 v[40:43], v80 offset:20480
    v_mfma_f32_16x16x32_bf16 v[88:91], v[132:135], v[224:227], v[88:91]
    s_nop 0
    ds_write_b128 v84, v[28:31] offset:16
    ds_read_b128 v[44:47], v80 offset:21504
    v_mfma_f32_16x16x32_bf16 v[88:91], v[152:155], v[228:231], v[88:91]
    s_waitcnt vmcnt(5)
    ds_read_b128 v[48:51], v80 offset:22528
    ds_read_b128 v[52:55], v80 offset:23552
    ds_read_b128 v[56:59], v80 offset:24576
    s_waitcnt lgkmcnt(5)
    v_mfma_f32_16x16x32_bf16 v[40:43], v[156:159], v[232:235], v[40:43]
    s_waitcnt vmcnt(4)
    v_mfma_f32_16x16x32_bf16 v[40:43], v[176:179], v[236:239], v[40:43]
    s_waitcnt vmcnt(3)
    v_mfma_f32_16x16x32_bf16 v[40:43], v[196:199], v[240:243], v[40:43]
    s_waitcnt vmcnt(2)
    v_mfma_f32_16x16x32_bf16 v[40:43], v[96:99], v[244:247], v[40:43]
    s_waitcnt vmcnt(1)
    v_mfma_f32_16x16x32_bf16 v[40:43], v[116:119], v[248:251], v[40:43]
    s_waitcnt vmcnt(0)
    ds_write_b128 v82, v[88:91] offset:32
    v_mfma_f32_16x16x32_bf16 v[40:43], v[136:139], v[252:255], v[40:43]
    v_mov_b32 v10, 7
    s_mov_b64 exec, 1
    ds_write_b32 v11, v10 offset:16
    s_mov_b64 exec, -1
    s_waitcnt lgkmcnt(5)
    v_mfma_f32_16x16x32_bf16 v[44:47], v[160:163], v[232:235], v[44:47]
    v_mfma_f32_16x16x32_bf16 v[44:47], v[180:183], v[236:239], v[44:47]
    v_mfma_f32_16x16x32_bf16 v[44:47], v[200:203], v[240:243], v[44:47]
    v_mfma_f32_16x16x32_bf16 v[44:47], v[100:103], v[244:247], v[44:47]
    v_mfma_f32_16x16x32_bf16 v[44:47], v[120:123], v[248:251], v[44:47]
    ds_write_b128 v82, v[40:43] offset:20480
    v_mfma_f32_16x16x32_bf16 v[44:47], v[140:143], v[252:255], v[44:47]
    s_waitcnt lgkmcnt(5)
    v_mfma_f32_16x16x32_bf16 v[48:51], v[164:167], v[232:235], v[48:51]
    v_mfma_f32_16x16x32_bf16 v[48:51], v[184:187], v[236:239], v[48:51]
    v_mfma_f32_16x16x32_bf16 v[48:51], v[204:207], v[240:243], v[48:51]
    v_mfma_f32_16x16x32_bf16 v[48:51], v[104:107], v[244:247], v[48:51]
    v_mfma_f32_16x16x32_bf16 v[48:51], v[124:127], v[248:251], v[48:51]
s_nop 1
    ds_write_b128 v84, v[44:47] offset:20480
    v_mfma_f32_16x16x32_bf16 v[48:51], v[144:147], v[252:255], v[48:51]
    s_waitcnt lgkmcnt(5)
    v_mfma_f32_16x16x32_bf16 v[52:55], v[168:171], v[232:235], v[52:55]
    v_mfma_f32_16x16x32_bf16 v[52:55], v[188:191], v[236:239], v[52:55]
    v_mfma_f32_16x16x32_bf16 v[52:55], v[16:19], v[240:243], v[52:55]
    v_mfma_f32_16x16x32_bf16 v[52:55], v[108:111], v[244:247], v[52:55]
    v_mfma_f32_16x16x32_bf16 v[52:55], v[128:131], v[248:251], v[52:55]
s_nop 1
    ds_write_b128 v82, v[48:51] offset:20496
    v_mfma_f32_16x16x32_bf16 v[52:55], v[148:151], v[252:255], v[52:55]
    s_waitcnt lgkmcnt(5)
    v_mfma_f32_16x16x32_bf16 v[56:59], v[172:175], v[232:235], v[56:59]
    v_mfma_f32_16x16x32_bf16 v[56:59], v[192:195], v[236:239], v[56:59]
    v_mfma_f32_16x16x32_bf16 v[56:59], v[20:23], v[240:243], v[56:59]
    v_mfma_f32_16x16x32_bf16 v[56:59], v[112:115], v[244:247], v[56:59]
    v_mfma_f32_16x16x32_bf16 v[56:59], v[132:135], v[248:251], v[56:59]
s_nop 1
    ds_write_b128 v84, v[52:55] offset:20496
    v_mfma_f32_16x16x32_bf16 v[56:59], v[152:155], v[252:255], v[56:59]
    s_nop 0
s_nop 6
    ds_write_b128 v82, v[56:59] offset:20512
    v_mov_b32 v10, 8
    s_mov_b64 exec, 1
    ds_write_b32 v11, v10 offset:16
    s_mov_b64 exec, -1
    ds_read_b128 v[96:99], v94 offset:15360
    ds_read_b128 v[100:103], v94 offset:17920
    s_mov_b32 s7, 4194304
L_lsp_5072:
    ds_read_b32 v3, v12 offset:16
    s_sub_u32 s7, s7, 1
    s_waitcnt lgkmcnt(0)
    s_cbranch_scc1 L_lok_5073
    v_cmp_gt_u32 vcc, 8, v3
    s_cbranch_vccnz L_lsp_5072
L_lok_5073:
.p2align 3
    ds_read_b128 v[104:107], v95 offset:20480
    ds_read_b128 v[108:111], v95 offset:23040
    ds_read_b128 v[112:115], v95 offset:25600
    ds_read_b128 v[116:119], v95 offset:28160
    ds_read_b128 v[120:123], v95 offset:30720
    ds_read_b128 v[124:127], v95 offset:33280
    ds_read_b128 v[128:131], v95 offset:35840
    ds_read_b128 v[132:135], v95 offset:38400
    s_add_u32 s78, s78, 61440
    s_waitcnt lgkmcnt(6)
    v_pk_add_f32 v[96:97], v[96:97], v[104:105]
    v_pk_add_f32 v[98:99], v[98:99], v[106:107]
    v_pk_add_f32 v[100:101], v[100:101], v[108:109]
    v_pk_add_f32 v[102:103], v[102:103], v[110:111]
    s_waitcnt lgkmcnt(4)
    v_pk_add_f32 v[96:97], v[96:97], v[112:113]
    v_pk_add_f32 v[98:99], v[98:99], v[114:115]
    v_pk_add_f32 v[100:101], v[100:101], v[116:117]
    v_pk_add_f32 v[102:103], v[102:103], v[118:119]
    s_waitcnt lgkmcnt(2)
    v_pk_add_f32 v[96:97], v[96:97], v[120:121]
    v_pk_add_f32 v[98:99], v[98:99], v[122:123]
    v_pk_add_f32 v[100:101], v[100:101], v[124:125]
    v_pk_add_f32 v[102:103], v[102:103], v[126:127]
    s_waitcnt lgkmcnt(0)
.p2align 3
    v_pk_add_f32 v[96:97], v[96:97], v[128:129]
    v_pk_add_f32 v[98:99], v[98:99], v[130:131]
    v_pk_add_f32 v[100:101], v[100:101], v[132:133]
    v_pk_add_f32 v[102:103], v[102:103], v[134:135]
    v_cvt_pk_bf16_f32 v104, v96, v97
    v_cvt_pk_bf16_f32 v105, v98, v99
    v_cvt_pk_bf16_f32 v106, v100, v101
    v_cvt_pk_bf16_f32 v107, v102, v103
    s_mov_b32 exec_hi, 0xff
    buffer_store_dwordx4 v[104:107], v93, s[20:23], s78 offen nt
    s_mov_b32 exec_hi, -1
    s_endpgm
.p2align 6
L_roleA:
    v_and_b32 v3, 15, v1
    v_lshrrev_b32 v4, 4, v1
    s_lshr_b32 s6, s2, 6
    s_bfe_u32 s4, s2, 0x30003
    s_and_b32 s7, s2, 7
    s_lshl2_add_u32 s5, s7, s6
    s_add_u32 s49, s6, s4
    s_add_u32 s7, s7, s49
    s_mul_i32 s50, s7, 52
    s_lshr_b32 s50, s50, 8
    s_mul_i32 s50, s50, 5
    s_sub_u32 s44, s7, s50
    s_add_u32 s45, s44, 1
    s_cmp_eq_u32 s45, 5
    s_cselect_b32 s45, 0, s45
    s_add_u32 s46, s45, 1
    s_cmp_eq_u32 s46, 5
    s_cselect_b32 s46, 0, s46
    s_add_u32 s47, s46, 1
    s_cmp_eq_u32 s47, 5
    s_cselect_b32 s47, 0, s47
    s_add_u32 s48, s47, 1
    s_cmp_eq_u32 s48, 5
    s_cselect_b32 s48, 0, s48
    v_lshlrev_b32 v5, 4, v1
    v_mov_b32 v6, 0
    s_mov_b32 s55, 0xffff0000
    s_mul_i32 s62, s3, 20480
    v_xor_b32 v9, v3, v4
    v_xor_b32 v10, 0, v9
    v_lshlrev_b32 v10, 4, v10
    v_lshl_add_u32 v10, v3, 8, v10
    v_add_u32 v128, s62, v10
    v_xor_b32 v10, 4, v9
    v_lshlrev_b32 v10, 4, v10
    v_lshl_add_u32 v10, v3, 8, v10
    v_add_u32 v129, s62, v10
    v_xor_b32 v10, 8, v9
    v_lshlrev_b32 v10, 4, v10
    v_lshl_add_u32 v10, v3, 8, v10
    v_add_u32 v130, s62, v10
    v_xor_b32 v10, 12, v9
    v_lshlrev_b32 v10, 4, v10
    v_lshl_add_u32 v10, v3, 8, v10
    v_add_u32 v131, s62, v10
    v_mov_b32 v132, 0
    v_mov_b32 v133, 0
    v_mov_b32 v134, 0
    v_mov_b32 v135, 0
    v_mov_b32 v2, 0x3f803f80
    v_lshrrev_b32 v7, 2, v1
    v_mul_u32_u24 v7, 160, v7
    v_and_b32 v8, 3, v1
    v_mul_u32_u24 v8, 40, v8
    v_add_u32 v7, v7, v8
    v_add_u32 v24, 56320, v7
    v_add_u32 v25, 117760, v7
    v_add_u32 v26, 56320, v5
    v_add_u32 v27, 117760, v5
    v_and_b32 v8, 3, v1
    v_lshlrev_b32 v8, 2, v8
    v_add_u32 v12, 162816, v8
    s_lshl_b32 s49, s3, 2
    s_add_u32 s49, s49, 162816
    v_mov_b32 v11, s49
    s_mov_b64 exec, 1
    ds_write_b32 v11, v6 offset:0
    ds_write_b32 v11, v6 offset:16
    ds_write_b32 v11, v6 offset:32
    s_mov_b64 exec, -1
    v_mul_u32_u24 v7, 800, v4
    v_bfe_u32 v8, v1, 2, 2
    v_mul_u32_u24 v8, 40, v8
    v_add_u32 v7, v7, v8
    v_and_b32 v8, 3, v1
    v_lshl_add_u32 v28, v8, 3, v7
    s_lshl_b32 s49, s3, 4
    v_add_u32 v7, s49, v3
    v_mul_u32_u24 v8, 336, v7
    v_mul_u32_u24 v10, 80, v4
    v_add_u32 v29, v8, v10
    v_mul_u32_u24 v8, 208, v7
    v_mul_u32_u24 v10, 48, v4
    v_add_u32 v30, v8, v10
    v_lshrrev_b32 v7, 2, v1
    v_and_b32 v8, 3, v1
    s_mul_i32 s49, s3, 80
    s_mul_i32 s50, s3, 48
    v_mul_u32_u24 v10, 336, v7
    v_add_u32 v10, s49, v10
    v_lshl_add_u32 v31, v8, 4, v10
    v_lshl_add_u32 v32, v8, 3, v10
    v_mul_u32_u24 v10, 208, v7
    v_add_u32 v10, s50, v10
    v_lshl_add_u32 v33, v8, 3, v10
    v_mul_u32_u24 v7, 80, v3
    v_mul_u32_u24 v8, 2048, v4
    v_add_u32 v7, v7, v8
    v_add_u32 v41, 102400, v7
    s_mul_i32 s49, s3, 3072
    s_add_u32 s49, s49, 40960
    v_mul_u32_u24 v7, 80, v3
    v_add_u32 v7, s49, v7
    v_lshl_add_u32 v34, v4, 4, v7
    v_lshl_add_u32 v35, v4, 3, v7
    v_mul_u32_u24 v7, 240, v4
    v_min_u32 v8, 14, v3
    v_lshl_add_u32 v7, v8, 4, v7
    v_add_u32 v38, s49, v7
    v_lshlrev_b32 v7, 4, v3
    v_mul_u32_u24 v8, 196608, v4
    v_add_u32 v39, v7, v8
    v_mul_u32_u24 v8, 240, v4
    s_mul_i32 s49, s3, 2048
    s_add_u32 s49, s49, 102400
    v_add3_u32 v42, v7, v8, s49
    v_mul_u32_u24 v13, 40, v4
    v_mul_u32_u24 v40, 24, v4
    s_mul_i32 s49, s4, 160
    s_sub_u32 s50, 5, s44
    v_lshl_add_u32 v9, v3, 8, s62
    v_add3_u32 v7, v13, 0, s49
    v_lshrrev_b32 v8, 8, v7
    v_add_u32 v8, s50, v8
    v_subrev_u32 v10, 5, v8
    v_min_u32 v8, v8, v10
    v_lshl_add_u32 v8, v8, 12, v9
    v_bfe_u32 v10, v7, 4, 4
    v_xor_b32 v10, v10, v3
    v_lshl_add_u32 v8, v10, 4, v8
    v_and_b32 v7, 8, v7
    v_add_u32 v14, v7, v8
    v_add3_u32 v7, v13, 8, s49
    v_lshrrev_b32 v8, 8, v7
    v_add_u32 v8, s50, v8
    v_subrev_u32 v10, 5, v8
    v_min_u32 v8, v8, v10
    v_lshl_add_u32 v8, v8, 12, v9
    v_bfe_u32 v10, v7, 4, 4
    v_xor_b32 v10, v10, v3
    v_lshl_add_u32 v8, v10, 4, v8
    v_and_b32 v7, 8, v7
    v_add_u32 v16, v7, v8
    v_add3_u32 v7, v13, 16, s49
    v_lshrrev_b32 v8, 8, v7
    v_add_u32 v8, s50, v8
    v_subrev_u32 v10, 5, v8
    v_min_u32 v8, v8, v10
    v_lshl_add_u32 v8, v8, 12, v9
    v_bfe_u32 v10, v7, 4, 4
    v_xor_b32 v10, v10, v3
    v_lshl_add_u32 v8, v10, 4, v8
    v_and_b32 v7, 8, v7
    v_add_u32 v18, v7, v8
    v_add3_u32 v7, v13, 24, s49
    v_lshrrev_b32 v8, 8, v7
    v_add_u32 v8, s50, v8
    v_subrev_u32 v10, 5, v8
    v_min_u32 v8, v8, v10
    v_lshl_add_u32 v8, v8, 12, v9
    v_bfe_u32 v10, v7, 4, 4
    v_xor_b32 v10, v10, v3
    v_lshl_add_u32 v8, v10, 4, v8
    v_and_b32 v7, 8, v7
    v_add_u32 v20, v7, v8
    v_add3_u32 v7, v13, 32, s49
    v_lshrrev_b32 v8, 8, v7
    v_add_u32 v8, s50, v8
    v_subrev_u32 v10, 5, v8
    v_min_u32 v8, v8, v10
    v_lshl_add_u32 v8, v8, 12, v9
    v_bfe_u32 v10, v7, 4, 4
    v_xor_b32 v10, v10, v3
    v_lshl_add_u32 v8, v10, 4, v8
    v_and_b32 v7, 8, v7
    v_add_u32 v22, v7, v8
    v_and_b32 v8, 7, v1
    v_lshlrev_b32 v44, 2, v8
    s_mul_i32 s49, s3, 5120
    s_add_u32 s49, s49, 0
    v_lshl_add_u32 v45, v1, 4, s49
    v_mul_u32_u24 v7, 21504, v4
    v_lshl_add_u32 v46, v3, 3, v7
    v_mul_u32_u24 v7, 6554, v1
    v_lshrrev_b32 v7, 16, v7
    v_mul_u32_u24 v7, 1120, v7
    v_lshl_add_u32 v49, v1, 4, v7
    s_mul_i32 s49, s3, 640
    v_lshl_add_u32 v48, v1, 4, s49
    s_waitcnt lgkmcnt(0)
    s_mov_b32 s32, s76
    s_mov_b32 s33, s77
    s_mov_b32 s34, 3072
    s_mov_b32 s35, 0x20000
    s_mov_b32 s36, s80
    s_mov_b32 s37, s81
    s_mov_b32 s38, 1280
    s_mov_b32 s39, 0x20000
    s_mov_b32 s28, s68
    s_mov_b32 s29, s69
    s_mov_b32 s30, 25600
    s_mov_b32 s31, 0x20000
    s_cmp_lg_u32 s3, 0
    s_cbranch_scc1 L_wm_1
    v_lshlrev_b32 v7, 7, v1
    s_mul_i32 s49, s4, 384
    s_mul_i32 s50, s4, 160
    s_mul_i32 s51, s4, 3200
    s_mov_b64 exec, 7
    buffer_load_dword v43, v7, s[32:35], s49 offen
    buffer_load_dword v43, v7, s[36:39], s50 offen
    s_mov_b64 exec, 0x1ffffff
    buffer_load_dword v43, v7, s[28:31], s51 offen
    s_mov_b64 exec, -1
L_wm_1:
    s_mov_b32 s12, s66
    s_mov_b32 s13, s67
    s_mov_b32 s14, 2457600
    s_mov_b32 s15, 0x20000
    s_cmp_lg_u32 s3, 1
    s_cbranch_scc1 L_wm_2
    s_mul_i32 s49, s2, 50
    v_min_u32 v7, 49, v1
    v_add_u32 v7, s49, v7
    s_mov_b32 s50, 214748365
    v_mul_hi_u32 v8, v7, s50
    v_mul_u32_u24 v8, 1280, v8
    v_lshl_add_u32 v7, v7, 7, v8
    buffer_load_dword v43, v7, s[12:15], 0 offen offset:1280
L_wm_2:
    s_mov_b32 s16, s86
    s_mov_b32 s17, s87
    s_mov_b32 s18, 33554432
    s_mov_b32 s19, 0x20000
    s_mov_b32 s20, s82
    s_mov_b32 s21, s83
    s_mov_b32 s22, 2621440
    s_mov_b32 s23, 0x20000
    s_mul_i32 s63, s5, 196608
    s_add_u32 s63, s63, 8388608
    s_lshl_b32 s49, s4, 2
    s_add_u32 s49, s49, s3
    s_mul_i32 s49, s49, 61440
    s_add_u32 s64, s49, 3147776
    s_add_u32 s65, s49, 5242880
    s_mul_i32 s49, s3, 49152
    s_add_u32 s49, s49, s63
    s_add_u32 s66, s49, 0
    s_mul_i32 s49, s4, 24576
    s_add_u32 s71, s49, s63
    s_lshr_b32 s49, s3, 1
    s_mul_i32 s49, s49, 3072
    s_add_u32 s49, s49, s71
    s_and_b32 s50, s3, 1
    s_lshl_b32 s50, s50, 9
    s_add_u32 s49, s49, s50
    s_add_u32 s67, s49, 2048
    s_lshl_b32 s49, s5, 3
    s_add_u32 s50, s49, s4
    s_lshl_b32 s50, s50, 7
    s_lshl_b32 s51, s3, 2
    s_add_u32 s50, s50, s51
    s_add_u32 s68, s50, 98304
    s_lshl_b32 s50, s3, 1
    s_add_u32 s49, s49, s50
    s_lshl_b32 s49, s49, 7
    s_add_u32 s69, s49, 98304
    s_lshl_b32 s49, s5, 4
    s_add_u32 s49, s49, s3
    s_mul_i32 s49, s49, 5120
    s_mul_i32 s50, s4, 160
    s_add_u32 s70, s49, s50
    s_lshl_b32 s49, s3, 6
    s_add_u32 s49, s49, s4
    s_mul_i32 s49, s49, 24576
    s_lshl_b32 s50, s5, 8
    s_add_u32 s49, s49, s50
    s_add_u32 s72, s49, 8388608
    s_lshl_b32 s49, s4, 13
    s_lshl_b32 s50, s3, 11
    s_add_u32 s49, s49, s50
    s_add_u32 s73, s49, 7340032
    s_lshl_b32 s49, s3, 11
    s_add_u32 s74, s63, s49
    s_add_u32 s76, s71, s49
    s_mul_i32 s49, s3, 2560
    s_add_u32 s49, s49, s71
    s_add_u32 s77, s49, 14336
    s_lshl_b32 s50, s3, 9
    s_add_u32 s75, s50, s71
    s_add_u32 s75, s75, 8192
    s_add_u32 s50, s50, s63
    s_add_u32 s50, s50, 6144
    s_lshr_b32 s49, s4, 1
    s_add_u32 s49, s49, 0
    s_and_b32 s49, s49, 3
    s_mul_i32 s49, s49, 49152
    s_add_u32 s78, s49, s74
    s_add_u32 s82, s49, s50
    s_lshr_b32 s49, s4, 1
    s_add_u32 s49, s49, 1
    s_and_b32 s49, s49, 3
    s_mul_i32 s49, s49, 49152
    s_add_u32 s79, s49, s74
    s_add_u32 s83, s49, s50
    s_lshr_b32 s49, s4, 1
    s_add_u32 s49, s49, 2
    s_and_b32 s49, s49, 3
    s_mul_i32 s49, s49, 49152
    s_add_u32 s80, s49, s74
    s_add_u32 s84, s49, s50
    s_lshr_b32 s49, s4, 1
    s_add_u32 s49, s49, 3
    s_and_b32 s49, s49, 3
    s_mul_i32 s49, s49, 49152
    s_add_u32 s81, s49, s74
    s_add_u32 s85, s49, s50
    s_barrier
    ds_read_b128 v[176:179], v128 offset:0
    ds_read_b128 v[180:183], v129 offset:0
    ds_read_b128 v[184:187], v130 offset:0
    ds_read_b128 v[188:191], v131 offset:0
    s_waitcnt lgkmcnt(3)
    v_dot2c_f32_bf16 v132, v176, v2
    v_dot2c_f32_bf16 v134, v176, v176
    v_dot2c_f32_bf16 v133, v177, v2
    v_dot2c_f32_bf16 v135, v177, v177
    v_dot2c_f32_bf16 v132, v178, v2
    v_dot2c_f32_bf16 v134, v178, v178
    v_dot2c_f32_bf16 v133, v179, v2
    v_dot2c_f32_bf16 v135, v179, v179
    s_waitcnt lgkmcnt(2)
    v_dot2c_f32_bf16 v132, v180, v2
    v_dot2c_f32_bf16 v134, v180, v180
    v_dot2c_f32_bf16 v133, v181, v2
    v_dot2c_f32_bf16 v135, v181, v181
    v_dot2c_f32_bf16 v132, v182, v2
    v_dot2c_f32_bf16 v134, v182, v182
    v_dot2c_f32_bf16 v133, v183, v2
    v_dot2c_f32_bf16 v135, v183, v183
    s_waitcnt lgkmcnt(1)
    v_dot2c_f32_bf16 v132, v184, v2
    v_dot2c_f32_bf16 v134, v184, v184
    v_dot2c_f32_bf16 v133, v185, v2
    v_dot2c_f32_bf16 v135, v185, v185
    v_dot2c_f32_bf16 v132, v186, v2
    v_dot2c_f32_bf16 v134, v186, v186
    v_dot2c_f32_bf16 v133, v187, v2
    v_dot2c_f32_bf16 v135, v187, v187
    s_waitcnt lgkmcnt(0)
    v_dot2c_f32_bf16 v132, v188, v2
    v_dot2c_f32_bf16 v134, v188, v188
    v_dot2c_f32_bf16 v133, v189, v2
    v_dot2c_f32_bf16 v135, v189, v189
    v_dot2c_f32_bf16 v132, v190, v2
    v_dot2c_f32_bf16 v134, v190, v190
    v_dot2c_f32_bf16 v133, v191, v2
    v_dot2c_f32_bf16 v135, v191, v191
    s_barrier
    ds_read_b128 v[192:195], v128 offset:4096
    ds_read_b128 v[196:199], v129 offset:4096
    ds_read_b128 v[200:203], v130 offset:4096
    ds_read_b128 v[204:207], v131 offset:4096
    s_waitcnt lgkmcnt(3)
    v_dot2c_f32_bf16 v132, v192, v2
    v_dot2c_f32_bf16 v134, v192, v192
    v_dot2c_f32_bf16 v133, v193, v2
    v_dot2c_f32_bf16 v135, v193, v193
    v_dot2c_f32_bf16 v132, v194, v2
    v_dot2c_f32_bf16 v134, v194, v194
    v_dot2c_f32_bf16 v133, v195, v2
    v_dot2c_f32_bf16 v135, v195, v195
    s_waitcnt lgkmcnt(2)
    v_dot2c_f32_bf16 v132, v196, v2
    v_dot2c_f32_bf16 v134, v196, v196
    v_dot2c_f32_bf16 v133, v197, v2
    v_dot2c_f32_bf16 v135, v197, v197
    v_dot2c_f32_bf16 v132, v198, v2
    v_dot2c_f32_bf16 v134, v198, v198
    v_dot2c_f32_bf16 v133, v199, v2
    v_dot2c_f32_bf16 v135, v199, v199
    s_waitcnt lgkmcnt(1)
    v_dot2c_f32_bf16 v132, v200, v2
    v_dot2c_f32_bf16 v134, v200, v200
    v_dot2c_f32_bf16 v133, v201, v2
    v_dot2c_f32_bf16 v135, v201, v201
    v_dot2c_f32_bf16 v132, v202, v2
    v_dot2c_f32_bf16 v134, v202, v202
    v_dot2c_f32_bf16 v133, v203, v2
    v_dot2c_f32_bf16 v135, v203, v203
    s_waitcnt lgkmcnt(0)
    v_dot2c_f32_bf16 v132, v204, v2
    v_dot2c_f32_bf16 v134, v204, v204
    v_dot2c_f32_bf16 v133, v205, v2
    v_dot2c_f32_bf16 v135, v205, v205
    v_dot2c_f32_bf16 v132, v206, v2
    v_dot2c_f32_bf16 v134, v206, v206
    v_dot2c_f32_bf16 v133, v207, v2
    v_dot2c_f32_bf16 v135, v207, v207
    s_barrier
    ds_read_b128 v[208:211], v128 offset:8192
    ds_read_b128 v[212:215], v129 offset:8192
    ds_read_b128 v[216:219], v130 offset:8192
    ds_read_b128 v[220:223], v131 offset:8192
    s_waitcnt lgkmcnt(3)
    v_dot2c_f32_bf16 v132, v208, v2
    v_dot2c_f32_bf16 v134, v208, v208
    v_dot2c_f32_bf16 v133, v209, v2
    v_dot2c_f32_bf16 v135, v209, v209
    v_dot2c_f32_bf16 v132, v210, v2
    v_dot2c_f32_bf16 v134, v210, v210
    v_dot2c_f32_bf16 v133, v211, v2
    v_dot2c_f32_bf16 v135, v211, v211
    s_waitcnt lgkmcnt(2)
    v_dot2c_f32_bf16 v132, v212, v2
    v_dot2c_f32_bf16 v134, v212, v212
    v_dot2c_f32_bf16 v133, v213, v2
    v_dot2c_f32_bf16 v135, v213, v213
    v_dot2c_f32_bf16 v132, v214, v2
    v_dot2c_f32_bf16 v134, v214, v214
    v_dot2c_f32_bf16 v133, v215, v2
    v_dot2c_f32_bf16 v135, v215, v215
    s_waitcnt lgkmcnt(1)
    v_dot2c_f32_bf16 v132, v216, v2
    v_dot2c_f32_bf16 v134, v216, v216
    v_dot2c_f32_bf16 v133, v217, v2
    v_dot2c_f32_bf16 v135, v217, v217
    v_dot2c_f32_bf16 v132, v218, v2
    v_dot2c_f32_bf16 v134, v218, v218
    v_dot2c_f32_bf16 v133, v219, v2
    v_dot2c_f32_bf16 v135, v219, v219
    s_waitcnt lgkmcnt(0)
    v_dot2c_f32_bf16 v132, v220, v2
    v_dot2c_f32_bf16 v134, v220, v220
    v_dot2c_f32_bf16 v133, v221, v2
    v_dot2c_f32_bf16 v135, v221, v221
    v_dot2c_f32_bf16 v132, v222, v2
    v_dot2c_f32_bf16 v134, v222, v222
    v_dot2c_f32_bf16 v133, v223, v2
    v_dot2c_f32_bf16 v135, v223, v223
    s_barrier
    ds_read_b128 v[224:227], v128 offset:12288
    ds_read_b128 v[228:231], v129 offset:12288
    ds_read_b128 v[232:235], v130 offset:12288
    ds_read_b128 v[236:239], v131 offset:12288
    s_waitcnt lgkmcnt(3)
    v_dot2c_f32_bf16 v132, v224, v2
    v_dot2c_f32_bf16 v134, v224, v224
    v_dot2c_f32_bf16 v133, v225, v2
    v_dot2c_f32_bf16 v135, v225, v225
    v_dot2c_f32_bf16 v132, v226, v2
    v_dot2c_f32_bf16 v134, v226, v226
    v_dot2c_f32_bf16 v133, v227, v2
    v_dot2c_f32_bf16 v135, v227, v227
    s_waitcnt lgkmcnt(2)
    v_dot2c_f32_bf16 v132, v228, v2
    v_dot2c_f32_bf16 v134, v228, v228
    v_dot2c_f32_bf16 v133, v229, v2
    v_dot2c_f32_bf16 v135, v229, v229
    v_dot2c_f32_bf16 v132, v230, v2
    v_dot2c_f32_bf16 v134, v230, v230
    v_dot2c_f32_bf16 v133, v231, v2
    v_dot2c_f32_bf16 v135, v231, v231
    s_waitcnt lgkmcnt(1)
    v_dot2c_f32_bf16 v132, v232, v2
    v_dot2c_f32_bf16 v134, v232, v232
    v_dot2c_f32_bf16 v133, v233, v2
    v_dot2c_f32_bf16 v135, v233, v233
    v_dot2c_f32_bf16 v132, v234, v2
    v_dot2c_f32_bf16 v134, v234, v234
    v_dot2c_f32_bf16 v133, v235, v2
    v_dot2c_f32_bf16 v135, v235, v235
    s_waitcnt lgkmcnt(0)
    v_dot2c_f32_bf16 v132, v236, v2
    v_dot2c_f32_bf16 v134, v236, v236
    v_dot2c_f32_bf16 v133, v237, v2
    v_dot2c_f32_bf16 v135, v237, v237
    v_dot2c_f32_bf16 v132, v238, v2
    v_dot2c_f32_bf16 v134, v238, v238
    v_dot2c_f32_bf16 v133, v239, v2
    v_dot2c_f32_bf16 v135, v239, v239
    s_barrier
.p2align 3
    ds_read_b64 v[14:15], v14
    ds_read_b64 v[16:17], v16
    ds_read_b64 v[18:19], v18
    ds_read_b64 v[20:21], v20
    ds_read_b64 v[22:23], v22
    ds_read_b128 v[240:243], v128 offset:16384
    ds_read_b128 v[244:247], v129 offset:16384
    ds_read_b128 v[248:251], v130 offset:16384
    ds_read_b128 v[252:255], v131 offset:16384
    s_waitcnt lgkmcnt(3)
    v_dot2c_f32_bf16 v132, v240, v2
    v_dot2c_f32_bf16 v134, v240, v240
    v_dot2c_f32_bf16 v133, v241, v2
    v_dot2c_f32_bf16 v135, v241, v241
    v_dot2c_f32_bf16 v132, v242, v2
    v_dot2c_f32_bf16 v134, v242, v242
    v_dot2c_f32_bf16 v133, v243, v2
    v_dot2c_f32_bf16 v135, v243, v243
    s_waitcnt lgkmcnt(2)
    v_dot2c_f32_bf16 v132, v244, v2
    v_dot2c_f32_bf16 v134, v244, v244
    v_dot2c_f32_bf16 v133, v245, v2
    v_dot2c_f32_bf16 v135, v245, v245
    v_dot2c_f32_bf16 v132, v246, v2
    v_dot2c_f32_bf16 v134, v246, v246
    v_dot2c_f32_bf16 v133, v247, v2
    v_dot2c_f32_bf16 v135, v247, v247
    s_waitcnt lgkmcnt(1)
    v_dot2c_f32_bf16 v132, v248, v2
    v_dot2c_f32_bf16 v134, v248, v248
    v_dot2c_f32_bf16 v133, v249, v2
    v_dot2c_f32_bf16 v135, v249, v249
    v_dot2c_f32_bf16 v132, v250, v2
    v_dot2c_f32_bf16 v134, v250, v250
    v_dot2c_f32_bf16 v133, v251, v2
    v_dot2c_f32_bf16 v135, v251, v251
    s_waitcnt lgkmcnt(0)
    s_barrier
    v_dot2c_f32_bf16 v132, v252, v2
    v_dot2c_f32_bf16 v134, v252, v252
    v_dot2c_f32_bf16 v133, v253, v2
    v_dot2c_f32_bf16 v135, v253, v253
    v_dot2c_f32_bf16 v132, v254, v2
    v_dot2c_f32_bf16 v134, v254, v254
    v_dot2c_f32_bf16 v133, v255, v2
    v_dot2c_f32_bf16 v135, v255, v255
s_nop 1
    v_add_f32 v132, v132, v133
    v_add_f32 v134, v134, v135
    v_mov_b32 v7, v132
    v_mov_b32 v8, v134
s_nop 0
    v_permlane32_swap_b32 v132, v7
    v_permlane32_swap_b32 v134, v8
    v_add_f32 v132, v132, v7
    v_add_f32 v134, v134, v8
    v_mov_b32 v7, v132
    v_mov_b32 v8, v134
s_nop 0
    v_permlane16_swap_b32 v132, v7
    v_permlane16_swap_b32 v134, v8
    v_add_f32 v132, v132, v7
    v_add_f32 v134, v134, v8
    v_mul_f32 v132, 0x3acccccd, v132
    v_mul_f32 v134, 0x3acccccd, v134
    v_fma_f32 v134, -v132, v132, v134
    v_max_f32 v134, 0, v134
    v_add_f32 v134, 0x3727c5ac, v134
    v_rsq_f32 v134, v134
s_nop 0
    v_mul_f32 v132, v132, v134
    v_sub_f32 v132, 0, v132
    v_lshlrev_b32 v50, 16, v176
    v_and_b32 v51, s55, v176
    v_pk_fma_f32 v[50:51], v[50:51], v[134:135], v[132:133] op_sel_hi:[1,0,0]
    v_cvt_pk_bf16_f32 v176, v50, v51
    v_lshlrev_b32 v52, 16, v177
    v_and_b32 v53, s55, v177
    v_pk_fma_f32 v[52:53], v[52:53], v[134:135], v[132:133] op_sel_hi:[1,0,0]
    v_cvt_pk_bf16_f32 v177, v52, v53
    v_lshlrev_b32 v50, 16, v178
    v_and_b32 v51, s55, v178
    v_pk_fma_f32 v[50:51], v[50:51], v[134:135], v[132:133] op_sel_hi:[1,0,0]
    v_cvt_pk_bf16_f32 v178, v50, v51
    v_lshlrev_b32 v52, 16, v179
    v_and_b32 v53, s55, v179
    v_pk_fma_f32 v[52:53], v[52:53], v[134:135], v[132:133] op_sel_hi:[1,0,0]
    v_cvt_pk_bf16_f32 v179, v52, v53
    v_lshlrev_b32 v50, 16, v180
    v_and_b32 v51, s55, v180
    v_pk_fma_f32 v[50:51], v[50:51], v[134:135], v[132:133] op_sel_hi:[1,0,0]
    v_cvt_pk_bf16_f32 v180, v50, v51
    v_lshlrev_b32 v52, 16, v181
    v_and_b32 v53, s55, v181
    v_pk_fma_f32 v[52:53], v[52:53], v[134:135], v[132:133] op_sel_hi:[1,0,0]
    v_cvt_pk_bf16_f32 v181, v52, v53
    v_lshlrev_b32 v50, 16, v182
    v_and_b32 v51, s55, v182
    v_pk_fma_f32 v[50:51], v[50:51], v[134:135], v[132:133] op_sel_hi:[1,0,0]
    v_cvt_pk_bf16_f32 v182, v50, v51
    v_lshlrev_b32 v52, 16, v183
    v_and_b32 v53, s55, v183
    v_pk_fma_f32 v[52:53], v[52:53], v[134:135], v[132:133] op_sel_hi:[1,0,0]
    v_cvt_pk_bf16_f32 v183, v52, v53
    v_lshlrev_b32 v50, 16, v184
    v_and_b32 v51, s55, v184
    v_pk_fma_f32 v[50:51], v[50:51], v[134:135], v[132:133] op_sel_hi:[1,0,0]
    v_cvt_pk_bf16_f32 v184, v50, v51
    v_lshlrev_b32 v52, 16, v185
    v_and_b32 v53, s55, v185
    v_pk_fma_f32 v[52:53], v[52:53], v[134:135], v[132:133] op_sel_hi:[1,0,0]
    v_cvt_pk_bf16_f32 v185, v52, v53
    v_lshlrev_b32 v50, 16, v186
    v_and_b32 v51, s55, v186
    v_pk_fma_f32 v[50:51], v[50:51], v[134:135], v[132:133] op_sel_hi:[1,0,0]
    v_cvt_pk_bf16_f32 v186, v50, v51
    v_lshlrev_b32 v52, 16, v187
    v_and_b32 v53, s55, v187
    v_pk_fma_f32 v[52:53], v[52:53], v[134:135], v[132:133] op_sel_hi:[1,0,0]
    v_cvt_pk_bf16_f32 v187, v52, v53
    v_lshlrev_b32 v50, 16, v188
    v_and_b32 v51, s55, v188
    v_pk_fma_f32 v[50:51], v[50:51], v[134:135], v[132:133] op_sel_hi:[1,0,0]
    v_cvt_pk_bf16_f32 v188, v50, v51
    v_lshlrev_b32 v52, 16, v189
    v_and_b32 v53, s55, v189
    v_pk_fma_f32 v[52:53], v[52:53], v[134:135], v[132:133] op_sel_hi:[1,0,0]
    v_cvt_pk_bf16_f32 v189, v52, v53
    v_lshlrev_b32 v50, 16, v190
    v_and_b32 v51, s55, v190
    v_pk_fma_f32 v[50:51], v[50:51], v[134:135], v[132:133] op_sel_hi:[1,0,0]
    v_cvt_pk_bf16_f32 v190, v50, v51
    v_lshlrev_b32 v52, 16, v191
    v_and_b32 v53, s55, v191
    v_pk_fma_f32 v[52:53], v[52:53], v[134:135], v[132:133] op_sel_hi:[1,0,0]
    v_cvt_pk_bf16_f32 v191, v52, v53
    v_lshlrev_b32 v50, 16, v192
    v_and_b32 v51, s55, v192
    v_pk_fma_f32 v[50:51], v[50:51], v[134:135], v[132:133] op_sel_hi:[1,0,0]
    v_cvt_pk_bf16_f32 v192, v50, v51
    v_lshlrev_b32 v52, 16, v193
    v_and_b32 v53, s55, v193
    v_pk_fma_f32 v[52:53], v[52:53], v[134:135], v[132:133] op_sel_hi:[1,0,0]
    v_cvt_pk_bf16_f32 v193, v52, v53
    v_lshlrev_b32 v50, 16, v194
    v_and_b32 v51, s55, v194
    v_pk_fma_f32 v[50:51], v[50:51], v[134:135], v[132:133] op_sel_hi:[1,0,0]
    v_cvt_pk_bf16_f32 v194, v50, v51
    v_lshlrev_b32 v52, 16, v195
    v_and_b32 v53, s55, v195
    v_pk_fma_f32 v[52:53], v[52:53], v[134:135], v[132:133] op_sel_hi:[1,0,0]
    v_cvt_pk_bf16_f32 v195, v52, v53
    v_lshlrev_b32 v50, 16, v196
    v_and_b32 v51, s55, v196
    v_pk_fma_f32 v[50:51], v[50:51], v[134:135], v[132:133] op_sel_hi:[1,0,0]
    v_cvt_pk_bf16_f32 v196, v50, v51
    v_lshlrev_b32 v52, 16, v197
    v_and_b32 v53, s55, v197
    v_pk_fma_f32 v[52:53], v[52:53], v[134:135], v[132:133] op_sel_hi:[1,0,0]
    v_cvt_pk_bf16_f32 v197, v52, v53
    v_lshlrev_b32 v50, 16, v198
    v_and_b32 v51, s55, v198
    v_pk_fma_f32 v[50:51], v[50:51], v[134:135], v[132:133] op_sel_hi:[1,0,0]
    v_cvt_pk_bf16_f32 v198, v50, v51
    v_lshlrev_b32 v52, 16, v199
    v_and_b32 v53, s55, v199
    v_pk_fma_f32 v[52:53], v[52:53], v[134:135], v[132:133] op_sel_hi:[1,0,0]
    v_cvt_pk_bf16_f32 v199, v52, v53
    v_lshlrev_b32 v50, 16, v200
    v_and_b32 v51, s55, v200
    v_pk_fma_f32 v[50:51], v[50:51], v[134:135], v[132:133] op_sel_hi:[1,0,0]
    v_cvt_pk_bf16_f32 v200, v50, v51
    v_lshlrev_b32 v52, 16, v201
    v_and_b32 v53, s55, v201
    v_pk_fma_f32 v[52:53], v[52:53], v[134:135], v[132:133] op_sel_hi:[1,0,0]
    v_cvt_pk_bf16_f32 v201, v52, v53
    v_lshlrev_b32 v50, 16, v202
    v_and_b32 v51, s55, v202
    v_pk_fma_f32 v[50:51], v[50:51], v[134:135], v[132:133] op_sel_hi:[1,0,0]
    v_cvt_pk_bf16_f32 v202, v50, v51
    v_lshlrev_b32 v52, 16, v203
    v_and_b32 v53, s55, v203
    v_pk_fma_f32 v[52:53], v[52:53], v[134:135], v[132:133] op_sel_hi:[1,0,0]
    v_cvt_pk_bf16_f32 v203, v52, v53
    v_lshlrev_b32 v50, 16, v204
    v_and_b32 v51, s55, v204
    v_pk_fma_f32 v[50:51], v[50:51], v[134:135], v[132:133] op_sel_hi:[1,0,0]
    v_cvt_pk_bf16_f32 v204, v50, v51
    v_lshlrev_b32 v52, 16, v205
    v_and_b32 v53, s55, v205
    v_pk_fma_f32 v[52:53], v[52:53], v[134:135], v[132:133] op_sel_hi:[1,0,0]
    v_cvt_pk_bf16_f32 v205, v52, v53
    v_lshlrev_b32 v50, 16, v206
    v_and_b32 v51, s55, v206
    v_pk_fma_f32 v[50:51], v[50:51], v[134:135], v[132:133] op_sel_hi:[1,0,0]
    v_cvt_pk_bf16_f32 v206, v50, v51
    v_lshlrev_b32 v52, 16, v207
    v_and_b32 v53, s55, v207
    v_pk_fma_f32 v[52:53], v[52:53], v[134:135], v[132:133] op_sel_hi:[1,0,0]
    v_cvt_pk_bf16_f32 v207, v52, v53
    v_lshlrev_b32 v50, 16, v208
    v_and_b32 v51, s55, v208
    v_pk_fma_f32 v[50:51], v[50:51], v[134:135], v[132:133] op_sel_hi:[1,0,0]
    v_cvt_pk_bf16_f32 v208, v50, v51
    v_lshlrev_b32 v52, 16, v209
    v_and_b32 v53, s55, v209
    v_pk_fma_f32 v[52:53], v[52:53], v[134:135], v[132:133] op_sel_hi:[1,0,0]
    v_cvt_pk_bf16_f32 v209, v52, v53
    v_lshlrev_b32 v50, 16, v210
    v_and_b32 v51, s55, v210
    v_pk_fma_f32 v[50:51], v[50:51], v[134:135], v[132:133] op_sel_hi:[1,0,0]
    v_cvt_pk_bf16_f32 v210, v50, v51
    v_lshlrev_b32 v52, 16, v211
    v_and_b32 v53, s55, v211
    v_pk_fma_f32 v[52:53], v[52:53], v[134:135], v[132:133] op_sel_hi:[1,0,0]
    v_cvt_pk_bf16_f32 v211, v52, v53
    v_lshlrev_b32 v50, 16, v212
    v_and_b32 v51, s55, v212
    v_pk_fma_f32 v[50:51], v[50:51], v[134:135], v[132:133] op_sel_hi:[1,0,0]
    v_cvt_pk_bf16_f32 v212, v50, v51
    v_lshlrev_b32 v52, 16, v213
    v_and_b32 v53, s55, v213
    v_pk_fma_f32 v[52:53], v[52:53], v[134:135], v[132:133] op_sel_hi:[1,0,0]
    v_cvt_pk_bf16_f32 v213, v52, v53
    v_lshlrev_b32 v50, 16, v214
    v_and_b32 v51, s55, v214
    v_pk_fma_f32 v[50:51], v[50:51], v[134:135], v[132:133] op_sel_hi:[1,0,0]
    v_cvt_pk_bf16_f32 v214, v50, v51
    v_lshlrev_b32 v52, 16, v215
    v_and_b32 v53, s55, v215
    v_pk_fma_f32 v[52:53], v[52:53], v[134:135], v[132:133] op_sel_hi:[1,0,0]
    v_cvt_pk_bf16_f32 v215, v52, v53
    v_lshlrev_b32 v50, 16, v216
    v_and_b32 v51, s55, v216
    v_pk_fma_f32 v[50:51], v[50:51], v[134:135], v[132:133] op_sel_hi:[1,0,0]
    v_cvt_pk_bf16_f32 v216, v50, v51
    v_lshlrev_b32 v52, 16, v217
    v_and_b32 v53, s55, v217
    v_pk_fma_f32 v[52:53], v[52:53], v[134:135], v[132:133] op_sel_hi:[1,0,0]
    v_cvt_pk_bf16_f32 v217, v52, v53
    v_lshlrev_b32 v50, 16, v218
    v_and_b32 v51, s55, v218
    v_pk_fma_f32 v[50:51], v[50:51], v[134:135], v[132:133] op_sel_hi:[1,0,0]
    v_cvt_pk_bf16_f32 v218, v50, v51
    v_lshlrev_b32 v52, 16, v219
    v_and_b32 v53, s55, v219
    v_pk_fma_f32 v[52:53], v[52:53], v[134:135], v[132:133] op_sel_hi:[1,0,0]
    v_cvt_pk_bf16_f32 v219, v52, v53
    v_lshlrev_b32 v50, 16, v220
    v_and_b32 v51, s55, v220
    v_pk_fma_f32 v[50:51], v[50:51], v[134:135], v[132:133] op_sel_hi:[1,0,0]
    v_cvt_pk_bf16_f32 v220, v50, v51
    v_lshlrev_b32 v52, 16, v221
    v_and_b32 v53, s55, v221
    v_pk_fma_f32 v[52:53], v[52:53], v[134:135], v[132:133] op_sel_hi:[1,0,0]
    v_cvt_pk_bf16_f32 v221, v52, v53
    v_lshlrev_b32 v50, 16, v222
    v_and_b32 v51, s55, v222
    v_pk_fma_f32 v[50:51], v[50:51], v[134:135], v[132:133] op_sel_hi:[1,0,0]
    v_cvt_pk_bf16_f32 v222, v50, v51
    v_lshlrev_b32 v52, 16, v223
    v_and_b32 v53, s55, v223
    v_pk_fma_f32 v[52:53], v[52:53], v[134:135], v[132:133] op_sel_hi:[1,0,0]
    v_cvt_pk_bf16_f32 v223, v52, v53
    v_lshlrev_b32 v50, 16, v224
    v_and_b32 v51, s55, v224
    v_pk_fma_f32 v[50:51], v[50:51], v[134:135], v[132:133] op_sel_hi:[1,0,0]
    v_cvt_pk_bf16_f32 v224, v50, v51
    v_lshlrev_b32 v52, 16, v225
    v_and_b32 v53, s55, v225
    v_pk_fma_f32 v[52:53], v[52:53], v[134:135], v[132:133] op_sel_hi:[1,0,0]
    v_cvt_pk_bf16_f32 v225, v52, v53
    v_lshlrev_b32 v50, 16, v226
    v_and_b32 v51, s55, v226
    v_pk_fma_f32 v[50:51], v[50:51], v[134:135], v[132:133] op_sel_hi:[1,0,0]
    v_cvt_pk_bf16_f32 v226, v50, v51
    v_lshlrev_b32 v52, 16, v227
    v_and_b32 v53, s55, v227
    v_pk_fma_f32 v[52:53], v[52:53], v[134:135], v[132:133] op_sel_hi:[1,0,0]
    v_cvt_pk_bf16_f32 v227, v52, v53
    v_lshlrev_b32 v50, 16, v228
    v_and_b32 v51, s55, v228
    v_pk_fma_f32 v[50:51], v[50:51], v[134:135], v[132:133] op_sel_hi:[1,0,0]
    v_cvt_pk_bf16_f32 v228, v50, v51
    v_lshlrev_b32 v52, 16, v229
    v_and_b32 v53, s55, v229
    v_pk_fma_f32 v[52:53], v[52:53], v[134:135], v[132:133] op_sel_hi:[1,0,0]
    v_cvt_pk_bf16_f32 v229, v52, v53
    v_lshlrev_b32 v50, 16, v230
    v_and_b32 v51, s55, v230
    v_pk_fma_f32 v[50:51], v[50:51], v[134:135], v[132:133] op_sel_hi:[1,0,0]
    v_cvt_pk_bf16_f32 v230, v50, v51
    v_lshlrev_b32 v52, 16, v231
    v_and_b32 v53, s55, v231
    v_pk_fma_f32 v[52:53], v[52:53], v[134:135], v[132:133] op_sel_hi:[1,0,0]
    v_cvt_pk_bf16_f32 v231, v52, v53
    v_lshlrev_b32 v50, 16, v232
    v_and_b32 v51, s55, v232
    v_pk_fma_f32 v[50:51], v[50:51], v[134:135], v[132:133] op_sel_hi:[1,0,0]
    v_cvt_pk_bf16_f32 v232, v50, v51
    v_lshlrev_b32 v52, 16, v233
    v_and_b32 v53, s55, v233
    v_pk_fma_f32 v[52:53], v[52:53], v[134:135], v[132:133] op_sel_hi:[1,0,0]
    v_cvt_pk_bf16_f32 v233, v52, v53
    v_lshlrev_b32 v50, 16, v234
    v_and_b32 v51, s55, v234
    v_pk_fma_f32 v[50:51], v[50:51], v[134:135], v[132:133] op_sel_hi:[1,0,0]
    v_cvt_pk_bf16_f32 v234, v50, v51
    v_lshlrev_b32 v52, 16, v235
    v_and_b32 v53, s55, v235
    v_pk_fma_f32 v[52:53], v[52:53], v[134:135], v[132:133] op_sel_hi:[1,0,0]
    v_cvt_pk_bf16_f32 v235, v52, v53
    v_lshlrev_b32 v50, 16, v236
    v_and_b32 v51, s55, v236
    v_pk_fma_f32 v[50:51], v[50:51], v[134:135], v[132:133] op_sel_hi:[1,0,0]
    v_cvt_pk_bf16_f32 v236, v50, v51
    v_lshlrev_b32 v52, 16, v237
    v_and_b32 v53, s55, v237
    v_pk_fma_f32 v[52:53], v[52:53], v[134:135], v[132:133] op_sel_hi:[1,0,0]
    v_cvt_pk_bf16_f32 v237, v52, v53
    v_lshlrev_b32 v50, 16, v238
    v_and_b32 v51, s55, v238
    v_pk_fma_f32 v[50:51], v[50:51], v[134:135], v[132:133] op_sel_hi:[1,0,0]
    v_cvt_pk_bf16_f32 v238, v50, v51
    v_lshlrev_b32 v52, 16, v239
    v_and_b32 v53, s55, v239
    v_pk_fma_f32 v[52:53], v[52:53], v[134:135], v[132:133] op_sel_hi:[1,0,0]
    v_cvt_pk_bf16_f32 v239, v52, v53
    v_lshlrev_b32 v50, 16, v240
    v_and_b32 v51, s55, v240
    v_pk_fma_f32 v[50:51], v[50:51], v[134:135], v[132:133] op_sel_hi:[1,0,0]
    v_cvt_pk_bf16_f32 v240, v50, v51
    v_lshlrev_b32 v52, 16, v241
    v_and_b32 v53, s55, v241
    v_pk_fma_f32 v[52:53], v[52:53], v[134:135], v[132:133] op_sel_hi:[1,0,0]
    v_cvt_pk_bf16_f32 v241, v52, v53
    v_lshlrev_b32 v50, 16, v242
    v_and_b32 v51, s55, v242
    v_pk_fma_f32 v[50:51], v[50:51], v[134:135], v[132:133] op_sel_hi:[1,0,0]
    v_cvt_pk_bf16_f32 v242, v50, v51
    v_lshlrev_b32 v52, 16, v243
    v_and_b32 v53, s55, v243
    v_pk_fma_f32 v[52:53], v[52:53], v[134:135], v[132:133] op_sel_hi:[1,0,0]
    v_cvt_pk_bf16_f32 v243, v52, v53
    v_lshlrev_b32 v50, 16, v244
    v_and_b32 v51, s55, v244
    v_pk_fma_f32 v[50:51], v[50:51], v[134:135], v[132:133] op_sel_hi:[1,0,0]
    v_cvt_pk_bf16_f32 v244, v50, v51
    v_lshlrev_b32 v52, 16, v245
    v_and_b32 v53, s55, v245
    v_pk_fma_f32 v[52:53], v[52:53], v[134:135], v[132:133] op_sel_hi:[1,0,0]
    v_cvt_pk_bf16_f32 v245, v52, v53
    v_lshlrev_b32 v50, 16, v246
    v_and_b32 v51, s55, v246
    v_pk_fma_f32 v[50:51], v[50:51], v[134:135], v[132:133] op_sel_hi:[1,0,0]
    v_cvt_pk_bf16_f32 v246, v50, v51
    v_lshlrev_b32 v52, 16, v247
    v_and_b32 v53, s55, v247
    v_pk_fma_f32 v[52:53], v[52:53], v[134:135], v[132:133] op_sel_hi:[1,0,0]
    v_cvt_pk_bf16_f32 v247, v52, v53
    v_lshlrev_b32 v50, 16, v248
    v_and_b32 v51, s55, v248
    v_pk_fma_f32 v[50:51], v[50:51], v[134:135], v[132:133] op_sel_hi:[1,0,0]
    v_cvt_pk_bf16_f32 v248, v50, v51
    v_lshlrev_b32 v52, 16, v249
    v_and_b32 v53, s55, v249
    v_pk_fma_f32 v[52:53], v[52:53], v[134:135], v[132:133] op_sel_hi:[1,0,0]
    v_cvt_pk_bf16_f32 v249, v52, v53
    v_lshlrev_b32 v50, 16, v250
    v_and_b32 v51, s55, v250
    v_pk_fma_f32 v[50:51], v[50:51], v[134:135], v[132:133] op_sel_hi:[1,0,0]
    v_cvt_pk_bf16_f32 v250, v50, v51
    v_lshlrev_b32 v52, 16, v251
    v_and_b32 v53, s55, v251
    v_pk_fma_f32 v[52:53], v[52:53], v[134:135], v[132:133] op_sel_hi:[1,0,0]
    v_cvt_pk_bf16_f32 v251, v52, v53
    v_lshlrev_b32 v50, 16, v252
    v_and_b32 v51, s55, v252
    v_pk_fma_f32 v[50:51], v[50:51], v[134:135], v[132:133] op_sel_hi:[1,0,0]
    v_cvt_pk_bf16_f32 v252, v50, v51
    v_lshlrev_b32 v52, 16, v253
    v_and_b32 v53, s55, v253
    v_pk_fma_f32 v[52:53], v[52:53], v[134:135], v[132:133] op_sel_hi:[1,0,0]
    v_cvt_pk_bf16_f32 v253, v52, v53
    v_lshlrev_b32 v50, 16, v254
    v_and_b32 v51, s55, v254
    v_pk_fma_f32 v[50:51], v[50:51], v[134:135], v[132:133] op_sel_hi:[1,0,0]
    v_cvt_pk_bf16_f32 v254, v50, v51
    v_lshlrev_b32 v52, 16, v255
    v_and_b32 v53, s55, v255
    v_pk_fma_f32 v[52:53], v[52:53], v[134:135], v[132:133] op_sel_hi:[1,0,0]
    v_cvt_pk_bf16_f32 v255, v52, v53
    s_barrier
.p2align 3
    ds_read_b64_tr_b16 v[50:51], v24 offset:25600
    ds_read_b64_tr_b16 v[52:53], v24 offset:28160
    ds_read_b64_tr_b16 v[54:55], v24 offset:25608
    ds_read_b64_tr_b16 v[56:57], v24 offset:28168
    ds_read_b64_tr_b16 v[58:59], v24 offset:25616
    ds_read_b64_tr_b16 v[60:61], v24 offset:28176
    ds_read_b64_tr_b16 v[62:63], v24 offset:25624
    ds_read_b64_tr_b16 v[64:65], v24 offset:28184
    ds_read_b64_tr_b16 v[66:67], v24 offset:25632
    ds_read_b64_tr_b16 v[68:69], v24 offset:28192
    ds_read_b64_tr_b16 v[70:71], v24 offset:46080
    ds_read_b64_tr_b16 v[72:73], v24 offset:48640
    ds_read_b64_tr_b16 v[74:75], v24 offset:46088
    ds_read_b64_tr_b16 v[76:77], v24 offset:48648
    s_waitcnt lgkmcnt(12)
    v_mfma_f32_16x16x32_bf16 v[78:81], v[50:53], v[176:179], 0
    s_waitcnt lgkmcnt(10)
    ds_read_b64_tr_b16 v[50:51], v24 offset:46096
    ds_read_b64_tr_b16 v[52:53], v24 offset:48656
    v_mfma_f32_16x16x32_bf16 v[82:85], v[54:57], v[176:179], 0
    s_waitcnt lgkmcnt(10)
    ds_read_b64_tr_b16 v[54:55], v24 offset:46104
    ds_read_b64_tr_b16 v[56:57], v24 offset:48664
    v_mfma_f32_16x16x32_bf16 v[86:89], v[58:61], v[176:179], 0
    s_waitcnt lgkmcnt(10)
    ds_read_b64_tr_b16 v[58:59], v24 offset:46112
    ds_read_b64_tr_b16 v[60:61], v24 offset:48672
    v_mfma_f32_16x16x32_bf16 v[90:93], v[62:65], v[176:179], 0
    s_waitcnt lgkmcnt(10)
    ds_read_b64_tr_b16 v[62:63], v25 offset:5120
    ds_read_b64_tr_b16 v[64:65], v25 offset:7680
    v_mfma_f32_16x16x32_bf16 v[94:97], v[66:69], v[176:179], 0
    s_waitcnt lgkmcnt(10)
    ds_read_b64_tr_b16 v[66:67], v25 offset:5128
    ds_read_b64_tr_b16 v[68:69], v25 offset:7688
    v_mfma_f32_16x16x32_bf16 v[78:81], v[70:73], v[180:183], v[78:81]
    s_waitcnt lgkmcnt(10)
    ds_read_b64_tr_b16 v[70:71], v25 offset:5136
    ds_read_b64_tr_b16 v[72:73], v25 offset:7696
    v_mfma_f32_16x16x32_bf16 v[82:85], v[74:77], v[180:183], v[82:85]
    s_waitcnt lgkmcnt(10)
    ds_read_b64_tr_b16 v[74:75], v25 offset:5144
    ds_read_b64_tr_b16 v[76:77], v25 offset:7704
    v_mfma_f32_16x16x32_bf16 v[86:89], v[50:53], v[180:183], v[86:89]
    s_waitcnt lgkmcnt(10)
    ds_read_b64_tr_b16 v[50:51], v25 offset:5152
    ds_read_b64_tr_b16 v[52:53], v25 offset:7712
    v_mfma_f32_16x16x32_bf16 v[90:93], v[54:57], v[180:183], v[90:93]
    s_waitcnt lgkmcnt(10)
    ds_read_b64_tr_b16 v[54:55], v25 offset:25600
    ds_read_b64_tr_b16 v[56:57], v25 offset:28160
    v_mfma_f32_16x16x32_bf16 v[94:97], v[58:61], v[180:183], v[94:97]
    s_waitcnt lgkmcnt(10)
    ds_read_b64_tr_b16 v[58:59], v25 offset:25608
    ds_read_b64_tr_b16 v[60:61], v25 offset:28168
    v_mfma_f32_16x16x32_bf16 v[78:81], v[62:65], v[184:187], v[78:81]
    s_waitcnt lgkmcnt(10)
    ds_read_b64_tr_b16 v[62:63], v25 offset:25616
    ds_read_b64_tr_b16 v[64:65], v25 offset:28176
    v_mfma_f32_16x16x32_bf16 v[82:85], v[66:69], v[184:187], v[82:85]
    s_waitcnt lgkmcnt(10)
    ds_read_b64_tr_b16 v[66:67], v25 offset:25624
    ds_read_b64_tr_b16 v[68:69], v25 offset:28184
    v_mfma_f32_16x16x32_bf16 v[86:89], v[70:73], v[184:187], v[86:89]
    s_waitcnt lgkmcnt(10)
    ds_read_b64_tr_b16 v[70:71], v25 offset:25632
    ds_read_b64_tr_b16 v[72:73], v25 offset:28192
    v_mfma_f32_16x16x32_bf16 v[90:93], v[74:77], v[184:187], v[90:93]
    s_barrier
    ds_read_b64_tr_b16 v[74:75], v24 offset:30720
    ds_read_b64_tr_b16 v[76:77], v24 offset:33280
    s_waitcnt lgkmcnt(12)
    v_mfma_f32_16x16x32_bf16 v[94:97], v[50:53], v[184:187], v[94:97]
    s_waitcnt lgkmcnt(10)
    ds_read_b64_tr_b16 v[50:51], v24 offset:30728
    ds_read_b64_tr_b16 v[52:53], v24 offset:33288
    v_mfma_f32_16x16x32_bf16 v[78:81], v[54:57], v[188:191], v[78:81]
    s_waitcnt lgkmcnt(10)
    ds_read_b64_tr_b16 v[54:55], v24 offset:30736
    ds_read_b64_tr_b16 v[56:57], v24 offset:33296
    v_mfma_f32_16x16x32_bf16 v[82:85], v[58:61], v[188:191], v[82:85]
    s_waitcnt lgkmcnt(10)
    ds_read_b64_tr_b16 v[58:59], v24 offset:30744
    ds_read_b64_tr_b16 v[60:61], v24 offset:33304
    v_mfma_f32_16x16x32_bf16 v[86:89], v[62:65], v[188:191], v[86:89]
    s_waitcnt lgkmcnt(10)
    ds_read_b64_tr_b16 v[62:63], v24 offset:30752
    ds_read_b64_tr_b16 v[64:65], v24 offset:33312
    v_mfma_f32_16x16x32_bf16 v[90:93], v[66:69], v[188:191], v[90:93]
    s_waitcnt lgkmcnt(10)
    ds_read_b64_tr_b16 v[66:67], v24 offset:51200
    ds_read_b64_tr_b16 v[68:69], v24 offset:53760
    v_mfma_f32_16x16x32_bf16 v[94:97], v[70:73], v[188:191], v[94:97]
    s_waitcnt lgkmcnt(10)
    ds_read_b64_tr_b16 v[70:71], v24 offset:51208
    ds_read_b64_tr_b16 v[72:73], v24 offset:53768
    v_mfma_f32_16x16x32_bf16 v[78:81], v[74:77], v[192:195], v[78:81]
    s_waitcnt lgkmcnt(10)
    ds_read_b64_tr_b16 v[74:75], v24 offset:51216
    ds_read_b64_tr_b16 v[76:77], v24 offset:53776
    v_mfma_f32_16x16x32_bf16 v[82:85], v[50:53], v[192:195], v[82:85]
    s_waitcnt lgkmcnt(10)
    ds_read_b64_tr_b16 v[50:51], v24 offset:51224
    ds_read_b64_tr_b16 v[52:53], v24 offset:53784
    v_mfma_f32_16x16x32_bf16 v[86:89], v[54:57], v[192:195], v[86:89]
    s_waitcnt lgkmcnt(10)
    ds_read_b64_tr_b16 v[54:55], v24 offset:51232
    ds_read_b64_tr_b16 v[56:57], v24 offset:53792
    v_mfma_f32_16x16x32_bf16 v[90:93], v[58:61], v[192:195], v[90:93]
    s_waitcnt lgkmcnt(10)
    ds_read_b64_tr_b16 v[58:59], v25 offset:10240
    ds_read_b64_tr_b16 v[60:61], v25 offset:12800
    v_mfma_f32_16x16x32_bf16 v[94:97], v[62:65], v[192:195], v[94:97]
    s_waitcnt lgkmcnt(10)
    ds_read_b64_tr_b16 v[62:63], v25 offset:10248
    ds_read_b64_tr_b16 v[64:65], v25 offset:12808
    v_mfma_f32_16x16x32_bf16 v[78:81], v[66:69], v[196:199], v[78:81]
    s_waitcnt lgkmcnt(10)
    ds_read_b64_tr_b16 v[66:67], v25 offset:10256
    ds_read_b64_tr_b16 v[68:69], v25 offset:12816
    v_mfma_f32_16x16x32_bf16 v[82:85], v[70:73], v[196:199], v[82:85]
    s_waitcnt lgkmcnt(10)
    ds_read_b64_tr_b16 v[70:71], v25 offset:10264
    ds_read_b64_tr_b16 v[72:73], v25 offset:12824
    v_mfma_f32_16x16x32_bf16 v[86:89], v[74:77], v[196:199], v[86:89]
    s_waitcnt lgkmcnt(10)
    ds_read_b64_tr_b16 v[74:75], v25 offset:10272
    ds_read_b64_tr_b16 v[76:77], v25 offset:12832
    v_mfma_f32_16x16x32_bf16 v[90:93], v[50:53], v[196:199], v[90:93]
    s_waitcnt lgkmcnt(10)
    ds_read_b64_tr_b16 v[50:51], v25 offset:30720
    ds_read_b64_tr_b16 v[52:53], v25 offset:33280
    v_mfma_f32_16x16x32_bf16 v[94:97], v[54:57], v[196:199], v[94:97]
    s_waitcnt lgkmcnt(10)
    ds_read_b64_tr_b16 v[54:55], v25 offset:30728
    ds_read_b64_tr_b16 v[56:57], v25 offset:33288
    v_mfma_f32_16x16x32_bf16 v[78:81], v[58:61], v[200:203], v[78:81]
    s_waitcnt lgkmcnt(10)
    ds_read_b64_tr_b16 v[58:59], v25 offset:30736
    ds_read_b64_tr_b16 v[60:61], v25 offset:33296
    v_mfma_f32_16x16x32_bf16 v[82:85], v[62:65], v[200:203], v[82:85]
    s_waitcnt lgkmcnt(10)
    ds_read_b64_tr_b16 v[62:63], v25 offset:30744
    ds_read_b64_tr_b16 v[64:65], v25 offset:33304
    v_mfma_f32_16x16x32_bf16 v[86:89], v[66:69], v[200:203], v[86:89]
    s_waitcnt lgkmcnt(10)
    ds_read_b64_tr_b16 v[66:67], v25 offset:30752
    ds_read_b64_tr_b16 v[68:69], v25 offset:33312
    v_mfma_f32_16x16x32_bf16 v[90:93], v[70:73], v[200:203], v[90:93]
    s_barrier
    ds_read_b64_tr_b16 v[70:71], v24 offset:35840
    ds_read_b64_tr_b16 v[72:73], v24 offset:38400
    s_waitcnt lgkmcnt(12)
    v_mfma_f32_16x16x32_bf16 v[94:97], v[74:77], v[200:203], v[94:97]
    s_waitcnt lgkmcnt(10)
    ds_read_b64_tr_b16 v[74:75], v24 offset:35848
    ds_read_b64_tr_b16 v[76:77], v24 offset:38408
    v_mfma_f32_16x16x32_bf16 v[78:81], v[50:53], v[204:207], v[78:81]
    s_waitcnt lgkmcnt(10)
    ds_read_b64_tr_b16 v[50:51], v24 offset:35856
    ds_read_b64_tr_b16 v[52:53], v24 offset:38416
    v_mfma_f32_16x16x32_bf16 v[82:85], v[54:57], v[204:207], v[82:85]
    s_waitcnt lgkmcnt(10)
    ds_read_b64_tr_b16 v[54:55], v24 offset:35864
    ds_read_b64_tr_b16 v[56:57], v24 offset:38424
    v_mfma_f32_16x16x32_bf16 v[86:89], v[58:61], v[204:207], v[86:89]
    s_waitcnt lgkmcnt(10)
    ds_read_b64_tr_b16 v[58:59], v24 offset:35872
    ds_read_b64_tr_b16 v[60:61], v24 offset:38432
    v_mfma_f32_16x16x32_bf16 v[90:93], v[62:65], v[204:207], v[90:93]
    s_waitcnt lgkmcnt(10)
    ds_read_b64_tr_b16 v[62:63], v24 offset:56320
    ds_read_b64_tr_b16 v[64:65], v24 offset:58880
    v_mfma_f32_16x16x32_bf16 v[94:97], v[66:69], v[204:207], v[94:97]
    s_waitcnt lgkmcnt(10)
    ds_read_b64_tr_b16 v[66:67], v24 offset:56328
    ds_read_b64_tr_b16 v[68:69], v24 offset:58888
    v_mfma_f32_16x16x32_bf16 v[78:81], v[70:73], v[208:211], v[78:81]
    s_waitcnt lgkmcnt(10)
    ds_read_b64_tr_b16 v[70:71], v24 offset:56336
    ds_read_b64_tr_b16 v[72:73], v24 offset:58896
    v_mfma_f32_16x16x32_bf16 v[82:85], v[74:77], v[208:211], v[82:85]
    s_waitcnt lgkmcnt(10)
    ds_read_b64_tr_b16 v[74:75], v24 offset:56344
    ds_read_b64_tr_b16 v[76:77], v24 offset:58904
    v_mfma_f32_16x16x32_bf16 v[86:89], v[50:53], v[208:211], v[86:89]
    s_waitcnt lgkmcnt(10)
    ds_read_b64_tr_b16 v[50:51], v24 offset:56352
    ds_read_b64_tr_b16 v[52:53], v24 offset:58912
    v_mfma_f32_16x16x32_bf16 v[90:93], v[54:57], v[208:211], v[90:93]
    s_waitcnt lgkmcnt(10)
    ds_read_b64_tr_b16 v[54:55], v25 offset:15360
    ds_read_b64_tr_b16 v[56:57], v25 offset:17920
    v_mfma_f32_16x16x32_bf16 v[94:97], v[58:61], v[208:211], v[94:97]
    s_waitcnt lgkmcnt(10)
    ds_read_b64_tr_b16 v[58:59], v25 offset:15368
    ds_read_b64_tr_b16 v[60:61], v25 offset:17928
    v_mfma_f32_16x16x32_bf16 v[78:81], v[62:65], v[212:215], v[78:81]
    s_waitcnt lgkmcnt(10)
    ds_read_b64_tr_b16 v[62:63], v25 offset:15376
    ds_read_b64_tr_b16 v[64:65], v25 offset:17936
    v_mfma_f32_16x16x32_bf16 v[82:85], v[66:69], v[212:215], v[82:85]
    s_waitcnt lgkmcnt(10)
    ds_read_b64_tr_b16 v[66:67], v25 offset:15384
    ds_read_b64_tr_b16 v[68:69], v25 offset:17944
    v_mfma_f32_16x16x32_bf16 v[86:89], v[70:73], v[212:215], v[86:89]
    s_waitcnt lgkmcnt(10)
    ds_read_b64_tr_b16 v[70:71], v25 offset:15392
    ds_read_b64_tr_b16 v[72:73], v25 offset:17952
    v_mfma_f32_16x16x32_bf16 v[90:93], v[74:77], v[212:215], v[90:93]
    s_waitcnt lgkmcnt(10)
    ds_read_b64_tr_b16 v[74:75], v25 offset:35840
    ds_read_b64_tr_b16 v[76:77], v25 offset:38400
    v_mfma_f32_16x16x32_bf16 v[94:97], v[50:53], v[212:215], v[94:97]
    s_waitcnt lgkmcnt(10)
    ds_read_b64_tr_b16 v[50:51], v25 offset:35848
    ds_read_b64_tr_b16 v[52:53], v25 offset:38408
    v_mfma_f32_16x16x32_bf16 v[78:81], v[54:57], v[216:219], v[78:81]
    s_waitcnt lgkmcnt(10)
    ds_read_b64_tr_b16 v[54:55], v25 offset:35856
    ds_read_b64_tr_b16 v[56:57], v25 offset:38416
    v_mfma_f32_16x16x32_bf16 v[82:85], v[58:61], v[216:219], v[82:85]
    s_waitcnt lgkmcnt(10)
    ds_read_b64_tr_b16 v[58:59], v25 offset:35864
    ds_read_b64_tr_b16 v[60:61], v25 offset:38424
    v_mfma_f32_16x16x32_bf16 v[86:89], v[62:65], v[216:219], v[86:89]
    s_waitcnt lgkmcnt(10)
    ds_read_b64_tr_b16 v[62:63], v25 offset:35872
    ds_read_b64_tr_b16 v[64:65], v25 offset:38432
    v_mfma_f32_16x16x32_bf16 v[90:93], v[66:69], v[216:219], v[90:93]
    s_barrier
    ds_read_b64_tr_b16 v[66:67], v24 offset:40960
    ds_read_b64_tr_b16 v[68:69], v24 offset:43520
    s_waitcnt lgkmcnt(12)
    v_mfma_f32_16x16x32_bf16 v[94:97], v[70:73], v[216:219], v[94:97]
    s_waitcnt lgkmcnt(10)
    ds_read_b64_tr_b16 v[70:71], v24 offset:40968
    ds_read_b64_tr_b16 v[72:73], v24 offset:43528
    v_mfma_f32_16x16x32_bf16 v[78:81], v[74:77], v[220:223], v[78:81]
    s_waitcnt lgkmcnt(10)
    ds_read_b64_tr_b16 v[74:75], v24 offset:40976
    ds_read_b64_tr_b16 v[76:77], v24 offset:43536
    v_mfma_f32_16x16x32_bf16 v[82:85], v[50:53], v[220:223], v[82:85]
    s_waitcnt lgkmcnt(10)
    ds_read_b64_tr_b16 v[50:51], v24 offset:40984
    ds_read_b64_tr_b16 v[52:53], v24 offset:43544
    v_mfma_f32_16x16x32_bf16 v[86:89], v[54:57], v[220:223], v[86:89]
    s_waitcnt lgkmcnt(10)
    ds_read_b64_tr_b16 v[54:55], v24 offset:40992
    ds_read_b64_tr_b16 v[56:57], v24 offset:43552
    v_mfma_f32_16x16x32_bf16 v[90:93], v[58:61], v[220:223], v[90:93]
    s_waitcnt lgkmcnt(10)
    ds_read_b64_tr_b16 v[58:59], v25 offset:0
    ds_read_b64_tr_b16 v[60:61], v25 offset:2560
    v_mfma_f32_16x16x32_bf16 v[94:97], v[62:65], v[220:223], v[94:97]
    s_waitcnt lgkmcnt(10)
    ds_read_b64_tr_b16 v[62:63], v25 offset:8
    ds_read_b64_tr_b16 v[64:65], v25 offset:2568
    v_mfma_f32_16x16x32_bf16 v[78:81], v[66:69], v[224:227], v[78:81]
    s_waitcnt lgkmcnt(10)
    ds_read_b64_tr_b16 v[66:67], v25 offset:16
    ds_read_b64_tr_b16 v[68:69], v25 offset:2576
    v_mfma_f32_16x16x32_bf16 v[82:85], v[70:73], v[224:227], v[82:85]
    s_waitcnt lgkmcnt(10)
    ds_read_b64_tr_b16 v[70:71], v25 offset:24
    ds_read_b64_tr_b16 v[72:73], v25 offset:2584
    v_mfma_f32_16x16x32_bf16 v[86:89], v[74:77], v[224:227], v[86:89]
    s_waitcnt lgkmcnt(10)
    ds_read_b64_tr_b16 v[74:75], v25 offset:32
    ds_read_b64_tr_b16 v[76:77], v25 offset:2592
    v_mfma_f32_16x16x32_bf16 v[90:93], v[50:53], v[224:227], v[90:93]
    s_waitcnt lgkmcnt(10)
    ds_read_b64_tr_b16 v[50:51], v25 offset:20480
    ds_read_b64_tr_b16 v[52:53], v25 offset:23040
    v_mfma_f32_16x16x32_bf16 v[94:97], v[54:57], v[224:227], v[94:97]
    s_waitcnt lgkmcnt(10)
    ds_read_b64_tr_b16 v[54:55], v25 offset:20488
    ds_read_b64_tr_b16 v[56:57], v25 offset:23048
    v_mfma_f32_16x16x32_bf16 v[78:81], v[58:61], v[228:231], v[78:81]
    s_waitcnt lgkmcnt(10)
    ds_read_b64_tr_b16 v[58:59], v25 offset:20496
    ds_read_b64_tr_b16 v[60:61], v25 offset:23056
    v_mfma_f32_16x16x32_bf16 v[82:85], v[62:65], v[228:231], v[82:85]
    s_waitcnt lgkmcnt(10)
    ds_read_b64_tr_b16 v[62:63], v25 offset:20504
    ds_read_b64_tr_b16 v[64:65], v25 offset:23064
    v_mfma_f32_16x16x32_bf16 v[86:89], v[66:69], v[228:231], v[86:89]
    s_waitcnt lgkmcnt(10)
    ds_read_b64_tr_b16 v[66:67], v25 offset:20512
    ds_read_b64_tr_b16 v[68:69], v25 offset:23072
    v_mfma_f32_16x16x32_bf16 v[90:93], v[70:73], v[228:231], v[90:93]
    s_waitcnt lgkmcnt(10)
    ds_read_b64_tr_b16 v[70:71], v24 offset:0
    ds_read_b64_tr_b16 v[72:73], v24 offset:2560
    v_mfma_f32_16x16x32_bf16 v[94:97], v[74:77], v[228:231], v[94:97]
    s_waitcnt lgkmcnt(10)
    ds_read_b64_tr_b16 v[74:75], v24 offset:8
    ds_read_b64_tr_b16 v[76:77], v24 offset:2568
    v_mfma_f32_16x16x32_bf16 v[78:81], v[50:53], v[232:235], v[78:81]
    s_waitcnt lgkmcnt(10)
    ds_read_b64_tr_b16 v[50:51], v24 offset:16
    ds_read_b64_tr_b16 v[52:53], v24 offset:2576
    v_mfma_f32_16x16x32_bf16 v[82:85], v[54:57], v[232:235], v[82:85]
    s_waitcnt lgkmcnt(10)
    ds_read_b64_tr_b16 v[54:55], v24 offset:24
    ds_read_b64_tr_b16 v[56:57], v24 offset:2584
    v_mfma_f32_16x16x32_bf16 v[86:89], v[58:61], v[232:235], v[86:89]
    s_waitcnt lgkmcnt(10)
    ds_read_b64_tr_b16 v[58:59], v24 offset:32
    ds_read_b64_tr_b16 v[60:61], v24 offset:2592
    v_mfma_f32_16x16x32_bf16 v[90:93], v[62:65], v[232:235], v[90:93]
    s_nop 0
.p2align 3
    ds_read_b64_tr_b16 v[156:157], v28 offset:36864
    ds_read_b64_tr_b16 v[158:159], v28 offset:36896
    ds_read_b64_tr_b16 v[160:161], v28 offset:37024
    ds_read_b64_tr_b16 v[162:163], v28 offset:37056
    ds_read_b64_tr_b16 v[164:165], v28 offset:37184
    ds_read_b64_tr_b16 v[166:167], v28 offset:37216
    ds_read_b64_tr_b16 v[168:169], v28 offset:37344
    ds_read_b64_tr_b16 v[170:171], v28 offset:37376
    ds_read_b64_tr_b16 v[172:173], v28 offset:37504
    ds_read_b64_tr_b16 v[174:175], v28 offset:37536
    s_barrier
    ds_read_b64_tr_b16 v[62:63], v24 offset:5120
    ds_read_b64_tr_b16 v[64:65], v24 offset:7680
    s_waitcnt lgkmcnt(15)
    v_mfma_f32_16x16x32_bf16 v[94:97], v[66:69], v[232:235], v[94:97]
    s_nop 0
    ds_read_b64_tr_b16 v[66:67], v24 offset:5128
    ds_read_b64_tr_b16 v[68:69], v24 offset:7688
    v_mfma_f32_16x16x32_bf16 v[78:81], v[70:73], v[236:239], v[78:81]
    s_nop 0
    ds_read_b64_tr_b16 v[70:71], v24 offset:5136
    ds_read_b64_tr_b16 v[72:73], v24 offset:7696
    v_mfma_f32_16x16x32_bf16 v[82:85], v[74:77], v[236:239], v[82:85]
    s_nop 0
    ds_read_b64_tr_b16 v[74:75], v24 offset:5144
    ds_read_b64_tr_b16 v[76:77], v24 offset:7704
    v_mfma_f32_16x16x32_bf16 v[86:89], v[50:53], v[236:239], v[86:89]
    s_waitcnt lgkmcnt(13)
    ds_read_b64_tr_b16 v[50:51], v24 offset:5152
    ds_read_b64_tr_b16 v[52:53], v24 offset:7712
    v_mfma_f32_16x16x32_bf16 v[90:93], v[54:57], v[236:239], v[90:93]
    s_nop 0
    ds_read_b64_tr_b16 v[54:55], v24 offset:10240
    ds_read_b64_tr_b16 v[56:57], v24 offset:12800
    v_mfma_f32_16x16x32_bf16 v[94:97], v[58:61], v[236:239], v[94:97]
    s_waitcnt lgkmcnt(10)
    ds_read_b64_tr_b16 v[58:59], v24 offset:10248
    ds_read_b64_tr_b16 v[60:61], v24 offset:12808
    v_mfma_f32_16x16x32_bf16 v[78:81], v[62:65], v[240:243], v[78:81]
    s_waitcnt lgkmcnt(10)
    ds_read_b64_tr_b16 v[62:63], v24 offset:10256
    ds_read_b64_tr_b16 v[64:65], v24 offset:12816
    v_mfma_f32_16x16x32_bf16 v[82:85], v[66:69], v[240:243], v[82:85]
    s_waitcnt lgkmcnt(10)
    ds_read_b64_tr_b16 v[66:67], v24 offset:10264
    ds_read_b64_tr_b16 v[68:69], v24 offset:12824
    v_mfma_f32_16x16x32_bf16 v[86:89], v[70:73], v[240:243], v[86:89]
    s_waitcnt lgkmcnt(10)
    ds_read_b64_tr_b16 v[70:71], v24 offset:10272
    ds_read_b64_tr_b16 v[72:73], v24 offset:12832
    v_mfma_f32_16x16x32_bf16 v[90:93], v[74:77], v[240:243], v[90:93]
    s_waitcnt lgkmcnt(10)
    ds_read_b64_tr_b16 v[74:75], v24 offset:15360
    ds_read_b64_tr_b16 v[76:77], v24 offset:17920
    v_mfma_f32_16x16x32_bf16 v[94:97], v[50:53], v[240:243], v[94:97]
    s_waitcnt lgkmcnt(10)
    ds_read_b64_tr_b16 v[50:51], v24 offset:15368
    ds_read_b64_tr_b16 v[52:53], v24 offset:17928
    v_mfma_f32_16x16x32_bf16 v[78:81], v[54:57], v[244:247], v[78:81]
    s_waitcnt lgkmcnt(10)
    ds_read_b64_tr_b16 v[54:55], v24 offset:15376
    ds_read_b64_tr_b16 v[56:57], v24 offset:17936
    v_mfma_f32_16x16x32_bf16 v[82:85], v[58:61], v[244:247], v[82:85]
    s_waitcnt lgkmcnt(10)
    ds_read_b64_tr_b16 v[58:59], v24 offset:15384
    ds_read_b64_tr_b16 v[60:61], v24 offset:17944
    v_mfma_f32_16x16x32_bf16 v[86:89], v[62:65], v[244:247], v[86:89]
    s_waitcnt lgkmcnt(10)
    ds_read_b64_tr_b16 v[62:63], v24 offset:15392
    ds_read_b64_tr_b16 v[64:65], v24 offset:17952
    v_mfma_f32_16x16x32_bf16 v[90:93], v[66:69], v[244:247], v[90:93]
    s_waitcnt lgkmcnt(10)
    ds_read_b64_tr_b16 v[66:67], v24 offset:20480
    ds_read_b64_tr_b16 v[68:69], v24 offset:23040
    v_mfma_f32_16x16x32_bf16 v[94:97], v[70:73], v[244:247], v[94:97]
    s_waitcnt lgkmcnt(10)
    ds_read_b64_tr_b16 v[70:71], v24 offset:20488
    ds_read_b64_tr_b16 v[72:73], v24 offset:23048
    v_mfma_f32_16x16x32_bf16 v[78:81], v[74:77], v[248:251], v[78:81]
    s_waitcnt lgkmcnt(10)
    ds_read_b64_tr_b16 v[74:75], v24 offset:20496
    ds_read_b64_tr_b16 v[76:77], v24 offset:23056
    v_mfma_f32_16x16x32_bf16 v[82:85], v[50:53], v[248:251], v[82:85]
    s_waitcnt lgkmcnt(10)
    ds_read_b64_tr_b16 v[50:51], v24 offset:20504
    ds_read_b64_tr_b16 v[52:53], v24 offset:23064
    v_mfma_f32_16x16x32_bf16 v[86:89], v[54:57], v[248:251], v[86:89]
    s_waitcnt lgkmcnt(10)
    ds_read_b64_tr_b16 v[54:55], v24 offset:20512
    ds_read_b64_tr_b16 v[56:57], v24 offset:23072
    v_mfma_f32_16x16x32_bf16 v[90:93], v[58:61], v[248:251], v[90:93]
    s_waitcnt lgkmcnt(10)
    v_mfma_f32_16x16x32_bf16 v[94:97], v[62:65], v[248:251], v[94:97]
    s_waitcnt lgkmcnt(8)
    v_mfma_f32_16x16x32_bf16 v[78:81], v[66:69], v[252:255], v[78:81]
    s_waitcnt lgkmcnt(6)
    v_mfma_f32_16x16x32_bf16 v[82:85], v[70:73], v[252:255], v[82:85]
    s_waitcnt lgkmcnt(4)
    v_mfma_f32_16x16x32_bf16 v[86:89], v[74:77], v[252:255], v[86:89]
    s_waitcnt lgkmcnt(0)
    v_mfma_f32_16x16x32_bf16 v[90:93], v[50:53], v[252:255], v[90:93]
    s_barrier
    v_mfma_f32_16x16x32_bf16 v[94:97], v[54:57], v[252:255], v[94:97]
    s_mov_b32 s58, 0x3fb8aa3b
    s_mov_b32 s59, 0x3fb8aa3b
    s_mov_b32 s60, 0xbfb8aa3b
    s_mov_b32 s61, 0xbfb8aa3b
.p2align 3
    v_cvt_pk_bf16_f32 v98, v78, v79
    v_cvt_pk_bf16_f32 v99, v80, v81
    v_cvt_pk_bf16_f32 v100, v82, v83
    v_cvt_pk_bf16_f32 v101, v84, v85
    v_cvt_pk_bf16_f32 v102, v86, v87
    v_cvt_pk_bf16_f32 v103, v88, v89
    v_cvt_pk_bf16_f32 v104, v90, v91
    v_cvt_pk_bf16_f32 v105, v92, v93
    v_cvt_pk_bf16_f32 v106, v94, v95
    v_cvt_pk_bf16_f32 v107, v96, v97
    v_mfma_f32_4x4x4_16b_bf16 v[78:81], v[156:157], v[98:99], 0 cbsz:2 abid:0
    v_mfma_f32_4x4x4_16b_bf16 v[82:85], v[156:157], v[98:99], 0 cbsz:2 abid:1
    v_mfma_f32_4x4x4_16b_bf16 v[86:89], v[156:157], v[98:99], 0 cbsz:2 abid:2
    v_mfma_f32_4x4x4_16b_bf16 v[90:93], v[156:157], v[98:99], 0 cbsz:2 abid:3
    v_mfma_f32_4x4x4_16b_bf16 v[94:97], v[158:159], v[98:99], 0 cbsz:2 abid:0
    v_mfma_f32_4x4x4_16b_bf16 v[78:81], v[160:161], v[100:101], v[78:81] cbsz:2 abid:0
    v_mfma_f32_4x4x4_16b_bf16 v[82:85], v[160:161], v[100:101], v[82:85] cbsz:2 abid:1
    v_mfma_f32_4x4x4_16b_bf16 v[86:89], v[160:161], v[100:101], v[86:89] cbsz:2 abid:2
    v_mfma_f32_4x4x4_16b_bf16 v[90:93], v[160:161], v[100:101], v[90:93] cbsz:2 abid:3
    v_mfma_f32_4x4x4_16b_bf16 v[94:97], v[162:163], v[100:101], v[94:97] cbsz:2 abid:0
    v_mfma_f32_4x4x4_16b_bf16 v[78:81], v[164:165], v[102:103], v[78:81] cbsz:2 abid:0
    v_mfma_f32_4x4x4_16b_bf16 v[82:85], v[164:165], v[102:103], v[82:85] cbsz:2 abid:1
    v_mfma_f32_4x4x4_16b_bf16 v[86:89], v[164:165], v[102:103], v[86:89] cbsz:2 abid:2
    v_mfma_f32_4x4x4_16b_bf16 v[90:93], v[164:165], v[102:103], v[90:93] cbsz:2 abid:3
    v_mfma_f32_4x4x4_16b_bf16 v[94:97], v[166:167], v[102:103], v[94:97] cbsz:2 abid:0
    v_mfma_f32_4x4x4_16b_bf16 v[78:81], v[168:169], v[104:105], v[78:81] cbsz:2 abid:0
    v_mfma_f32_4x4x4_16b_bf16 v[82:85], v[168:169], v[104:105], v[82:85] cbsz:2 abid:1
    v_mfma_f32_4x4x4_16b_bf16 v[86:89], v[168:169], v[104:105], v[86:89] cbsz:2 abid:2
    v_mfma_f32_4x4x4_16b_bf16 v[90:93], v[168:169], v[104:105], v[90:93] cbsz:2 abid:3
    v_mfma_f32_4x4x4_16b_bf16 v[94:97], v[170:171], v[104:105], v[94:97] cbsz:2 abid:0
    v_mfma_f32_4x4x4_16b_bf16 v[78:81], v[172:173], v[106:107], v[78:81] cbsz:2 abid:0
    v_mfma_f32_4x4x4_16b_bf16 v[82:85], v[172:173], v[106:107], v[82:85] cbsz:2 abid:1
    v_mfma_f32_4x4x4_16b_bf16 v[86:89], v[172:173], v[106:107], v[86:89] cbsz:2 abid:2
    v_mfma_f32_4x4x4_16b_bf16 v[90:93], v[172:173], v[106:107], v[90:93] cbsz:2 abid:3
    v_mfma_f32_4x4x4_16b_bf16 v[94:97], v[174:175], v[106:107], v[94:97] cbsz:2 abid:0
s_nop 0
    v_max_f32 v70, v78, v79
    v_min_f32 v72, v78, v79
.p2align 3
    v_max3_f32 v70, v70, v80, v81
    v_min3_f32 v72, v72, v80, v81
    v_max3_f32 v70, v70, v82, v83
    v_min3_f32 v72, v72, v82, v83
    v_max3_f32 v70, v70, v84, v85
    v_min3_f32 v72, v72, v84, v85
    v_max3_f32 v70, v70, v86, v87
    v_min3_f32 v72, v72, v86, v87
    v_max3_f32 v70, v70, v88, v89
    v_min3_f32 v72, v72, v88, v89
    v_max3_f32 v70, v70, v90, v91
    v_min3_f32 v72, v72, v90, v91
    v_max3_f32 v70, v70, v92, v93
    v_min3_f32 v72, v72, v92, v93
    v_max3_f32 v70, v70, v94, v95
    v_min3_f32 v72, v72, v94, v95
    v_max3_f32 v70, v70, v96, v97
    v_min3_f32 v72, v72, v96, v97
    v_mul_f32 v70, s60, v70
    v_mul_f32 v72, s58, v72
.p2align 3
    v_pk_fma_f32 v[50:51], v[78:79], s[58:59], v[70:71] op_sel_hi:[1,1,0]
    v_pk_fma_f32 v[78:79], v[78:79], s[60:61], v[72:73] op_sel_hi:[1,1,0]
    v_pk_fma_f32 v[52:53], v[80:81], s[58:59], v[70:71] op_sel_hi:[1,1,0]
    v_pk_fma_f32 v[80:81], v[80:81], s[60:61], v[72:73] op_sel_hi:[1,1,0]
    v_pk_fma_f32 v[54:55], v[82:83], s[58:59], v[70:71] op_sel_hi:[1,1,0]
    v_pk_fma_f32 v[82:83], v[82:83], s[60:61], v[72:73] op_sel_hi:[1,1,0]
    v_pk_fma_f32 v[56:57], v[84:85], s[58:59], v[70:71] op_sel_hi:[1,1,0]
    v_pk_fma_f32 v[84:85], v[84:85], s[60:61], v[72:73] op_sel_hi:[1,1,0]
    v_pk_fma_f32 v[58:59], v[86:87], s[58:59], v[70:71] op_sel_hi:[1,1,0]
    v_pk_fma_f32 v[86:87], v[86:87], s[60:61], v[72:73] op_sel_hi:[1,1,0]
    v_pk_fma_f32 v[60:61], v[88:89], s[58:59], v[70:71] op_sel_hi:[1,1,0]
    v_pk_fma_f32 v[88:89], v[88:89], s[60:61], v[72:73] op_sel_hi:[1,1,0]
    v_pk_fma_f32 v[62:63], v[90:91], s[58:59], v[70:71] op_sel_hi:[1,1,0]
    v_pk_fma_f32 v[90:91], v[90:91], s[60:61], v[72:73] op_sel_hi:[1,1,0]
    v_pk_fma_f32 v[64:65], v[92:93], s[58:59], v[70:71] op_sel_hi:[1,1,0]
    v_pk_fma_f32 v[92:93], v[92:93], s[60:61], v[72:73] op_sel_hi:[1,1,0]
    v_pk_fma_f32 v[66:67], v[94:95], s[58:59], v[70:71] op_sel_hi:[1,1,0]
    v_pk_fma_f32 v[94:95], v[94:95], s[60:61], v[72:73] op_sel_hi:[1,1,0]
    v_pk_fma_f32 v[68:69], v[96:97], s[58:59], v[70:71] op_sel_hi:[1,1,0]
    v_pk_fma_f32 v[96:97], v[96:97], s[60:61], v[72:73] op_sel_hi:[1,1,0]
    v_exp_f32 v50, v50
    v_exp_f32 v51, v51
    v_exp_f32 v52, v52
    v_exp_f32 v53, v53
    v_exp_f32 v54, v54
    v_exp_f32 v55, v55
    v_exp_f32 v56, v56
    v_exp_f32 v57, v57
    v_exp_f32 v58, v58
    v_exp_f32 v59, v59
    v_exp_f32 v60, v60
    v_exp_f32 v61, v61
    v_exp_f32 v62, v62
    v_exp_f32 v63, v63
    v_exp_f32 v64, v64
    v_exp_f32 v65, v65
    v_exp_f32 v66, v66
    v_exp_f32 v67, v67
    v_exp_f32 v68, v68
    v_exp_f32 v69, v69
    v_exp_f32 v78, v78
    v_exp_f32 v79, v79
    v_exp_f32 v80, v80
    v_exp_f32 v81, v81
    v_exp_f32 v82, v82
    v_exp_f32 v83, v83
    v_exp_f32 v84, v84
    v_exp_f32 v85, v85
    v_exp_f32 v86, v86
    v_exp_f32 v87, v87
    v_exp_f32 v88, v88
    v_exp_f32 v89, v89
    v_exp_f32 v90, v90
    v_exp_f32 v91, v91
    v_exp_f32 v92, v92
    v_exp_f32 v93, v93
    v_exp_f32 v94, v94
    v_exp_f32 v95, v95
    v_exp_f32 v96, v96
    v_exp_f32 v97, v97
.p2align 3
    v_pk_add_f32 v[70:71], v[50:51], v[52:53]
    v_pk_add_f32 v[72:73], v[78:79], v[80:81]
    v_pk_add_f32 v[70:71], v[70:71], v[54:55]
    v_pk_add_f32 v[72:73], v[72:73], v[82:83]
    v_pk_add_f32 v[70:71], v[70:71], v[56:57]
    v_pk_add_f32 v[72:73], v[72:73], v[84:85]
    v_pk_add_f32 v[70:71], v[70:71], v[58:59]
    v_pk_add_f32 v[72:73], v[72:73], v[86:87]
    v_pk_add_f32 v[70:71], v[70:71], v[60:61]
    v_pk_add_f32 v[72:73], v[72:73], v[88:89]
    v_pk_add_f32 v[70:71], v[70:71], v[62:63]
    v_pk_add_f32 v[72:73], v[72:73], v[90:91]
    v_pk_add_f32 v[70:71], v[70:71], v[64:65]
    v_pk_add_f32 v[72:73], v[72:73], v[92:93]
    v_pk_add_f32 v[70:71], v[70:71], v[66:67]
    v_pk_add_f32 v[72:73], v[72:73], v[94:95]
    v_pk_add_f32 v[70:71], v[70:71], v[68:69]
    v_pk_add_f32 v[72:73], v[72:73], v[96:97]
    v_add_f32 v70, v70, v71
    v_add_f32 v72, v72, v73
    v_rcp_f32 v70, v70
    v_rcp_f32 v72, v72
.p2align 3
    v_pk_mul_f32 v[50:51], v[50:51], v[70:71] op_sel_hi:[1,0]
    v_pk_mul_f32 v[78:79], v[78:79], v[72:73] op_sel_hi:[1,0]
    v_pk_mul_f32 v[52:53], v[52:53], v[70:71] op_sel_hi:[1,0]
    v_pk_mul_f32 v[80:81], v[80:81], v[72:73] op_sel_hi:[1,0]
    v_pk_mul_f32 v[54:55], v[54:55], v[70:71] op_sel_hi:[1,0]
    v_pk_mul_f32 v[82:83], v[82:83], v[72:73] op_sel_hi:[1,0]
    v_pk_mul_f32 v[56:57], v[56:57], v[70:71] op_sel_hi:[1,0]
    v_pk_mul_f32 v[84:85], v[84:85], v[72:73] op_sel_hi:[1,0]
    v_pk_mul_f32 v[58:59], v[58:59], v[70:71] op_sel_hi:[1,0]
    v_pk_mul_f32 v[86:87], v[86:87], v[72:73] op_sel_hi:[1,0]
    v_pk_mul_f32 v[60:61], v[60:61], v[70:71] op_sel_hi:[1,0]
    v_pk_mul_f32 v[88:89], v[88:89], v[72:73] op_sel_hi:[1,0]
    v_pk_mul_f32 v[62:63], v[62:63], v[70:71] op_sel_hi:[1,0]
    v_pk_mul_f32 v[90:91], v[90:91], v[72:73] op_sel_hi:[1,0]
    v_pk_mul_f32 v[64:65], v[64:65], v[70:71] op_sel_hi:[1,0]
    v_pk_mul_f32 v[92:93], v[92:93], v[72:73] op_sel_hi:[1,0]
    v_pk_mul_f32 v[66:67], v[66:67], v[70:71] op_sel_hi:[1,0]
    v_pk_mul_f32 v[94:95], v[94:95], v[72:73] op_sel_hi:[1,0]
    v_pk_mul_f32 v[68:69], v[68:69], v[70:71] op_sel_hi:[1,0]
    v_pk_mul_f32 v[96:97], v[96:97], v[72:73] op_sel_hi:[1,0]
    v_cvt_pk_bf16_f32 v98, v50, v51
    v_cvt_pk_bf16_f32 v108, v78, v79
    v_cvt_pk_bf16_f32 v99, v52, v53
    v_cvt_pk_bf16_f32 v109, v80, v81
    v_cvt_pk_bf16_f32 v100, v54, v55
    v_cvt_pk_bf16_f32 v110, v82, v83
    v_cvt_pk_bf16_f32 v101, v56, v57
    v_cvt_pk_bf16_f32 v111, v84, v85
    v_cvt_pk_bf16_f32 v102, v58, v59
    v_cvt_pk_bf16_f32 v112, v86, v87
    v_cvt_pk_bf16_f32 v103, v60, v61
    v_cvt_pk_bf16_f32 v113, v88, v89
    v_cvt_pk_bf16_f32 v104, v62, v63
    v_cvt_pk_bf16_f32 v114, v90, v91
    v_cvt_pk_bf16_f32 v105, v64, v65
    v_cvt_pk_bf16_f32 v115, v92, v93
    v_cvt_pk_bf16_f32 v106, v66, v67
    v_cvt_pk_bf16_f32 v116, v94, v95
    v_cvt_pk_bf16_f32 v107, v68, v69
    v_cvt_pk_bf16_f32 v117, v96, v97
    ds_write_b128 v29, v[98:101] offset:0
    ds_write_b128 v29, v[102:105] offset:16
    ds_write_b128 v29, v[106:109] offset:32
    ds_write_b128 v29, v[110:113] offset:48
    ds_write_b128 v29, v[114:117] offset:64
    s_barrier
.p2align 3
    ds_read_b64_tr_b16 v[50:51], v24 offset:25600
    ds_read_b64_tr_b16 v[52:53], v24 offset:28160
    ds_read_b64_tr_b16 v[54:55], v24 offset:25608
    ds_read_b64_tr_b16 v[56:57], v24 offset:28168
    ds_read_b64_tr_b16 v[58:59], v24 offset:25616
    ds_read_b64_tr_b16 v[60:61], v24 offset:28176
    ds_read_b64_tr_b16 v[62:63], v24 offset:25624
    ds_read_b64_tr_b16 v[64:65], v24 offset:28184
    ds_read_b64_tr_b16 v[66:67], v24 offset:25632
    ds_read_b64_tr_b16 v[68:69], v24 offset:28192
    ds_read_b64_tr_b16 v[70:71], v24 offset:46080
    ds_read_b64_tr_b16 v[72:73], v24 offset:48640
    ds_read_b64_tr_b16 v[74:75], v24 offset:46088
    ds_read_b64_tr_b16 v[76:77], v24 offset:48648
    s_waitcnt lgkmcnt(12)
    v_mfma_f32_16x16x32_bf16 v[78:81], v[50:53], v[176:179], 0
    s_waitcnt lgkmcnt(10)
    ds_read_b64_tr_b16 v[50:51], v24 offset:46096
    ds_read_b64_tr_b16 v[52:53], v24 offset:48656
    v_mfma_f32_16x16x32_bf16 v[82:85], v[54:57], v[176:179], 0
    s_waitcnt lgkmcnt(10)
    ds_read_b64_tr_b16 v[54:55], v24 offset:46104
    ds_read_b64_tr_b16 v[56:57], v24 offset:48664
    v_mfma_f32_16x16x32_bf16 v[86:89], v[58:61], v[176:179], 0
    s_waitcnt lgkmcnt(10)
    ds_read_b64_tr_b16 v[58:59], v24 offset:46112
    ds_read_b64_tr_b16 v[60:61], v24 offset:48672
    v_mfma_f32_16x16x32_bf16 v[90:93], v[62:65], v[176:179], 0
    s_waitcnt lgkmcnt(10)
    ds_read_b64_tr_b16 v[62:63], v25 offset:5120
    ds_read_b64_tr_b16 v[64:65], v25 offset:7680
    v_mfma_f32_16x16x32_bf16 v[94:97], v[66:69], v[176:179], 0
    s_waitcnt lgkmcnt(10)
    ds_read_b64_tr_b16 v[66:67], v25 offset:5128
    ds_read_b64_tr_b16 v[68:69], v25 offset:7688
    v_mfma_f32_16x16x32_bf16 v[78:81], v[70:73], v[180:183], v[78:81]
    s_waitcnt lgkmcnt(10)
    ds_read_b64_tr_b16 v[70:71], v25 offset:5136
    ds_read_b64_tr_b16 v[72:73], v25 offset:7696
    v_mfma_f32_16x16x32_bf16 v[82:85], v[74:77], v[180:183], v[82:85]
    s_waitcnt lgkmcnt(10)
    ds_read_b64_tr_b16 v[74:75], v25 offset:5144
    ds_read_b64_tr_b16 v[76:77], v25 offset:7704
    v_mfma_f32_16x16x32_bf16 v[86:89], v[50:53], v[180:183], v[86:89]
    s_waitcnt lgkmcnt(10)
    ds_read_b64_tr_b16 v[50:51], v25 offset:5152
    ds_read_b64_tr_b16 v[52:53], v25 offset:7712
    v_mfma_f32_16x16x32_bf16 v[90:93], v[54:57], v[180:183], v[90:93]
    s_waitcnt lgkmcnt(10)
    ds_read_b64_tr_b16 v[54:55], v25 offset:25600
    ds_read_b64_tr_b16 v[56:57], v25 offset:28160
    v_mfma_f32_16x16x32_bf16 v[94:97], v[58:61], v[180:183], v[94:97]
    s_waitcnt lgkmcnt(10)
    ds_read_b64_tr_b16 v[58:59], v25 offset:25608
    ds_read_b64_tr_b16 v[60:61], v25 offset:28168
    v_mfma_f32_16x16x32_bf16 v[78:81], v[62:65], v[184:187], v[78:81]
    s_waitcnt lgkmcnt(10)
    ds_read_b64_tr_b16 v[62:63], v25 offset:25616
    ds_read_b64_tr_b16 v[64:65], v25 offset:28176
    v_mfma_f32_16x16x32_bf16 v[82:85], v[66:69], v[184:187], v[82:85]
    s_waitcnt lgkmcnt(10)
    ds_read_b64_tr_b16 v[66:67], v25 offset:25624
    ds_read_b64_tr_b16 v[68:69], v25 offset:28184
    v_mfma_f32_16x16x32_bf16 v[86:89], v[70:73], v[184:187], v[86:89]
    s_waitcnt lgkmcnt(10)
    ds_read_b64_tr_b16 v[70:71], v25 offset:25632
    ds_read_b64_tr_b16 v[72:73], v25 offset:28192
    v_mfma_f32_16x16x32_bf16 v[90:93], v[74:77], v[184:187], v[90:93]
    s_barrier
    ds_read_b64_tr_b16 v[74:75], v24 offset:30720
    ds_read_b64_tr_b16 v[76:77], v24 offset:33280
    s_waitcnt lgkmcnt(12)
    v_mfma_f32_16x16x32_bf16 v[94:97], v[50:53], v[184:187], v[94:97]
    s_waitcnt lgkmcnt(10)
    ds_read_b64_tr_b16 v[50:51], v24 offset:30728
    ds_read_b64_tr_b16 v[52:53], v24 offset:33288
    v_mfma_f32_16x16x32_bf16 v[78:81], v[54:57], v[188:191], v[78:81]
    s_waitcnt lgkmcnt(10)
    ds_read_b64_tr_b16 v[54:55], v24 offset:30736
    ds_read_b64_tr_b16 v[56:57], v24 offset:33296
    v_mfma_f32_16x16x32_bf16 v[82:85], v[58:61], v[188:191], v[82:85]
    s_waitcnt lgkmcnt(10)
    ds_read_b64_tr_b16 v[58:59], v24 offset:30744
    ds_read_b64_tr_b16 v[60:61], v24 offset:33304
    v_mfma_f32_16x16x32_bf16 v[86:89], v[62:65], v[188:191], v[86:89]
    s_waitcnt lgkmcnt(10)
    ds_read_b64_tr_b16 v[62:63], v24 offset:30752
    ds_read_b64_tr_b16 v[64:65], v24 offset:33312
    v_mfma_f32_16x16x32_bf16 v[90:93], v[66:69], v[188:191], v[90:93]
    s_waitcnt lgkmcnt(10)
    ds_read_b64_tr_b16 v[66:67], v24 offset:51200
    ds_read_b64_tr_b16 v[68:69], v24 offset:53760
    v_mfma_f32_16x16x32_bf16 v[94:97], v[70:73], v[188:191], v[94:97]
    s_waitcnt lgkmcnt(10)
    ds_read_b64_tr_b16 v[70:71], v24 offset:51208
    ds_read_b64_tr_b16 v[72:73], v24 offset:53768
    v_mfma_f32_16x16x32_bf16 v[78:81], v[74:77], v[192:195], v[78:81]
    s_waitcnt lgkmcnt(10)
    ds_read_b64_tr_b16 v[74:75], v24 offset:51216
    ds_read_b64_tr_b16 v[76:77], v24 offset:53776
    v_mfma_f32_16x16x32_bf16 v[82:85], v[50:53], v[192:195], v[82:85]
    s_waitcnt lgkmcnt(10)
    ds_read_b64_tr_b16 v[50:51], v24 offset:51224
    ds_read_b64_tr_b16 v[52:53], v24 offset:53784
    v_mfma_f32_16x16x32_bf16 v[86:89], v[54:57], v[192:195], v[86:89]
    s_waitcnt lgkmcnt(10)
    ds_read_b64_tr_b16 v[54:55], v24 offset:51232
    ds_read_b64_tr_b16 v[56:57], v24 offset:53792
    v_mfma_f32_16x16x32_bf16 v[90:93], v[58:61], v[192:195], v[90:93]
    s_waitcnt lgkmcnt(10)
    ds_read_b64_tr_b16 v[58:59], v25 offset:10240
    ds_read_b64_tr_b16 v[60:61], v25 offset:12800
    v_mfma_f32_16x16x32_bf16 v[94:97], v[62:65], v[192:195], v[94:97]
    s_waitcnt lgkmcnt(10)
    ds_read_b64_tr_b16 v[62:63], v25 offset:10248
    ds_read_b64_tr_b16 v[64:65], v25 offset:12808
    v_mfma_f32_16x16x32_bf16 v[78:81], v[66:69], v[196:199], v[78:81]
    s_waitcnt lgkmcnt(10)
    ds_read_b64_tr_b16 v[66:67], v25 offset:10256
    ds_read_b64_tr_b16 v[68:69], v25 offset:12816
    v_mfma_f32_16x16x32_bf16 v[82:85], v[70:73], v[196:199], v[82:85]
    s_waitcnt lgkmcnt(10)
    ds_read_b64_tr_b16 v[70:71], v25 offset:10264
    ds_read_b64_tr_b16 v[72:73], v25 offset:12824
    v_mfma_f32_16x16x32_bf16 v[86:89], v[74:77], v[196:199], v[86:89]
    s_waitcnt lgkmcnt(10)
    ds_read_b64_tr_b16 v[74:75], v25 offset:10272
    ds_read_b64_tr_b16 v[76:77], v25 offset:12832
    v_mfma_f32_16x16x32_bf16 v[90:93], v[50:53], v[196:199], v[90:93]
    s_waitcnt lgkmcnt(10)
    ds_read_b64_tr_b16 v[50:51], v25 offset:30720
    ds_read_b64_tr_b16 v[52:53], v25 offset:33280
    v_mfma_f32_16x16x32_bf16 v[94:97], v[54:57], v[196:199], v[94:97]
    s_waitcnt lgkmcnt(10)
    ds_read_b64_tr_b16 v[54:55], v25 offset:30728
    ds_read_b64_tr_b16 v[56:57], v25 offset:33288
    v_mfma_f32_16x16x32_bf16 v[78:81], v[58:61], v[200:203], v[78:81]
    s_waitcnt lgkmcnt(10)
    ds_read_b64_tr_b16 v[58:59], v25 offset:30736
    ds_read_b64_tr_b16 v[60:61], v25 offset:33296
    v_mfma_f32_16x16x32_bf16 v[82:85], v[62:65], v[200:203], v[82:85]
    s_waitcnt lgkmcnt(10)
    ds_read_b64_tr_b16 v[62:63], v25 offset:30744
    ds_read_b64_tr_b16 v[64:65], v25 offset:33304
    v_mfma_f32_16x16x32_bf16 v[86:89], v[66:69], v[200:203], v[86:89]
    s_waitcnt lgkmcnt(10)
    ds_read_b64_tr_b16 v[66:67], v25 offset:30752
    ds_read_b64_tr_b16 v[68:69], v25 offset:33312
    v_mfma_f32_16x16x32_bf16 v[90:93], v[70:73], v[200:203], v[90:93]
    s_barrier
    ds_read_b64_tr_b16 v[70:71], v24 offset:35840
    ds_read_b64_tr_b16 v[72:73], v24 offset:38400
    s_waitcnt lgkmcnt(12)
    v_mfma_f32_16x16x32_bf16 v[94:97], v[74:77], v[200:203], v[94:97]
    s_waitcnt lgkmcnt(10)
    ds_read_b64_tr_b16 v[74:75], v24 offset:35848
    ds_read_b64_tr_b16 v[76:77], v24 offset:38408
    v_mfma_f32_16x16x32_bf16 v[78:81], v[50:53], v[204:207], v[78:81]
    s_waitcnt lgkmcnt(10)
    ds_read_b64_tr_b16 v[50:51], v24 offset:35856
    ds_read_b64_tr_b16 v[52:53], v24 offset:38416
    v_mfma_f32_16x16x32_bf16 v[82:85], v[54:57], v[204:207], v[82:85]
    s_waitcnt lgkmcnt(10)
    ds_read_b64_tr_b16 v[54:55], v24 offset:35864
    ds_read_b64_tr_b16 v[56:57], v24 offset:38424
    v_mfma_f32_16x16x32_bf16 v[86:89], v[58:61], v[204:207], v[86:89]
    s_waitcnt lgkmcnt(10)
    ds_read_b64_tr_b16 v[58:59], v24 offset:35872
    ds_read_b64_tr_b16 v[60:61], v24 offset:38432
    v_mfma_f32_16x16x32_bf16 v[90:93], v[62:65], v[204:207], v[90:93]
    s_waitcnt lgkmcnt(10)
    ds_read_b64_tr_b16 v[62:63], v24 offset:56320
    ds_read_b64_tr_b16 v[64:65], v24 offset:58880
    v_mfma_f32_16x16x32_bf16 v[94:97], v[66:69], v[204:207], v[94:97]
    s_waitcnt lgkmcnt(10)
    ds_read_b64_tr_b16 v[66:67], v24 offset:56328
    ds_read_b64_tr_b16 v[68:69], v24 offset:58888
    v_mfma_f32_16x16x32_bf16 v[78:81], v[70:73], v[208:211], v[78:81]
    s_waitcnt lgkmcnt(10)
    ds_read_b64_tr_b16 v[70:71], v24 offset:56336
    ds_read_b64_tr_b16 v[72:73], v24 offset:58896
    v_mfma_f32_16x16x32_bf16 v[82:85], v[74:77], v[208:211], v[82:85]
    s_waitcnt lgkmcnt(10)
    ds_read_b64_tr_b16 v[74:75], v24 offset:56344
    ds_read_b64_tr_b16 v[76:77], v24 offset:58904
    v_mfma_f32_16x16x32_bf16 v[86:89], v[50:53], v[208:211], v[86:89]
    s_waitcnt lgkmcnt(10)
    ds_read_b64_tr_b16 v[50:51], v24 offset:56352
    ds_read_b64_tr_b16 v[52:53], v24 offset:58912
    v_mfma_f32_16x16x32_bf16 v[90:93], v[54:57], v[208:211], v[90:93]
    s_waitcnt lgkmcnt(10)
    ds_read_b64_tr_b16 v[54:55], v25 offset:15360
    ds_read_b64_tr_b16 v[56:57], v25 offset:17920
    v_mfma_f32_16x16x32_bf16 v[94:97], v[58:61], v[208:211], v[94:97]
    s_waitcnt lgkmcnt(10)
    ds_read_b64_tr_b16 v[58:59], v25 offset:15368
    ds_read_b64_tr_b16 v[60:61], v25 offset:17928
    v_mfma_f32_16x16x32_bf16 v[78:81], v[62:65], v[212:215], v[78:81]
    s_waitcnt lgkmcnt(10)
    ds_read_b64_tr_b16 v[62:63], v25 offset:15376
    ds_read_b64_tr_b16 v[64:65], v25 offset:17936
    v_mfma_f32_16x16x32_bf16 v[82:85], v[66:69], v[212:215], v[82:85]
    s_waitcnt lgkmcnt(10)
    ds_read_b64_tr_b16 v[66:67], v25 offset:15384
    ds_read_b64_tr_b16 v[68:69], v25 offset:17944
    v_mfma_f32_16x16x32_bf16 v[86:89], v[70:73], v[212:215], v[86:89]
    s_waitcnt lgkmcnt(10)
    ds_read_b64_tr_b16 v[70:71], v25 offset:15392
    ds_read_b64_tr_b16 v[72:73], v25 offset:17952
    v_mfma_f32_16x16x32_bf16 v[90:93], v[74:77], v[212:215], v[90:93]
    s_waitcnt lgkmcnt(10)
    ds_read_b64_tr_b16 v[74:75], v25 offset:35840
    ds_read_b64_tr_b16 v[76:77], v25 offset:38400
    v_mfma_f32_16x16x32_bf16 v[94:97], v[50:53], v[212:215], v[94:97]
    s_waitcnt lgkmcnt(10)
    ds_read_b64_tr_b16 v[50:51], v25 offset:35848
    ds_read_b64_tr_b16 v[52:53], v25 offset:38408
    v_mfma_f32_16x16x32_bf16 v[78:81], v[54:57], v[216:219], v[78:81]
    s_waitcnt lgkmcnt(10)
    ds_read_b64_tr_b16 v[54:55], v25 offset:35856
    ds_read_b64_tr_b16 v[56:57], v25 offset:38416
    v_mfma_f32_16x16x32_bf16 v[82:85], v[58:61], v[216:219], v[82:85]
    s_waitcnt lgkmcnt(10)
    ds_read_b64_tr_b16 v[58:59], v25 offset:35864
    ds_read_b64_tr_b16 v[60:61], v25 offset:38424
    v_mfma_f32_16x16x32_bf16 v[86:89], v[62:65], v[216:219], v[86:89]
    s_waitcnt lgkmcnt(10)
    ds_read_b64_tr_b16 v[62:63], v25 offset:35872
    ds_read_b64_tr_b16 v[64:65], v25 offset:38432
    v_mfma_f32_16x16x32_bf16 v[90:93], v[66:69], v[216:219], v[90:93]
    s_barrier
    ds_read_b64_tr_b16 v[66:67], v24 offset:40960
    ds_read_b64_tr_b16 v[68:69], v24 offset:43520
    s_waitcnt lgkmcnt(12)
    v_mfma_f32_16x16x32_bf16 v[94:97], v[70:73], v[216:219], v[94:97]
    s_waitcnt lgkmcnt(10)
    ds_read_b64_tr_b16 v[70:71], v24 offset:40968
    ds_read_b64_tr_b16 v[72:73], v24 offset:43528
    v_mfma_f32_16x16x32_bf16 v[78:81], v[74:77], v[220:223], v[78:81]
    s_waitcnt lgkmcnt(10)
    ds_read_b64_tr_b16 v[74:75], v24 offset:40976
    ds_read_b64_tr_b16 v[76:77], v24 offset:43536
    v_mfma_f32_16x16x32_bf16 v[82:85], v[50:53], v[220:223], v[82:85]
    s_waitcnt lgkmcnt(10)
    ds_read_b64_tr_b16 v[50:51], v24 offset:40984
    ds_read_b64_tr_b16 v[52:53], v24 offset:43544
    v_mfma_f32_16x16x32_bf16 v[86:89], v[54:57], v[220:223], v[86:89]
    s_waitcnt lgkmcnt(10)
    ds_read_b64_tr_b16 v[54:55], v24 offset:40992
    ds_read_b64_tr_b16 v[56:57], v24 offset:43552
    v_mfma_f32_16x16x32_bf16 v[90:93], v[58:61], v[220:223], v[90:93]
    s_waitcnt lgkmcnt(10)
    ds_read_b64_tr_b16 v[58:59], v25 offset:0
    ds_read_b64_tr_b16 v[60:61], v25 offset:2560
    v_mfma_f32_16x16x32_bf16 v[94:97], v[62:65], v[220:223], v[94:97]
    s_waitcnt lgkmcnt(10)
    ds_read_b64_tr_b16 v[62:63], v25 offset:8
    ds_read_b64_tr_b16 v[64:65], v25 offset:2568
    v_mfma_f32_16x16x32_bf16 v[78:81], v[66:69], v[224:227], v[78:81]
    s_waitcnt lgkmcnt(10)
    ds_read_b64_tr_b16 v[66:67], v25 offset:16
    ds_read_b64_tr_b16 v[68:69], v25 offset:2576
    v_mfma_f32_16x16x32_bf16 v[82:85], v[70:73], v[224:227], v[82:85]
    s_waitcnt lgkmcnt(10)
    ds_read_b64_tr_b16 v[70:71], v25 offset:24
    ds_read_b64_tr_b16 v[72:73], v25 offset:2584
    v_mfma_f32_16x16x32_bf16 v[86:89], v[74:77], v[224:227], v[86:89]
    s_waitcnt lgkmcnt(10)
    ds_read_b64_tr_b16 v[74:75], v25 offset:32
    ds_read_b64_tr_b16 v[76:77], v25 offset:2592
    v_mfma_f32_16x16x32_bf16 v[90:93], v[50:53], v[224:227], v[90:93]
    s_waitcnt lgkmcnt(10)
    ds_read_b64_tr_b16 v[50:51], v25 offset:20480
    ds_read_b64_tr_b16 v[52:53], v25 offset:23040
    v_mfma_f32_16x16x32_bf16 v[94:97], v[54:57], v[224:227], v[94:97]
    s_waitcnt lgkmcnt(10)
    ds_read_b64_tr_b16 v[54:55], v25 offset:20488
    ds_read_b64_tr_b16 v[56:57], v25 offset:23048
    v_mfma_f32_16x16x32_bf16 v[78:81], v[58:61], v[228:231], v[78:81]
    s_waitcnt lgkmcnt(10)
    ds_read_b64_tr_b16 v[58:59], v25 offset:20496
    ds_read_b64_tr_b16 v[60:61], v25 offset:23056
    v_mfma_f32_16x16x32_bf16 v[82:85], v[62:65], v[228:231], v[82:85]
    s_waitcnt lgkmcnt(10)
    ds_read_b64_tr_b16 v[62:63], v25 offset:20504
    ds_read_b64_tr_b16 v[64:65], v25 offset:23064
    v_mfma_f32_16x16x32_bf16 v[86:89], v[66:69], v[228:231], v[86:89]
    s_waitcnt lgkmcnt(10)
    ds_read_b64_tr_b16 v[66:67], v25 offset:20512
    ds_read_b64_tr_b16 v[68:69], v25 offset:23072
    v_mfma_f32_16x16x32_bf16 v[90:93], v[70:73], v[228:231], v[90:93]
    s_waitcnt lgkmcnt(10)
    ds_read_b64_tr_b16 v[70:71], v24 offset:0
    ds_read_b64_tr_b16 v[72:73], v24 offset:2560
    v_mfma_f32_16x16x32_bf16 v[94:97], v[74:77], v[228:231], v[94:97]
    s_waitcnt lgkmcnt(10)
    ds_read_b64_tr_b16 v[74:75], v24 offset:8
    ds_read_b64_tr_b16 v[76:77], v24 offset:2568
    v_mfma_f32_16x16x32_bf16 v[78:81], v[50:53], v[232:235], v[78:81]
    s_waitcnt lgkmcnt(10)
    ds_read_b64_tr_b16 v[50:51], v24 offset:16
    ds_read_b64_tr_b16 v[52:53], v24 offset:2576
    v_mfma_f32_16x16x32_bf16 v[82:85], v[54:57], v[232:235], v[82:85]
    s_waitcnt lgkmcnt(10)
    ds_read_b64_tr_b16 v[54:55], v24 offset:24
    ds_read_b64_tr_b16 v[56:57], v24 offset:2584
    v_mfma_f32_16x16x32_bf16 v[86:89], v[58:61], v[232:235], v[86:89]
    s_waitcnt lgkmcnt(10)
    ds_read_b64_tr_b16 v[58:59], v24 offset:32
    ds_read_b64_tr_b16 v[60:61], v24 offset:2592
    v_mfma_f32_16x16x32_bf16 v[90:93], v[62:65], v[232:235], v[90:93]
    s_barrier
    ds_read_b64_tr_b16 v[62:63], v24 offset:5120
    ds_read_b64_tr_b16 v[64:65], v24 offset:7680
    s_waitcnt lgkmcnt(12)
    v_mfma_f32_16x16x32_bf16 v[94:97], v[66:69], v[232:235], v[94:97]
    s_waitcnt lgkmcnt(10)
    ds_read_b64_tr_b16 v[66:67], v24 offset:5128
    ds_read_b64_tr_b16 v[68:69], v24 offset:7688
    v_mfma_f32_16x16x32_bf16 v[78:81], v[70:73], v[236:239], v[78:81]
    s_waitcnt lgkmcnt(10)
    ds_read_b64_tr_b16 v[70:71], v24 offset:5136
    ds_read_b64_tr_b16 v[72:73], v24 offset:7696
    v_mfma_f32_16x16x32_bf16 v[82:85], v[74:77], v[236:239], v[82:85]
    s_waitcnt lgkmcnt(10)
    ds_read_b64_tr_b16 v[74:75], v24 offset:5144
    ds_read_b64_tr_b16 v[76:77], v24 offset:7704
    v_mfma_f32_16x16x32_bf16 v[86:89], v[50:53], v[236:239], v[86:89]
    s_waitcnt lgkmcnt(10)
    ds_read_b64_tr_b16 v[50:51], v24 offset:5152
    ds_read_b64_tr_b16 v[52:53], v24 offset:7712
    v_mfma_f32_16x16x32_bf16 v[90:93], v[54:57], v[236:239], v[90:93]
    s_waitcnt lgkmcnt(10)
    ds_read_b64_tr_b16 v[54:55], v24 offset:10240
    ds_read_b64_tr_b16 v[56:57], v24 offset:12800
    v_mfma_f32_16x16x32_bf16 v[94:97], v[58:61], v[236:239], v[94:97]
    s_waitcnt lgkmcnt(10)
    ds_read_b64_tr_b16 v[58:59], v24 offset:10248
    ds_read_b64_tr_b16 v[60:61], v24 offset:12808
    v_mfma_f32_16x16x32_bf16 v[78:81], v[62:65], v[240:243], v[78:81]
    s_waitcnt lgkmcnt(10)
    ds_read_b64_tr_b16 v[62:63], v24 offset:10256
    ds_read_b64_tr_b16 v[64:65], v24 offset:12816
    v_mfma_f32_16x16x32_bf16 v[82:85], v[66:69], v[240:243], v[82:85]
    s_waitcnt lgkmcnt(10)
    ds_read_b64_tr_b16 v[66:67], v24 offset:10264
    ds_read_b64_tr_b16 v[68:69], v24 offset:12824
    v_mfma_f32_16x16x32_bf16 v[86:89], v[70:73], v[240:243], v[86:89]
    s_waitcnt lgkmcnt(10)
    ds_read_b64_tr_b16 v[70:71], v24 offset:10272
    ds_read_b64_tr_b16 v[72:73], v24 offset:12832
    v_mfma_f32_16x16x32_bf16 v[90:93], v[74:77], v[240:243], v[90:93]
    s_waitcnt lgkmcnt(10)
    ds_read_b64_tr_b16 v[74:75], v24 offset:15360
    ds_read_b64_tr_b16 v[76:77], v24 offset:17920
    v_mfma_f32_16x16x32_bf16 v[94:97], v[50:53], v[240:243], v[94:97]
    s_waitcnt lgkmcnt(10)
    ds_read_b64_tr_b16 v[50:51], v24 offset:15368
    ds_read_b64_tr_b16 v[52:53], v24 offset:17928
    v_mfma_f32_16x16x32_bf16 v[78:81], v[54:57], v[244:247], v[78:81]
    s_waitcnt lgkmcnt(10)
    ds_read_b64_tr_b16 v[54:55], v24 offset:15376
    ds_read_b64_tr_b16 v[56:57], v24 offset:17936
    v_mfma_f32_16x16x32_bf16 v[82:85], v[58:61], v[244:247], v[82:85]
    s_waitcnt lgkmcnt(10)
    ds_read_b64_tr_b16 v[58:59], v24 offset:15384
    ds_read_b64_tr_b16 v[60:61], v24 offset:17944
    v_mfma_f32_16x16x32_bf16 v[86:89], v[62:65], v[244:247], v[86:89]
    s_waitcnt lgkmcnt(10)
    ds_read_b64_tr_b16 v[62:63], v24 offset:15392
    ds_read_b64_tr_b16 v[64:65], v24 offset:17952
    v_mfma_f32_16x16x32_bf16 v[90:93], v[66:69], v[244:247], v[90:93]
    s_waitcnt lgkmcnt(10)
    ds_read_b64_tr_b16 v[66:67], v24 offset:20480
    ds_read_b64_tr_b16 v[68:69], v24 offset:23040
    v_mfma_f32_16x16x32_bf16 v[94:97], v[70:73], v[244:247], v[94:97]
    s_waitcnt lgkmcnt(10)
    ds_read_b64_tr_b16 v[70:71], v24 offset:20488
    ds_read_b64_tr_b16 v[72:73], v24 offset:23048
    v_mfma_f32_16x16x32_bf16 v[78:81], v[74:77], v[248:251], v[78:81]
    s_waitcnt lgkmcnt(10)
    ds_read_b64_tr_b16 v[74:75], v24 offset:20496
    ds_read_b64_tr_b16 v[76:77], v24 offset:23056
    v_mfma_f32_16x16x32_bf16 v[82:85], v[50:53], v[248:251], v[82:85]
    s_waitcnt lgkmcnt(10)
    ds_read_b64_tr_b16 v[50:51], v24 offset:20504
    ds_read_b64_tr_b16 v[52:53], v24 offset:23064
    v_mfma_f32_16x16x32_bf16 v[86:89], v[54:57], v[248:251], v[86:89]
    s_waitcnt lgkmcnt(10)
    ds_read_b64_tr_b16 v[54:55], v24 offset:20512
    ds_read_b64_tr_b16 v[56:57], v24 offset:23072
    v_mfma_f32_16x16x32_bf16 v[90:93], v[58:61], v[248:251], v[90:93]
    s_waitcnt lgkmcnt(10)
    v_mfma_f32_16x16x32_bf16 v[94:97], v[62:65], v[248:251], v[94:97]
    s_waitcnt lgkmcnt(8)
    v_mfma_f32_16x16x32_bf16 v[78:81], v[66:69], v[252:255], v[78:81]
    s_waitcnt lgkmcnt(6)
    v_mfma_f32_16x16x32_bf16 v[82:85], v[70:73], v[252:255], v[82:85]
    s_waitcnt lgkmcnt(4)
    v_mfma_f32_16x16x32_bf16 v[86:89], v[74:77], v[252:255], v[86:89]
    s_waitcnt lgkmcnt(0)
    v_mfma_f32_16x16x32_bf16 v[90:93], v[50:53], v[252:255], v[90:93]
    s_nop 0
.p2align 3
    ds_read_b64_tr_b16 v[128:129], v31 offset:0
    ds_read_b64_tr_b16 v[130:131], v31 offset:5376
    ds_read_b64_tr_b16 v[132:133], v31 offset:8
    ds_read_b64_tr_b16 v[134:135], v31 offset:5384
    ds_read_b64_tr_b16 v[136:137], v32 offset:64
    ds_read_b64_tr_b16 v[138:139], v32 offset:5440
    ds_read_b64_tr_b16 v[140:141], v31 offset:10752
    ds_read_b64_tr_b16 v[142:143], v31 offset:16128
    ds_read_b64_tr_b16 v[144:145], v31 offset:10760
    ds_read_b64_tr_b16 v[146:147], v31 offset:16136
    ds_read_b64_tr_b16 v[148:149], v32 offset:10816
    ds_read_b64_tr_b16 v[150:151], v32 offset:16192
    v_mfma_f32_16x16x32_bf16 v[94:97], v[54:57], v[252:255], v[94:97]
    v_mov_b32 v108, 0x3f80
    v_mov_b32 v109, 0
    s_add_u32 s50, s72, 786432
.p2align 3
    v_cvt_pk_bf16_f32 v98, v78, v79
    v_cvt_pk_bf16_f32 v99, v80, v81
    v_cvt_pk_bf16_f32 v100, v82, v83
    v_cvt_pk_bf16_f32 v101, v84, v85
    ds_write_b128 v30, v[98:101] offset:21504
    v_cvt_pk_bf16_f32 v102, v86, v87
    v_cvt_pk_bf16_f32 v103, v88, v89
    v_cvt_pk_bf16_f32 v104, v90, v91
    v_cvt_pk_bf16_f32 v105, v92, v93
    ds_write_b128 v30, v[102:105] offset:21520
    v_cvt_pk_bf16_f32 v106, v94, v95
    v_cvt_pk_bf16_f32 v107, v96, v97
    ds_write_b128 v30, v[106:109] offset:21536
    v_mov_b32 v10, 1
    s_mov_b64 exec, 1
    ds_write_b32 v11, v10 offset:0
    s_mov_b64 exec, -1
    s_mov_b32 s7, 4194304
L_lsp_3:
    ds_read_b32 v7, v12 offset:0
    s_sub_u32 s7, s7, 1
    s_waitcnt lgkmcnt(0)
    s_cbranch_scc1 L_lok_4
    v_cmp_gt_u32 vcc, 1, v7
    s_cbranch_vccnz L_lsp_3
L_lok_4:
.p2align 3
    ds_read_b64_tr_b16 v[98:99], v33 offset:21504
    ds_read_b64_tr_b16 v[100:101], v33 offset:24832
    ds_read_b64_tr_b16 v[106:107], v33 offset:28160
    ds_read_b64_tr_b16 v[108:109], v33 offset:31488
    ds_read_b64_tr_b16 v[102:103], v33 offset:21536
    ds_read_b64_tr_b16 v[104:105], v33 offset:24864
    ds_read_b64_tr_b16 v[110:111], v33 offset:28192
    ds_read_b64_tr_b16 v[112:113], v33 offset:31520
    s_waitcnt lgkmcnt(6)
    v_mfma_f32_16x16x32_bf16 v[50:53], v[128:131], v[98:101], 0
    v_mfma_f32_16x16x32_bf16 v[54:57], v[132:135], v[98:101], 0
    v_mfma_f32_16x16x32_bf16 v[58:61], v[136:139], v[98:101], 0
    s_waitcnt lgkmcnt(4)
    v_mfma_f32_16x16x32_bf16 v[50:53], v[140:143], v[106:109], v[50:53]
    v_mfma_f32_16x16x32_bf16 v[54:57], v[144:147], v[106:109], v[54:57]
    v_mfma_f32_16x16x32_bf16 v[58:61], v[148:151], v[106:109], v[58:61]
    s_waitcnt lgkmcnt(2)
    v_mfma_f32_16x16x32_bf16 v[62:65], v[128:131], v[102:105], 0
    v_mfma_f32_16x16x32_bf16 v[66:69], v[132:135], v[102:105], 0
    v_mfma_f32_16x16x32_bf16 v[70:73], v[136:139], v[102:105], 0
    s_waitcnt lgkmcnt(0)
    v_mfma_f32_16x16x32_bf16 v[62:65], v[140:143], v[110:113], v[62:65]
    v_mfma_f32_16x16x32_bf16 v[66:69], v[144:147], v[110:113], v[66:69]
    v_mfma_f32_16x16x32_bf16 v[70:73], v[148:151], v[110:113], v[70:73]
.p2align 3
    v_cvt_pk_bf16_f32 v128, v50, v51
    v_cvt_pk_bf16_f32 v129, v52, v53
    v_cvt_pk_bf16_f32 v130, v54, v55
    v_cvt_pk_bf16_f32 v131, v56, v57
    v_cvt_pk_bf16_f32 v132, v58, v59
    v_cvt_pk_bf16_f32 v133, v60, v61
    ds_write_b128 v34, v[128:131] offset:0
    v_cvt_pk_bf16_f32 v136, v62, v63
    v_cvt_pk_bf16_f32 v137, v64, v65
    v_cvt_pk_bf16_f32 v138, v66, v67
    v_cvt_pk_bf16_f32 v139, v68, v69
    v_cvt_pk_bf16_f32 v140, v70, v71
    v_cvt_pk_bf16_f32 v141, v72, v73
    ds_write_b128 v34, v[136:139] offset:1280
    s_mov_b32 exec_hi, 0
    ds_write_b64 v35, v[132:133] offset:64
    ds_write_b64 v35, v[140:141] offset:1344
    s_mov_b32 exec_hi, -1
    ds_read_b128 v[98:101], v38 offset:0
    ds_read_b128 v[102:105], v38 offset:960
    s_waitcnt lgkmcnt(1)
    buffer_store_dwordx4 v[98:101], v39, s[16:19], s72 offen sc1
    s_waitcnt lgkmcnt(0)
    buffer_store_dwordx4 v[102:105], v39, s[16:19], s50 offen sc1
    v_mov_b32 v8, 162816
    s_waitcnt vmcnt(2)
    s_mov_b32 s7, 4194304
L_lsp_5:
    ds_read_b32 v7, v12 offset:16
    s_sub_u32 s7, s7, 1
    s_waitcnt lgkmcnt(0)
    s_cbranch_scc1 L_lok_6
    v_cmp_gt_u32 vcc, 1, v7
    s_cbranch_vccnz L_lsp_5
L_lok_6:
.p2align 3
    ds_read_b128 v[50:53], v26 offset:25600
    ds_read_b128 v[54:57], v26 offset:26624
    ds_read_b128 v[58:61], v26 offset:27648
    ds_read_b128 v[62:65], v26 offset:28672
    ds_read_b128 v[66:69], v26 offset:29696
    ds_read_b128 v[70:73], v26 offset:46080
    ds_read_b128 v[74:77], v26 offset:47104
    s_waitcnt lgkmcnt(6)
    v_mfma_f32_16x16x32_bf16 v[78:81], v[50:53], v[176:179], 0
    s_waitcnt lgkmcnt(5)
    ds_read_b128 v[50:53], v26 offset:48128
    v_mfma_f32_16x16x32_bf16 v[82:85], v[54:57], v[176:179], 0
    s_waitcnt lgkmcnt(5)
    ds_read_b128 v[54:57], v26 offset:49152
    v_mfma_f32_16x16x32_bf16 v[86:89], v[58:61], v[176:179], 0
    s_waitcnt lgkmcnt(5)
    ds_read_b128 v[58:61], v26 offset:50176
    v_mfma_f32_16x16x32_bf16 v[90:93], v[62:65], v[176:179], 0
    s_waitcnt lgkmcnt(5)
    ds_read_b128 v[62:65], v27 offset:5120
    v_mfma_f32_16x16x32_bf16 v[94:97], v[66:69], v[176:179], 0
    s_waitcnt lgkmcnt(5)
    ds_read_b128 v[66:69], v27 offset:6144
    v_mfma_f32_16x16x32_bf16 v[78:81], v[70:73], v[180:183], v[78:81]
    s_waitcnt lgkmcnt(5)
    ds_read_b128 v[70:73], v27 offset:7168
    v_mfma_f32_16x16x32_bf16 v[82:85], v[74:77], v[180:183], v[82:85]
    s_waitcnt lgkmcnt(5)
    ds_read_b128 v[74:77], v27 offset:8192
    v_mfma_f32_16x16x32_bf16 v[86:89], v[50:53], v[180:183], v[86:89]
    s_waitcnt lgkmcnt(5)
    ds_read_b128 v[50:53], v27 offset:9216
    v_mfma_f32_16x16x32_bf16 v[90:93], v[54:57], v[180:183], v[90:93]
    s_waitcnt lgkmcnt(5)
    ds_read_b128 v[54:57], v27 offset:25600
    v_mfma_f32_16x16x32_bf16 v[94:97], v[58:61], v[180:183], v[94:97]
    s_waitcnt lgkmcnt(5)
    ds_read_b128 v[58:61], v27 offset:26624
    v_mfma_f32_16x16x32_bf16 v[78:81], v[62:65], v[184:187], v[78:81]
    s_waitcnt lgkmcnt(5)
    ds_read_b128 v[62:65], v27 offset:27648
    v_mfma_f32_16x16x32_bf16 v[82:85], v[66:69], v[184:187], v[82:85]
    s_waitcnt lgkmcnt(5)
    ds_read_b128 v[66:69], v27 offset:28672
    v_mfma_f32_16x16x32_bf16 v[86:89], v[70:73], v[184:187], v[86:89]
    s_waitcnt lgkmcnt(5)
    ds_read_b128 v[70:73], v27 offset:29696
    v_mfma_f32_16x16x32_bf16 v[90:93], v[74:77], v[184:187], v[90:93]
    s_waitcnt lgkmcnt(5)
    ds_read_b128 v[74:77], v26 offset:30720
    v_mfma_f32_16x16x32_bf16 v[94:97], v[50:53], v[184:187], v[94:97]
    s_waitcnt lgkmcnt(5)
    ds_read_b128 v[50:53], v26 offset:31744
    v_mfma_f32_16x16x32_bf16 v[78:81], v[54:57], v[188:191], v[78:81]
    s_waitcnt lgkmcnt(5)
    ds_read_b128 v[54:57], v26 offset:32768
    v_mfma_f32_16x16x32_bf16 v[82:85], v[58:61], v[188:191], v[82:85]
    s_waitcnt lgkmcnt(5)
    ds_read_b128 v[58:61], v26 offset:33792
    v_mfma_f32_16x16x32_bf16 v[86:89], v[62:65], v[188:191], v[86:89]
    s_waitcnt lgkmcnt(5)
    ds_read_b128 v[62:65], v26 offset:34816
    v_mfma_f32_16x16x32_bf16 v[90:93], v[66:69], v[188:191], v[90:93]
    s_waitcnt lgkmcnt(5)
    ds_read_b128 v[66:69], v26 offset:51200
    v_mfma_f32_16x16x32_bf16 v[94:97], v[70:73], v[188:191], v[94:97]
    s_waitcnt lgkmcnt(5)
    ds_read_b128 v[70:73], v26 offset:52224
    v_mfma_f32_16x16x32_bf16 v[78:81], v[74:77], v[192:195], v[78:81]
    s_waitcnt lgkmcnt(5)
    ds_read_b128 v[74:77], v26 offset:53248
    v_mfma_f32_16x16x32_bf16 v[82:85], v[50:53], v[192:195], v[82:85]
    s_waitcnt lgkmcnt(5)
    ds_read_b128 v[50:53], v26 offset:54272
    v_mfma_f32_16x16x32_bf16 v[86:89], v[54:57], v[192:195], v[86:89]
    s_waitcnt lgkmcnt(5)
    ds_read_b128 v[54:57], v26 offset:55296
    v_mfma_f32_16x16x32_bf16 v[90:93], v[58:61], v[192:195], v[90:93]
    s_waitcnt lgkmcnt(5)
    ds_read_b128 v[58:61], v27 offset:10240
    v_mfma_f32_16x16x32_bf16 v[94:97], v[62:65], v[192:195], v[94:97]
    s_waitcnt lgkmcnt(5)
    ds_read_b128 v[62:65], v27 offset:11264
    v_mfma_f32_16x16x32_bf16 v[78:81], v[66:69], v[196:199], v[78:81]
    s_waitcnt lgkmcnt(5)
    ds_read_b128 v[66:69], v27 offset:12288
    v_mfma_f32_16x16x32_bf16 v[82:85], v[70:73], v[196:199], v[82:85]
    s_waitcnt lgkmcnt(5)
    ds_read_b128 v[70:73], v27 offset:13312
    v_mfma_f32_16x16x32_bf16 v[86:89], v[74:77], v[196:199], v[86:89]
    s_waitcnt lgkmcnt(5)
    ds_read_b128 v[74:77], v27 offset:14336
    v_mfma_f32_16x16x32_bf16 v[90:93], v[50:53], v[196:199], v[90:93]
    s_waitcnt lgkmcnt(5)
    ds_read_b128 v[50:53], v27 offset:30720
    v_mfma_f32_16x16x32_bf16 v[94:97], v[54:57], v[196:199], v[94:97]
    s_waitcnt lgkmcnt(5)
    ds_read_b128 v[54:57], v27 offset:31744
    v_mfma_f32_16x16x32_bf16 v[78:81], v[58:61], v[200:203], v[78:81]
    s_waitcnt lgkmcnt(5)
    ds_read_b128 v[58:61], v27 offset:32768
    v_mfma_f32_16x16x32_bf16 v[82:85], v[62:65], v[200:203], v[82:85]
    s_waitcnt lgkmcnt(5)
    ds_read_b128 v[62:65], v27 offset:33792
    v_mfma_f32_16x16x32_bf16 v[86:89], v[66:69], v[200:203], v[86:89]
    s_waitcnt lgkmcnt(5)
    ds_read_b128 v[66:69], v27 offset:34816
    v_mfma_f32_16x16x32_bf16 v[90:93], v[70:73], v[200:203], v[90:93]
    s_waitcnt lgkmcnt(5)
    ds_read_b128 v[70:73], v26 offset:35840
    v_mfma_f32_16x16x32_bf16 v[94:97], v[74:77], v[200:203], v[94:97]
    s_waitcnt lgkmcnt(5)
    ds_read_b128 v[74:77], v26 offset:36864
    v_mfma_f32_16x16x32_bf16 v[78:81], v[50:53], v[204:207], v[78:81]
    s_waitcnt lgkmcnt(5)
    ds_read_b128 v[50:53], v26 offset:37888
    v_mfma_f32_16x16x32_bf16 v[82:85], v[54:57], v[204:207], v[82:85]
    s_waitcnt lgkmcnt(5)
    ds_read_b128 v[54:57], v26 offset:38912
    v_mfma_f32_16x16x32_bf16 v[86:89], v[58:61], v[204:207], v[86:89]
    s_waitcnt lgkmcnt(5)
    ds_read_b128 v[58:61], v26 offset:39936
    v_mfma_f32_16x16x32_bf16 v[90:93], v[62:65], v[204:207], v[90:93]
    s_waitcnt lgkmcnt(5)
    ds_read_b128 v[62:65], v26 offset:56320
    v_mfma_f32_16x16x32_bf16 v[94:97], v[66:69], v[204:207], v[94:97]
    s_waitcnt lgkmcnt(5)
    ds_read_b128 v[66:69], v26 offset:57344
    v_mfma_f32_16x16x32_bf16 v[78:81], v[70:73], v[208:211], v[78:81]
    s_waitcnt lgkmcnt(5)
    ds_read_b128 v[70:73], v26 offset:58368
    v_mfma_f32_16x16x32_bf16 v[82:85], v[74:77], v[208:211], v[82:85]
    s_waitcnt lgkmcnt(5)
    ds_read_b128 v[74:77], v26 offset:59392
    v_mfma_f32_16x16x32_bf16 v[86:89], v[50:53], v[208:211], v[86:89]
    s_waitcnt lgkmcnt(5)
    ds_read_b128 v[50:53], v26 offset:60416
    v_mfma_f32_16x16x32_bf16 v[90:93], v[54:57], v[208:211], v[90:93]
    s_waitcnt lgkmcnt(5)
    ds_read_b128 v[54:57], v27 offset:15360
    v_mfma_f32_16x16x32_bf16 v[94:97], v[58:61], v[208:211], v[94:97]
    s_waitcnt lgkmcnt(5)
    ds_read_b128 v[58:61], v27 offset:16384
    v_mfma_f32_16x16x32_bf16 v[78:81], v[62:65], v[212:215], v[78:81]
    s_waitcnt lgkmcnt(5)
    ds_read_b128 v[62:65], v27 offset:17408
    v_mfma_f32_16x16x32_bf16 v[82:85], v[66:69], v[212:215], v[82:85]
    s_waitcnt lgkmcnt(5)
    ds_read_b128 v[66:69], v27 offset:18432
    v_mfma_f32_16x16x32_bf16 v[86:89], v[70:73], v[212:215], v[86:89]
    s_waitcnt lgkmcnt(5)
    ds_read_b32 v7, v12 offset:16
    ds_read_b128 v[70:73], v27 offset:19456
    v_mfma_f32_16x16x32_bf16 v[90:93], v[74:77], v[212:215], v[90:93]
    s_waitcnt lgkmcnt(6)
    ds_read_b128 v[74:77], v27 offset:35840
    v_mfma_f32_16x16x32_bf16 v[94:97], v[50:53], v[212:215], v[94:97]
    s_waitcnt lgkmcnt(6)
    ds_read_b128 v[50:53], v27 offset:36864
    v_mfma_f32_16x16x32_bf16 v[78:81], v[54:57], v[216:219], v[78:81]
    s_waitcnt lgkmcnt(6)
    ds_read_b128 v[54:57], v27 offset:37888
    v_mfma_f32_16x16x32_bf16 v[82:85], v[58:61], v[216:219], v[82:85]
    s_waitcnt lgkmcnt(6)
    ds_read_b128 v[58:61], v27 offset:38912
    v_mfma_f32_16x16x32_bf16 v[86:89], v[62:65], v[216:219], v[86:89]
    s_waitcnt lgkmcnt(6)
    ds_read_b128 v[62:65], v27 offset:39936
    v_mfma_f32_16x16x32_bf16 v[90:93], v[66:69], v[216:219], v[90:93]
    s_waitcnt lgkmcnt(6)
    v_cmp_gt_u32 vcc, 2, v7
    s_cbranch_vccnz L_lsp_7
L_lok_8:
    ds_read_b128 v[66:69], v26 offset:40960
    s_waitcnt lgkmcnt(6)
    v_mfma_f32_16x16x32_bf16 v[94:97], v[70:73], v[216:219], v[94:97]
    s_waitcnt lgkmcnt(5)
    ds_read_b128 v[70:73], v26 offset:41984
    v_mfma_f32_16x16x32_bf16 v[78:81], v[74:77], v[220:223], v[78:81]
    s_waitcnt lgkmcnt(5)
    ds_read_b128 v[74:77], v26 offset:43008
    v_mfma_f32_16x16x32_bf16 v[82:85], v[50:53], v[220:223], v[82:85]
    s_waitcnt lgkmcnt(5)
    ds_read_b128 v[50:53], v26 offset:44032
    v_mfma_f32_16x16x32_bf16 v[86:89], v[54:57], v[220:223], v[86:89]
    s_waitcnt lgkmcnt(5)
    ds_read_b128 v[54:57], v26 offset:45056
    v_mfma_f32_16x16x32_bf16 v[90:93], v[58:61], v[220:223], v[90:93]
    s_waitcnt lgkmcnt(5)
    ds_read_b128 v[58:61], v27 offset:0
    v_mfma_f32_16x16x32_bf16 v[94:97], v[62:65], v[220:223], v[94:97]
    s_waitcnt lgkmcnt(5)
    ds_read_b128 v[62:65], v27 offset:1024
    v_mfma_f32_16x16x32_bf16 v[78:81], v[66:69], v[224:227], v[78:81]
    s_waitcnt lgkmcnt(5)
    ds_read_b128 v[66:69], v27 offset:2048
    v_mfma_f32_16x16x32_bf16 v[82:85], v[70:73], v[224:227], v[82:85]
    s_waitcnt lgkmcnt(5)
    ds_read_b128 v[70:73], v27 offset:3072
    v_mfma_f32_16x16x32_bf16 v[86:89], v[74:77], v[224:227], v[86:89]
    s_waitcnt lgkmcnt(5)
    ds_read_b128 v[74:77], v27 offset:4096
    v_mfma_f32_16x16x32_bf16 v[90:93], v[50:53], v[224:227], v[90:93]
    s_waitcnt lgkmcnt(5)
    ds_read_b128 v[50:53], v27 offset:20480
    v_mfma_f32_16x16x32_bf16 v[94:97], v[54:57], v[224:227], v[94:97]
    s_waitcnt lgkmcnt(5)
    ds_read_b128 v[54:57], v27 offset:21504
    v_mfma_f32_16x16x32_bf16 v[78:81], v[58:61], v[228:231], v[78:81]
    s_waitcnt lgkmcnt(5)
    ds_read_b128 v[58:61], v27 offset:22528
    v_mfma_f32_16x16x32_bf16 v[82:85], v[62:65], v[228:231], v[82:85]
    s_waitcnt lgkmcnt(5)
    ds_read_b128 v[62:65], v27 offset:23552
    v_mfma_f32_16x16x32_bf16 v[86:89], v[66:69], v[228:231], v[86:89]
    s_waitcnt lgkmcnt(5)
    ds_read_b128 v[66:69], v27 offset:24576
    v_mfma_f32_16x16x32_bf16 v[90:93], v[70:73], v[228:231], v[90:93]
    s_waitcnt lgkmcnt(5)
    ds_read_b128 v[70:73], v26 offset:0
    v_mfma_f32_16x16x32_bf16 v[94:97], v[74:77], v[228:231], v[94:97]
    s_waitcnt lgkmcnt(5)
    ds_read_b128 v[74:77], v26 offset:1024
    v_mfma_f32_16x16x32_bf16 v[78:81], v[50:53], v[232:235], v[78:81]
    s_waitcnt lgkmcnt(5)
    ds_read_b128 v[50:53], v26 offset:2048
    v_mfma_f32_16x16x32_bf16 v[82:85], v[54:57], v[232:235], v[82:85]
    s_waitcnt lgkmcnt(5)
    ds_read_b128 v[54:57], v26 offset:3072
    v_mfma_f32_16x16x32_bf16 v[86:89], v[58:61], v[232:235], v[86:89]
    s_waitcnt lgkmcnt(5)
    ds_read_b128 v[58:61], v26 offset:4096
    v_mfma_f32_16x16x32_bf16 v[90:93], v[62:65], v[232:235], v[90:93]
    s_waitcnt lgkmcnt(5)
    ds_read_b128 v[62:65], v26 offset:5120
    v_mfma_f32_16x16x32_bf16 v[94:97], v[66:69], v[232:235], v[94:97]
    s_waitcnt lgkmcnt(5)
    ds_read_b128 v[66:69], v26 offset:6144
    v_mfma_f32_16x16x32_bf16 v[78:81], v[70:73], v[236:239], v[78:81]
    s_waitcnt lgkmcnt(5)
    ds_read_b128 v[70:73], v26 offset:7168
    v_mfma_f32_16x16x32_bf16 v[82:85], v[74:77], v[236:239], v[82:85]
    s_waitcnt lgkmcnt(5)
    ds_read_b128 v[74:77], v26 offset:8192
    v_mfma_f32_16x16x32_bf16 v[86:89], v[50:53], v[236:239], v[86:89]
    s_waitcnt lgkmcnt(5)
    ds_read_b128 v[50:53], v26 offset:9216
    v_mfma_f32_16x16x32_bf16 v[90:93], v[54:57], v[236:239], v[90:93]
    s_waitcnt lgkmcnt(5)
    ds_read_b128 v[54:57], v26 offset:10240
    v_mfma_f32_16x16x32_bf16 v[94:97], v[58:61], v[236:239], v[94:97]
    s_waitcnt lgkmcnt(5)
    ds_read_b128 v[58:61], v26 offset:11264
    v_mfma_f32_16x16x32_bf16 v[78:81], v[62:65], v[240:243], v[78:81]
    s_waitcnt lgkmcnt(5)
    ds_read_b128 v[62:65], v26 offset:12288
    v_mfma_f32_16x16x32_bf16 v[82:85], v[66:69], v[240:243], v[82:85]
    s_waitcnt lgkmcnt(5)
    ds_read_b128 v[66:69], v26 offset:13312
    v_mfma_f32_16x16x32_bf16 v[86:89], v[70:73], v[240:243], v[86:89]
    s_waitcnt lgkmcnt(5)
    ds_read_b128 v[70:73], v26 offset:14336
    v_mfma_f32_16x16x32_bf16 v[90:93], v[74:77], v[240:243], v[90:93]
    s_waitcnt lgkmcnt(5)
    ds_read_b128 v[74:77], v26 offset:15360
    v_mfma_f32_16x16x32_bf16 v[94:97], v[50:53], v[240:243], v[94:97]
    s_waitcnt lgkmcnt(5)
    ds_read_b128 v[50:53], v26 offset:16384
    v_mfma_f32_16x16x32_bf16 v[78:81], v[54:57], v[244:247], v[78:81]
    s_waitcnt lgkmcnt(5)
    ds_read_b128 v[54:57], v26 offset:17408
    v_mfma_f32_16x16x32_bf16 v[82:85], v[58:61], v[244:247], v[82:85]
    s_waitcnt lgkmcnt(5)
    ds_read_b128 v[58:61], v26 offset:18432
    v_mfma_f32_16x16x32_bf16 v[86:89], v[62:65], v[244:247], v[86:89]
    s_waitcnt lgkmcnt(5)
    ds_read_b128 v[62:65], v26 offset:19456
    v_mfma_f32_16x16x32_bf16 v[90:93], v[66:69], v[244:247], v[90:93]
    s_waitcnt lgkmcnt(5)
    ds_read_b128 v[66:69], v26 offset:20480
    v_mfma_f32_16x16x32_bf16 v[94:97], v[70:73], v[244:247], v[94:97]
    s_waitcnt lgkmcnt(5)
    ds_read_b128 v[70:73], v26 offset:21504
    v_mfma_f32_16x16x32_bf16 v[78:81], v[74:77], v[248:251], v[78:81]
    s_waitcnt lgkmcnt(5)
    ds_read_b128 v[74:77], v26 offset:22528
    v_mfma_f32_16x16x32_bf16 v[82:85], v[50:53], v[248:251], v[82:85]
    s_waitcnt lgkmcnt(5)
    ds_read_b128 v[50:53], v26 offset:23552
    v_mfma_f32_16x16x32_bf16 v[86:89], v[54:57], v[248:251], v[86:89]
    s_waitcnt lgkmcnt(5)
    ds_read_b128 v[54:57], v26 offset:24576
    v_mfma_f32_16x16x32_bf16 v[90:93], v[58:61], v[248:251], v[90:93]
    s_waitcnt lgkmcnt(5)
    v_mfma_f32_16x16x32_bf16 v[94:97], v[62:65], v[248:251], v[94:97]
    s_waitcnt lgkmcnt(4)
    v_mfma_f32_16x16x32_bf16 v[78:81], v[66:69], v[252:255], v[78:81]
    s_waitcnt lgkmcnt(3)
    v_mfma_f32_16x16x32_bf16 v[82:85], v[70:73], v[252:255], v[82:85]
    s_waitcnt lgkmcnt(2)
    v_mfma_f32_16x16x32_bf16 v[86:89], v[74:77], v[252:255], v[86:89]
    s_waitcnt lgkmcnt(0)
    v_mfma_f32_16x16x32_bf16 v[90:93], v[50:53], v[252:255], v[90:93]
    ds_read_b32 v43, v8 offset:48
    v_mfma_f32_16x16x32_bf16 v[94:97], v[54:57], v[252:255], v[94:97]
    s_and_b32 s49, s4, 1
    s_mul_i32 s49, s49, 24576
    s_sub_u32 s50, 24576, s49
    v_add_u32 v3, s49, v5
    v_add_u32 v4, s50, v5
    v_lshrrev_b32 v7, 5, v1
    v_mul_u32_u24 v7, 24064, v7
    v_add_u32 v7, 2048, v7
    v_add_u32 v36, v7, v5
    s_mov_b32 s58, 0x3fb8aa3b
    s_mov_b32 s59, 0x3fb8aa3b
    s_mov_b32 s60, 0xbfb8aa3b
    s_mov_b32 s61, 0xbfb8aa3b
.p2align 3
    v_cvt_pk_bf16_f32 v98, v78, v79
    v_cvt_pk_bf16_f32 v99, v80, v81
    v_cvt_pk_bf16_f32 v100, v82, v83
    v_cvt_pk_bf16_f32 v101, v84, v85
    v_cvt_pk_bf16_f32 v102, v86, v87
    v_cvt_pk_bf16_f32 v103, v88, v89
    v_cvt_pk_bf16_f32 v104, v90, v91
    v_cvt_pk_bf16_f32 v105, v92, v93
    v_cvt_pk_bf16_f32 v106, v94, v95
    v_cvt_pk_bf16_f32 v107, v96, v97
    s_waitcnt lgkmcnt(0)
    v_mov_b32 v10, 2
    s_mov_b64 exec, 1
    ds_write_b32 v11, v10 offset:0
    s_mov_b64 exec, -1
    v_mfma_f32_4x4x4_16b_bf16 v[78:81], v[156:157], v[98:99], 0 cbsz:2 abid:0
    v_mfma_f32_4x4x4_16b_bf16 v[82:85], v[156:157], v[98:99], 0 cbsz:2 abid:1
    v_mfma_f32_4x4x4_16b_bf16 v[86:89], v[156:157], v[98:99], 0 cbsz:2 abid:2
    v_mfma_f32_4x4x4_16b_bf16 v[90:93], v[156:157], v[98:99], 0 cbsz:2 abid:3
    v_mfma_f32_4x4x4_16b_bf16 v[94:97], v[158:159], v[98:99], 0 cbsz:2 abid:0
    v_mfma_f32_4x4x4_16b_bf16 v[78:81], v[160:161], v[100:101], v[78:81] cbsz:2 abid:0
    v_mfma_f32_4x4x4_16b_bf16 v[82:85], v[160:161], v[100:101], v[82:85] cbsz:2 abid:1
    v_mfma_f32_4x4x4_16b_bf16 v[86:89], v[160:161], v[100:101], v[86:89] cbsz:2 abid:2
    v_mfma_f32_4x4x4_16b_bf16 v[90:93], v[160:161], v[100:101], v[90:93] cbsz:2 abid:3
    v_mfma_f32_4x4x4_16b_bf16 v[94:97], v[162:163], v[100:101], v[94:97] cbsz:2 abid:0
    v_mfma_f32_4x4x4_16b_bf16 v[78:81], v[164:165], v[102:103], v[78:81] cbsz:2 abid:0
    v_mfma_f32_4x4x4_16b_bf16 v[82:85], v[164:165], v[102:103], v[82:85] cbsz:2 abid:1
    v_mfma_f32_4x4x4_16b_bf16 v[86:89], v[164:165], v[102:103], v[86:89] cbsz:2 abid:2
    v_mfma_f32_4x4x4_16b_bf16 v[90:93], v[164:165], v[102:103], v[90:93] cbsz:2 abid:3
    v_mfma_f32_4x4x4_16b_bf16 v[94:97], v[166:167], v[102:103], v[94:97] cbsz:2 abid:0
    v_mfma_f32_4x4x4_16b_bf16 v[78:81], v[168:169], v[104:105], v[78:81] cbsz:2 abid:0
    v_mfma_f32_4x4x4_16b_bf16 v[82:85], v[168:169], v[104:105], v[82:85] cbsz:2 abid:1
    v_mfma_f32_4x4x4_16b_bf16 v[86:89], v[168:169], v[104:105], v[86:89] cbsz:2 abid:2
    v_mfma_f32_4x4x4_16b_bf16 v[90:93], v[168:169], v[104:105], v[90:93] cbsz:2 abid:3
    v_mfma_f32_4x4x4_16b_bf16 v[94:97], v[170:171], v[104:105], v[94:97] cbsz:2 abid:0
    v_mfma_f32_4x4x4_16b_bf16 v[78:81], v[172:173], v[106:107], v[78:81] cbsz:2 abid:0
    v_mfma_f32_4x4x4_16b_bf16 v[82:85], v[172:173], v[106:107], v[82:85] cbsz:2 abid:1
    v_mfma_f32_4x4x4_16b_bf16 v[86:89], v[172:173], v[106:107], v[86:89] cbsz:2 abid:2
    v_mfma_f32_4x4x4_16b_bf16 v[90:93], v[172:173], v[106:107], v[90:93] cbsz:2 abid:3
    v_mfma_f32_4x4x4_16b_bf16 v[94:97], v[174:175], v[106:107], v[94:97] cbsz:2 abid:0
s_nop 0
    v_max_f32 v70, v78, v79
    v_min_f32 v72, v78, v79
.p2align 3
    v_max3_f32 v70, v70, v80, v81
    v_min3_f32 v72, v72, v80, v81
    v_max3_f32 v70, v70, v82, v83
    v_min3_f32 v72, v72, v82, v83
    v_max3_f32 v70, v70, v84, v85
    v_min3_f32 v72, v72, v84, v85
    v_max3_f32 v70, v70, v86, v87
    v_min3_f32 v72, v72, v86, v87
    v_max3_f32 v70, v70, v88, v89
    v_min3_f32 v72, v72, v88, v89
    v_max3_f32 v70, v70, v90, v91
    v_min3_f32 v72, v72, v90, v91
    v_max3_f32 v70, v70, v92, v93
    v_min3_f32 v72, v72, v92, v93
    v_max3_f32 v70, v70, v94, v95
    v_min3_f32 v72, v72, v94, v95
    v_max3_f32 v70, v70, v96, v97
    v_min3_f32 v72, v72, v96, v97
    v_mul_f32 v70, s60, v70
    v_mul_f32 v72, s58, v72
.p2align 3
    v_pk_fma_f32 v[50:51], v[78:79], s[58:59], v[70:71] op_sel_hi:[1,1,0]
    v_pk_fma_f32 v[78:79], v[78:79], s[60:61], v[72:73] op_sel_hi:[1,1,0]
    v_pk_fma_f32 v[52:53], v[80:81], s[58:59], v[70:71] op_sel_hi:[1,1,0]
    v_pk_fma_f32 v[80:81], v[80:81], s[60:61], v[72:73] op_sel_hi:[1,1,0]
    v_pk_fma_f32 v[54:55], v[82:83], s[58:59], v[70:71] op_sel_hi:[1,1,0]
    v_pk_fma_f32 v[82:83], v[82:83], s[60:61], v[72:73] op_sel_hi:[1,1,0]
    v_pk_fma_f32 v[56:57], v[84:85], s[58:59], v[70:71] op_sel_hi:[1,1,0]
    v_pk_fma_f32 v[84:85], v[84:85], s[60:61], v[72:73] op_sel_hi:[1,1,0]
    v_pk_fma_f32 v[58:59], v[86:87], s[58:59], v[70:71] op_sel_hi:[1,1,0]
    v_pk_fma_f32 v[86:87], v[86:87], s[60:61], v[72:73] op_sel_hi:[1,1,0]
    v_pk_fma_f32 v[60:61], v[88:89], s[58:59], v[70:71] op_sel_hi:[1,1,0]
    v_pk_fma_f32 v[88:89], v[88:89], s[60:61], v[72:73] op_sel_hi:[1,1,0]
    v_pk_fma_f32 v[62:63], v[90:91], s[58:59], v[70:71] op_sel_hi:[1,1,0]
    v_pk_fma_f32 v[90:91], v[90:91], s[60:61], v[72:73] op_sel_hi:[1,1,0]
    v_pk_fma_f32 v[64:65], v[92:93], s[58:59], v[70:71] op_sel_hi:[1,1,0]
    v_pk_fma_f32 v[92:93], v[92:93], s[60:61], v[72:73] op_sel_hi:[1,1,0]
    v_pk_fma_f32 v[66:67], v[94:95], s[58:59], v[70:71] op_sel_hi:[1,1,0]
    v_pk_fma_f32 v[94:95], v[94:95], s[60:61], v[72:73] op_sel_hi:[1,1,0]
    v_pk_fma_f32 v[68:69], v[96:97], s[58:59], v[70:71] op_sel_hi:[1,1,0]
    v_pk_fma_f32 v[96:97], v[96:97], s[60:61], v[72:73] op_sel_hi:[1,1,0]
    v_exp_f32 v50, v50
    v_exp_f32 v51, v51
    v_exp_f32 v52, v52
    v_exp_f32 v53, v53
    v_exp_f32 v54, v54
    v_exp_f32 v55, v55
    v_exp_f32 v56, v56
    v_exp_f32 v57, v57
    v_exp_f32 v58, v58
    v_exp_f32 v59, v59
    v_exp_f32 v60, v60
    v_exp_f32 v61, v61
    v_exp_f32 v62, v62
    v_exp_f32 v63, v63
    v_exp_f32 v64, v64
    v_exp_f32 v65, v65
    v_exp_f32 v66, v66
    v_exp_f32 v67, v67
    v_exp_f32 v68, v68
    v_exp_f32 v69, v69
    v_exp_f32 v78, v78
    v_exp_f32 v79, v79
    v_exp_f32 v80, v80
    v_exp_f32 v81, v81
    v_exp_f32 v82, v82
    v_exp_f32 v83, v83
    v_exp_f32 v84, v84
    v_exp_f32 v85, v85
    v_exp_f32 v86, v86
    v_exp_f32 v87, v87
    v_exp_f32 v88, v88
    v_exp_f32 v89, v89
    v_exp_f32 v90, v90
    v_exp_f32 v91, v91
    v_exp_f32 v92, v92
    v_exp_f32 v93, v93
    v_exp_f32 v94, v94
    v_exp_f32 v95, v95
    v_exp_f32 v96, v96
    v_exp_f32 v97, v97
.p2align 3
    v_pk_add_f32 v[70:71], v[50:51], v[52:53]
    v_pk_add_f32 v[72:73], v[78:79], v[80:81]
    v_pk_add_f32 v[70:71], v[70:71], v[54:55]
    v_pk_add_f32 v[72:73], v[72:73], v[82:83]
    v_pk_add_f32 v[70:71], v[70:71], v[56:57]
    v_pk_add_f32 v[72:73], v[72:73], v[84:85]
    v_pk_add_f32 v[70:71], v[70:71], v[58:59]
    v_pk_add_f32 v[72:73], v[72:73], v[86:87]
    v_pk_add_f32 v[70:71], v[70:71], v[60:61]
    v_pk_add_f32 v[72:73], v[72:73], v[88:89]
    v_pk_add_f32 v[70:71], v[70:71], v[62:63]
    v_pk_add_f32 v[72:73], v[72:73], v[90:91]
    v_pk_add_f32 v[70:71], v[70:71], v[64:65]
    v_pk_add_f32 v[72:73], v[72:73], v[92:93]
    v_pk_add_f32 v[70:71], v[70:71], v[66:67]
    v_pk_add_f32 v[72:73], v[72:73], v[94:95]
    v_pk_add_f32 v[70:71], v[70:71], v[68:69]
    v_pk_add_f32 v[72:73], v[72:73], v[96:97]
    v_add_f32 v70, v70, v71
    v_add_f32 v72, v72, v73
    v_rcp_f32 v70, v70
    v_rcp_f32 v72, v72
.p2align 3
    v_pk_mul_f32 v[50:51], v[50:51], v[70:71] op_sel_hi:[1,0]
    v_pk_mul_f32 v[78:79], v[78:79], v[72:73] op_sel_hi:[1,0]
    v_pk_mul_f32 v[52:53], v[52:53], v[70:71] op_sel_hi:[1,0]
    v_pk_mul_f32 v[80:81], v[80:81], v[72:73] op_sel_hi:[1,0]
    v_pk_mul_f32 v[54:55], v[54:55], v[70:71] op_sel_hi:[1,0]
    v_pk_mul_f32 v[82:83], v[82:83], v[72:73] op_sel_hi:[1,0]
    v_pk_mul_f32 v[56:57], v[56:57], v[70:71] op_sel_hi:[1,0]
    v_pk_mul_f32 v[84:85], v[84:85], v[72:73] op_sel_hi:[1,0]
    v_pk_mul_f32 v[58:59], v[58:59], v[70:71] op_sel_hi:[1,0]
    v_pk_mul_f32 v[86:87], v[86:87], v[72:73] op_sel_hi:[1,0]
    v_pk_mul_f32 v[60:61], v[60:61], v[70:71] op_sel_hi:[1,0]
    v_pk_mul_f32 v[88:89], v[88:89], v[72:73] op_sel_hi:[1,0]
    v_pk_mul_f32 v[62:63], v[62:63], v[70:71] op_sel_hi:[1,0]
    v_pk_mul_f32 v[90:91], v[90:91], v[72:73] op_sel_hi:[1,0]
    v_pk_mul_f32 v[64:65], v[64:65], v[70:71] op_sel_hi:[1,0]
    v_pk_mul_f32 v[92:93], v[92:93], v[72:73] op_sel_hi:[1,0]
    v_pk_mul_f32 v[66:67], v[66:67], v[70:71] op_sel_hi:[1,0]
    v_pk_mul_f32 v[94:95], v[94:95], v[72:73] op_sel_hi:[1,0]
    v_pk_mul_f32 v[68:69], v[68:69], v[70:71] op_sel_hi:[1,0]
    v_pk_mul_f32 v[96:97], v[96:97], v[72:73] op_sel_hi:[1,0]
    v_cvt_pk_bf16_f32 v98, v50, v51
    v_cvt_pk_bf16_f32 v108, v78, v79
    v_cvt_pk_bf16_f32 v99, v52, v53
    v_cvt_pk_bf16_f32 v109, v80, v81
    v_cvt_pk_bf16_f32 v100, v54, v55
    v_cvt_pk_bf16_f32 v110, v82, v83
    v_cvt_pk_bf16_f32 v101, v56, v57
    v_cvt_pk_bf16_f32 v111, v84, v85
    v_cvt_pk_bf16_f32 v102, v58, v59
    v_cvt_pk_bf16_f32 v112, v86, v87
    v_cvt_pk_bf16_f32 v103, v60, v61
    v_cvt_pk_bf16_f32 v113, v88, v89
    v_cvt_pk_bf16_f32 v104, v62, v63
    v_cvt_pk_bf16_f32 v114, v90, v91
    v_cvt_pk_bf16_f32 v105, v64, v65
    v_cvt_pk_bf16_f32 v115, v92, v93
    v_cvt_pk_bf16_f32 v106, v66, v67
    v_cvt_pk_bf16_f32 v116, v94, v95
    v_cvt_pk_bf16_f32 v107, v68, v69
    v_cvt_pk_bf16_f32 v117, v96, v97
    v_readfirstlane_b32 s54, v43
    v_mov_b32 v8, 162816
    s_mov_b32 s7, 4194304
L_lsp_9:
    ds_read_b32 v7, v8 offset:32
    s_sub_u32 s7, s7, 1
    s_waitcnt lgkmcnt(0)
    s_cbranch_scc1 L_lok_10
    v_cmp_gt_u32 vcc, 1, v7
    s_cbranch_vccz L_lok_10
    s_sleep 1
    s_branch L_lsp_9
L_lok_10:
    s_mul_i32 s52, s4, 160
    buffer_load_dwordx4 v[24:27], v13, s[36:39], s52 offen offset:0
    s_mul_i32 s52, s4, 160
    buffer_load_dwordx4 v[28:31], v13, s[36:39], s52 offen offset:16
    s_sleep 2
    s_mov_b32 s53, 262144
    s_mov_b32 s58, 0x7fff7fff
    s_mov_b32 s59, 0x7fff7fff
    buffer_load_dwordx4 v[128:131], v5, s[16:19], s73 offen offset:0 sc1
    buffer_load_dwordx4 v[132:135], v5, s[16:19], s73 offen offset:1024 sc1
    s_mul_i32 s52, s4, 160
    buffer_load_dwordx2 v[32:33], v13, s[36:39], s52 offen offset:32
    s_lshl_b32 s52, s4, 2
    s_add_u32 s52, s52, s3
    s_mul_i32 s52, s52, 96
    buffer_load_dwordx2 v[34:35], v40, s[32:35], s52 offen offset:16
    s_waitcnt vmcnt(2)
L_hbf_13:
    v_max3_u32 v7, v128, v129, v130
    v_max3_u32 v8, v132, v133, v134
    v_max3_u32 v7, v7, v131, v135
    v_max_u32 v7, v7, v8
    v_cmp_eq_u32 vcc, -1, v7
    s_cbranch_vccnz L_hbr_11
L_hbx_12:
    s_mov_b64 exec, s[58:59]
    ds_write_b128 v42, v[128:131] offset:0
    ds_write_b128 v42, v[132:135] offset:960
    s_mov_b64 exec, -1
    v_mov_b32 v10, 3
    s_mov_b64 exec, 1
    ds_write_b32 v11, v10 offset:0
    s_mov_b64 exec, -1
    s_mov_b32 s7, 4194304
L_lsp_14:
    ds_read_b32 v7, v12 offset:0
    s_sub_u32 s7, s7, 1
    s_waitcnt lgkmcnt(0)
    s_cbranch_scc1 L_lok_15
    v_cmp_gt_u32 vcc, 3, v7
    s_cbranch_vccnz L_lsp_14
L_lok_15:
.p2align 3
    ds_read_b128 v[128:131], v41 offset:0
    ds_read_b128 v[132:135], v41 offset:1280
    ds_read_b128 v[136:139], v41 offset:16
    ds_read_b128 v[140:143], v41 offset:1296
    ds_read_b128 v[144:147], v41 offset:32
    ds_read_b128 v[148:151], v41 offset:1312
    ds_read_b128 v[152:155], v41 offset:48
    ds_read_b128 v[156:159], v41 offset:1328
    ds_read_b128 v[160:163], v41 offset:64
    ds_read_b128 v[164:167], v41 offset:1344
    s_waitcnt lgkmcnt(8)
    v_mfma_f32_4x4x4_16b_bf16 v[70:73], v[132:133], v[98:99], 0 cbsz:2 abid:1
    v_mfma_f32_4x4x4_16b_bf16 v[50:53], v[128:129], v[98:99], 0 cbsz:2 abid:0
    v_mfma_f32_4x4x4_16b_bf16 v[54:57], v[128:129], v[98:99], 0 cbsz:2 abid:1
    v_mfma_f32_4x4x4_16b_bf16 v[58:61], v[128:129], v[98:99], 0 cbsz:2 abid:2
    v_mfma_f32_4x4x4_16b_bf16 v[62:65], v[128:129], v[98:99], 0 cbsz:2 abid:3
    v_mfma_f32_4x4x4_16b_bf16 v[66:69], v[132:133], v[98:99], 0 cbsz:2 abid:0
    v_mfma_f32_4x4x4_16b_bf16 v[70:73], v[134:135], v[100:101], v[70:73] cbsz:2 abid:1
    v_mfma_f32_4x4x4_16b_bf16 v[50:53], v[130:131], v[100:101], v[50:53] cbsz:2 abid:0
    v_mfma_f32_4x4x4_16b_bf16 v[54:57], v[130:131], v[100:101], v[54:57] cbsz:2 abid:1
    v_mfma_f32_4x4x4_16b_bf16 v[58:61], v[130:131], v[100:101], v[58:61] cbsz:2 abid:2
    v_mfma_f32_4x4x4_16b_bf16 v[62:65], v[130:131], v[100:101], v[62:65] cbsz:2 abid:3
    v_mfma_f32_4x4x4_16b_bf16 v[66:69], v[134:135], v[100:101], v[66:69] cbsz:2 abid:0
    s_waitcnt lgkmcnt(6)
    v_mfma_f32_4x4x4_16b_bf16 v[70:73], v[140:141], v[102:103], v[70:73] cbsz:2 abid:1
    v_mfma_f32_4x4x4_16b_bf16 v[50:53], v[136:137], v[102:103], v[50:53] cbsz:2 abid:0
    v_mfma_f32_4x4x4_16b_bf16 v[54:57], v[136:137], v[102:103], v[54:57] cbsz:2 abid:1
    v_mfma_f32_4x4x4_16b_bf16 v[58:61], v[136:137], v[102:103], v[58:61] cbsz:2 abid:2
    v_mfma_f32_4x4x4_16b_bf16 v[62:65], v[136:137], v[102:103], v[62:65] cbsz:2 abid:3
    v_mfma_f32_4x4x4_16b_bf16 v[66:69], v[140:141], v[102:103], v[66:69] cbsz:2 abid:0
    v_mfma_f32_4x4x4_16b_bf16 v[70:73], v[142:143], v[104:105], v[70:73] cbsz:2 abid:1
    v_mfma_f32_4x4x4_16b_bf16 v[50:53], v[138:139], v[104:105], v[50:53] cbsz:2 abid:0
    v_mfma_f32_4x4x4_16b_bf16 v[54:57], v[138:139], v[104:105], v[54:57] cbsz:2 abid:1
    v_mfma_f32_4x4x4_16b_bf16 v[58:61], v[138:139], v[104:105], v[58:61] cbsz:2 abid:2
    v_mfma_f32_4x4x4_16b_bf16 v[62:65], v[138:139], v[104:105], v[62:65] cbsz:2 abid:3
    v_mfma_f32_4x4x4_16b_bf16 v[66:69], v[142:143], v[104:105], v[66:69] cbsz:2 abid:0
    s_waitcnt lgkmcnt(4)
    v_mfma_f32_4x4x4_16b_bf16 v[70:73], v[148:149], v[106:107], v[70:73] cbsz:2 abid:1
    v_mfma_f32_4x4x4_16b_bf16 v[50:53], v[144:145], v[106:107], v[50:53] cbsz:2 abid:0
    v_mfma_f32_4x4x4_16b_bf16 v[54:57], v[144:145], v[106:107], v[54:57] cbsz:2 abid:1
    v_mfma_f32_4x4x4_16b_bf16 v[58:61], v[144:145], v[106:107], v[58:61] cbsz:2 abid:2
    v_mfma_f32_4x4x4_16b_bf16 v[62:65], v[144:145], v[106:107], v[62:65] cbsz:2 abid:3
    v_mfma_f32_4x4x4_16b_bf16 v[66:69], v[148:149], v[106:107], v[66:69] cbsz:2 abid:0
    v_mfma_f32_4x4x4_16b_bf16 v[70:73], v[150:151], v[108:109], v[70:73] cbsz:2 abid:1
    v_mfma_f32_4x4x4_16b_bf16 v[50:53], v[146:147], v[108:109], v[50:53] cbsz:2 abid:0
    v_mfma_f32_4x4x4_16b_bf16 v[54:57], v[146:147], v[108:109], v[54:57] cbsz:2 abid:1
    v_mfma_f32_4x4x4_16b_bf16 v[58:61], v[146:147], v[108:109], v[58:61] cbsz:2 abid:2
    v_mfma_f32_4x4x4_16b_bf16 v[62:65], v[146:147], v[108:109], v[62:65] cbsz:2 abid:3
    v_mfma_f32_4x4x4_16b_bf16 v[66:69], v[150:151], v[108:109], v[66:69] cbsz:2 abid:0
    s_waitcnt lgkmcnt(2)
    v_mfma_f32_4x4x4_16b_bf16 v[70:73], v[156:157], v[110:111], v[70:73] cbsz:2 abid:1
    v_mfma_f32_4x4x4_16b_bf16 v[50:53], v[152:153], v[110:111], v[50:53] cbsz:2 abid:0
    v_mfma_f32_4x4x4_16b_bf16 v[54:57], v[152:153], v[110:111], v[54:57] cbsz:2 abid:1
    v_mfma_f32_4x4x4_16b_bf16 v[58:61], v[152:153], v[110:111], v[58:61] cbsz:2 abid:2
    v_mfma_f32_4x4x4_16b_bf16 v[62:65], v[152:153], v[110:111], v[62:65] cbsz:2 abid:3
    v_mfma_f32_4x4x4_16b_bf16 v[66:69], v[156:157], v[110:111], v[66:69] cbsz:2 abid:0
    v_mfma_f32_4x4x4_16b_bf16 v[70:73], v[158:159], v[112:113], v[70:73] cbsz:2 abid:1
    v_mfma_f32_4x4x4_16b_bf16 v[50:53], v[154:155], v[112:113], v[50:53] cbsz:2 abid:0
    v_mfma_f32_4x4x4_16b_bf16 v[54:57], v[154:155], v[112:113], v[54:57] cbsz:2 abid:1
    v_mfma_f32_4x4x4_16b_bf16 v[58:61], v[154:155], v[112:113], v[58:61] cbsz:2 abid:2
    v_mfma_f32_4x4x4_16b_bf16 v[62:65], v[154:155], v[112:113], v[62:65] cbsz:2 abid:3
    v_mfma_f32_4x4x4_16b_bf16 v[66:69], v[158:159], v[112:113], v[66:69] cbsz:2 abid:0
    s_waitcnt lgkmcnt(0)
    v_mfma_f32_4x4x4_16b_bf16 v[70:73], v[164:165], v[114:115], v[70:73] cbsz:2 abid:1
    v_mfma_f32_4x4x4_16b_bf16 v[50:53], v[160:161], v[114:115], v[50:53] cbsz:2 abid:0
    v_mfma_f32_4x4x4_16b_bf16 v[54:57], v[160:161], v[114:115], v[54:57] cbsz:2 abid:1
    v_mfma_f32_4x4x4_16b_bf16 v[58:61], v[160:161], v[114:115], v[58:61] cbsz:2 abid:2
    v_mfma_f32_4x4x4_16b_bf16 v[62:65], v[160:161], v[114:115], v[62:65] cbsz:2 abid:3
    v_mfma_f32_4x4x4_16b_bf16 v[66:69], v[164:165], v[114:115], v[66:69] cbsz:2 abid:0
    v_mfma_f32_4x4x4_16b_bf16 v[70:73], v[166:167], v[116:117], v[70:73] cbsz:2 abid:1
    v_mfma_f32_4x4x4_16b_bf16 v[50:53], v[162:163], v[116:117], v[50:53] cbsz:2 abid:0
    v_mfma_f32_4x4x4_16b_bf16 v[54:57], v[162:163], v[116:117], v[54:57] cbsz:2 abid:1
    v_mfma_f32_4x4x4_16b_bf16 v[58:61], v[162:163], v[116:117], v[58:61] cbsz:2 abid:2
    v_mfma_f32_4x4x4_16b_bf16 v[62:65], v[162:163], v[116:117], v[62:65] cbsz:2 abid:3
    v_mfma_f32_4x4x4_16b_bf16 v[66:69], v[166:167], v[116:117], v[66:69] cbsz:2 abid:0
    v_add_f32 v70, 0x358637bd, v70
    v_rcp_f32 v70, v70
s_nop 0
.p2align 3
    v_pk_mul_f32 v[50:51], v[50:51], v[70:71] op_sel_hi:[1,0]
    v_pk_mul_f32 v[52:53], v[52:53], v[70:71] op_sel_hi:[1,0]
    v_pk_mul_f32 v[54:55], v[54:55], v[70:71] op_sel_hi:[1,0]
    v_pk_mul_f32 v[56:57], v[56:57], v[70:71] op_sel_hi:[1,0]
    v_pk_mul_f32 v[58:59], v[58:59], v[70:71] op_sel_hi:[1,0]
    v_pk_mul_f32 v[60:61], v[60:61], v[70:71] op_sel_hi:[1,0]
    v_pk_mul_f32 v[62:63], v[62:63], v[70:71] op_sel_hi:[1,0]
    v_pk_mul_f32 v[64:65], v[64:65], v[70:71] op_sel_hi:[1,0]
    v_pk_mul_f32 v[66:67], v[66:67], v[70:71] op_sel_hi:[1,0]
    v_pk_mul_f32 v[68:69], v[68:69], v[70:71] op_sel_hi:[1,0]
    v_cvt_pk_bf16_f32 v128, v50, v51
    v_cvt_pk_bf16_f32 v129, v52, v53
    v_cvt_pk_bf16_f32 v130, v54, v55
    v_cvt_pk_bf16_f32 v131, v56, v57
    buffer_store_dwordx4 v[128:131], v5, s[16:19], s76 offen offset:0
    v_cvt_pk_bf16_f32 v132, v58, v59
    v_cvt_pk_bf16_f32 v133, v60, v61
    v_cvt_pk_bf16_f32 v134, v62, v63
    v_cvt_pk_bf16_f32 v135, v64, v65
    buffer_store_dwordx4 v[132:135], v5, s[16:19], s76 offen offset:1024
    v_cvt_pk_bf16_f32 v136, v66, v67
    v_cvt_pk_bf16_f32 v137, v68, v69
    v_mov_b32 v138, v136
    v_mov_b32 v139, v137
s_nop 0
    v_permlane32_swap_b32 v136, v138
    v_permlane32_swap_b32 v137, v139
    buffer_load_dwordx4 v[176:179], v5, s[16:19], s64 offen offset:0 sc1
    s_add_u32 s64, s64, 3072
    buffer_load_dwordx4 v[180:183], v5, s[16:19], s64 offen offset:0 sc1
    s_waitcnt vmcnt(2)
    s_mov_b32 s58, -1
    s_mov_b32 s59, 0
    s_mov_b64 exec, s[58:59]
    s_cmp_eq_u32 s54, 0
    s_cbranch_scc1 L_slow_16
    buffer_store_dwordx4 v[136:139], v5, s[16:19], s75 offen
L_back_17:
    s_mov_b64 exec, -1
    s_add_u32 s64, s64, 3072
    buffer_load_dwordx4 v[184:187], v5, s[16:19], s64 offen offset:0 sc1
    s_add_u32 s64, s64, 3072
    buffer_load_dwordx4 v[188:191], v5, s[16:19], s64 offen offset:0 sc1
    s_add_u32 s64, s64, 3072
    buffer_load_dwordx4 v[192:195], v5, s[16:19], s64 offen offset:0 sc1
    s_add_u32 s64, s64, 3072
    buffer_load_dwordx4 v[196:199], v5, s[16:19], s64 offen offset:0 sc1
    v_add_u32 v47, 51200, v5
    s_mov_b32 s7, 4194304
L_lsp_18:
    ds_read_b32 v7, v12 offset:16
    s_sub_u32 s7, s7, 1
    s_waitcnt lgkmcnt(0)
    s_cbranch_scc1 L_lok_19
    v_cmp_gt_u32 vcc, 3, v7
    s_cbranch_vccnz L_lsp_18
L_lok_19:
.p2align 3
    ds_read_b128 v[50:53], v5 offset:0
    ds_read_b128 v[54:57], v5 offset:1024
    ds_read_b128 v[58:61], v5 offset:2048
    ds_read_b128 v[62:65], v5 offset:3072
    ds_read_b128 v[66:69], v5 offset:4096
    ds_read_b128 v[70:73], v5 offset:5120
    ds_read_b128 v[74:77], v5 offset:6144
    v_lshlrev_b32 v78, 16, v14
    v_and_b32 v79, s55, v14
    v_lshlrev_b32 v80, 16, v15
    v_and_b32 v81, s55, v15
    v_lshlrev_b32 v82, 16, v16
    v_and_b32 v83, s55, v16
    v_lshlrev_b32 v84, 16, v17
    v_and_b32 v85, s55, v17
    v_lshlrev_b32 v86, 16, v18
    v_and_b32 v87, s55, v18
    v_lshlrev_b32 v88, 16, v19
    v_and_b32 v89, s55, v19
    v_lshlrev_b32 v90, 16, v20
    v_and_b32 v91, s55, v20
    v_lshlrev_b32 v92, 16, v21
    v_and_b32 v93, s55, v21
    v_lshlrev_b32 v94, 16, v22
    v_and_b32 v95, s55, v22
    v_lshlrev_b32 v96, 16, v23
    v_and_b32 v97, s55, v23
    v_mov_b32 v112, 0
    v_mov_b32 v113, 0
    v_lshlrev_b32 v9, 3, v1
    s_lshl3_add_u32 s75, s5, s4
    s_lshl2_add_u32 s75, s75, s3
    s_lshl_b32 s75, s75, 7
    s_add_u32 s75, s75, 262144
    s_waitcnt lgkmcnt(6)
    v_mfma_f32_16x16x32_bf16 v[78:81], v[50:53], v[128:131], v[78:81]
    s_waitcnt lgkmcnt(5)
    ds_read_b128 v[50:53], v5 offset:7168
    v_mfma_f32_16x16x32_bf16 v[82:85], v[54:57], v[128:131], v[82:85]
    s_waitcnt lgkmcnt(5)
    ds_read_b128 v[54:57], v5 offset:8192
    v_mfma_f32_16x16x32_bf16 v[86:89], v[58:61], v[128:131], v[86:89]
    s_waitcnt lgkmcnt(5)
    ds_read_b128 v[58:61], v5 offset:9216
    v_mfma_f32_16x16x32_bf16 v[90:93], v[62:65], v[128:131], v[90:93]
    s_waitcnt lgkmcnt(5)
    ds_read_b128 v[62:65], v5 offset:20480
    v_mfma_f32_16x16x32_bf16 v[94:97], v[66:69], v[128:131], v[94:97]
    s_waitcnt lgkmcnt(5)
    ds_read_b128 v[66:69], v5 offset:21504
    v_mfma_f32_16x16x32_bf16 v[78:81], v[70:73], v[132:135], v[78:81]
    s_waitcnt lgkmcnt(5)
    ds_read_b128 v[70:73], v5 offset:22528
    v_mfma_f32_16x16x32_bf16 v[82:85], v[74:77], v[132:135], v[82:85]
    s_waitcnt lgkmcnt(5)
    ds_read_b128 v[74:77], v5 offset:23552
    v_mfma_f32_16x16x32_bf16 v[86:89], v[50:53], v[132:135], v[86:89]
    s_waitcnt lgkmcnt(5)
    ds_read_b128 v[50:53], v5 offset:24576
    v_mfma_f32_16x16x32_bf16 v[90:93], v[54:57], v[132:135], v[90:93]
    s_waitcnt lgkmcnt(5)
    ds_read_b128 v[54:57], v5 offset:46080
    v_mfma_f32_16x16x32_bf16 v[94:97], v[58:61], v[132:135], v[94:97]
    s_nop 0
    ds_read_b128 v[58:61], v5 offset:47104
    s_mov_b32 s53, 262144
L_poll_20:
    buffer_load_dwordx4 v[136:139], v36, s[16:19], s82 offen sc1
    buffer_load_dwordx4 v[140:143], v36, s[16:19], s83 offen sc1
    buffer_load_dwordx4 v[144:147], v36, s[16:19], s84 offen sc1
    buffer_load_dwordx4 v[148:151], v36, s[16:19], s85 offen sc1
    s_sub_u32 s53, s53, 1
    s_waitcnt vmcnt(3)
    v_max_u32 v7, v136, v137
    v_max3_u32 v7, v7, v138, v139
    s_waitcnt vmcnt(2)
    v_max3_u32 v7, v7, v140, v141
    v_max3_u32 v7, v7, v142, v143
    s_waitcnt vmcnt(1)
    v_max3_u32 v7, v7, v144, v145
    v_max3_u32 v7, v7, v146, v147
    s_waitcnt vmcnt(0)
    v_max3_u32 v7, v7, v148, v149
    v_max3_u32 v7, v7, v150, v151
    s_cbranch_scc1 L_pollx_21
    v_cmp_eq_u32 vcc, -1, v7
    s_cbranch_vccnz L_poll_20
L_pollx_21:
    s_cmp_eq_u32 s54, 0
    s_cbranch_scc1 L_slow_22
L_back_23:
.p2align 3
    buffer_load_dwordx4 v[152:155], v4, s[16:19], s78 offen offset:0 sc1
    buffer_load_dwordx4 v[156:159], v4, s[16:19], s78 offen offset:1024 sc1
    buffer_load_dwordx4 v[160:163], v3, s[16:19], s79 offen offset:0 sc1
    buffer_load_dwordx4 v[164:167], v3, s[16:19], s79 offen offset:1024 sc1
    buffer_load_dwordx4 v[168:171], v4, s[16:19], s79 offen offset:0 sc1
    buffer_load_dwordx4 v[172:175], v4, s[16:19], s79 offen offset:1024 sc1
    buffer_load_dwordx4 v[128:131], v3, s[16:19], s80 offen offset:0 sc1
    s_waitcnt lgkmcnt(6)
    v_mfma_f32_16x16x32_bf16 v[78:81], v[62:65], v[136:139], v[78:81]
    s_waitcnt lgkmcnt(5)
    ds_read_b128 v[62:65], v5 offset:48128
    buffer_load_dwordx4 v[132:135], v3, s[16:19], s80 offen offset:1024 sc1
    v_mfma_f32_16x16x32_bf16 v[82:85], v[66:69], v[136:139], v[82:85]
    s_waitcnt lgkmcnt(5)
    ds_read_b128 v[66:69], v5 offset:49152
    v_mfma_f32_16x16x32_bf16 v[86:89], v[70:73], v[136:139], v[86:89]
    s_waitcnt lgkmcnt(5)
    ds_read_b128 v[70:73], v5 offset:50176
    v_mfma_f32_16x16x32_bf16 v[90:93], v[74:77], v[136:139], v[90:93]
    s_waitcnt lgkmcnt(5)
    ds_read_b128 v[74:77], v47 offset:20480
    v_mfma_f32_16x16x32_bf16 v[94:97], v[50:53], v[136:139], v[94:97]
    s_waitcnt lgkmcnt(5)
    ds_read_b128 v[50:53], v47 offset:21504
    v_mfma_f32_16x16x32_bf16 v[78:81], v[54:57], v[140:143], v[78:81]
    s_waitcnt lgkmcnt(5)
    ds_read_b128 v[54:57], v47 offset:22528
    buffer_load_dwordx4 v[136:139], v4, s[16:19], s80 offen offset:0 sc1
    v_mfma_f32_16x16x32_bf16 v[82:85], v[58:61], v[140:143], v[82:85]
    s_waitcnt lgkmcnt(5)
    ds_read_b128 v[58:61], v47 offset:23552
    v_mfma_f32_16x16x32_bf16 v[86:89], v[62:65], v[140:143], v[86:89]
    s_waitcnt lgkmcnt(5)
    ds_read_b128 v[62:65], v47 offset:24576
    v_mfma_f32_16x16x32_bf16 v[90:93], v[66:69], v[140:143], v[90:93]
    s_waitcnt lgkmcnt(5)
    ds_read_b128 v[66:69], v47 offset:46080
    v_mfma_f32_16x16x32_bf16 v[94:97], v[70:73], v[140:143], v[94:97]
    s_waitcnt lgkmcnt(5)
    ds_read_b128 v[70:73], v47 offset:47104
    v_mfma_f32_16x16x32_bf16 v[78:81], v[74:77], v[144:147], v[78:81]
    s_waitcnt lgkmcnt(5)
    ds_read_b128 v[74:77], v47 offset:48128
    buffer_load_dwordx4 v[140:143], v4, s[16:19], s80 offen offset:1024 sc1
    v_mfma_f32_16x16x32_bf16 v[82:85], v[50:53], v[144:147], v[82:85]
    s_waitcnt lgkmcnt(5)
    ds_read_b128 v[50:53], v47 offset:49152
    v_mfma_f32_16x16x32_bf16 v[86:89], v[54:57], v[144:147], v[86:89]
    s_waitcnt lgkmcnt(5)
    ds_read_b128 v[54:57], v47 offset:50176
    v_mfma_f32_16x16x32_bf16 v[90:93], v[58:61], v[144:147], v[90:93]
    s_waitcnt lgkmcnt(5)
    ds_read_b128 v[58:61], v5 offset:10240
    v_mfma_f32_16x16x32_bf16 v[94:97], v[62:65], v[144:147], v[94:97]
    s_waitcnt lgkmcnt(5)
    ds_read_b128 v[62:65], v5 offset:11264
    v_mfma_f32_16x16x32_bf16 v[78:81], v[66:69], v[148:151], v[78:81]
    s_waitcnt lgkmcnt(5)
    ds_read_b128 v[66:69], v5 offset:12288
    buffer_load_dwordx4 v[144:147], v3, s[16:19], s81 offen offset:0 sc1
    v_mfma_f32_16x16x32_bf16 v[82:85], v[70:73], v[148:151], v[82:85]
    s_waitcnt lgkmcnt(5)
    ds_read_b128 v[70:73], v5 offset:13312
    v_mfma_f32_16x16x32_bf16 v[86:89], v[74:77], v[148:151], v[86:89]
    s_waitcnt lgkmcnt(5)
    ds_read_b128 v[74:77], v5 offset:14336
    v_mfma_f32_16x16x32_bf16 v[90:93], v[50:53], v[148:151], v[90:93]
    s_waitcnt lgkmcnt(5)
    ds_read_b128 v[50:53], v5 offset:15360
    v_mfma_f32_16x16x32_bf16 v[94:97], v[54:57], v[148:151], v[94:97]
    s_waitcnt vmcnt(10)
    ds_read_b128 v[54:57], v5 offset:16384
    s_waitcnt lgkmcnt(6)
    v_mfma_f32_16x16x32_bf16 v[78:81], v[58:61], v[152:155], v[78:81]
    s_waitcnt lgkmcnt(5)
    ds_read_b128 v[58:61], v5 offset:17408
    buffer_load_dwordx4 v[148:151], v3, s[16:19], s81 offen offset:1024 sc1
    v_mfma_f32_16x16x32_bf16 v[82:85], v[62:65], v[152:155], v[82:85]
    s_waitcnt lgkmcnt(5)
    ds_read_b128 v[62:65], v5 offset:18432
    v_mfma_f32_16x16x32_bf16 v[86:89], v[66:69], v[152:155], v[86:89]
    s_waitcnt lgkmcnt(5)
    ds_read_b128 v[66:69], v5 offset:19456
    v_mfma_f32_16x16x32_bf16 v[90:93], v[70:73], v[152:155], v[90:93]
    s_waitcnt lgkmcnt(5)
    ds_read_b128 v[70:73], v5 offset:25600
    v_mfma_f32_16x16x32_bf16 v[94:97], v[74:77], v[152:155], v[94:97]
    s_waitcnt vmcnt(10)
    ds_read_b128 v[74:77], v5 offset:26624
    s_waitcnt lgkmcnt(6)
    v_mfma_f32_16x16x32_bf16 v[78:81], v[50:53], v[156:159], v[78:81]
    s_waitcnt lgkmcnt(5)
    ds_read_b128 v[50:53], v5 offset:27648
    buffer_load_dwordx4 v[152:155], v4, s[16:19], s81 offen offset:0 sc1
    v_mfma_f32_16x16x32_bf16 v[82:85], v[54:57], v[156:159], v[82:85]
    s_waitcnt lgkmcnt(5)
    ds_read_b128 v[54:57], v5 offset:28672
    v_mfma_f32_16x16x32_bf16 v[86:89], v[58:61], v[156:159], v[86:89]
    s_waitcnt lgkmcnt(5)
    ds_read_b128 v[58:61], v5 offset:29696
    v_mfma_f32_16x16x32_bf16 v[90:93], v[62:65], v[156:159], v[90:93]
    s_waitcnt lgkmcnt(5)
    ds_read_b128 v[62:65], v5 offset:30720
    v_mfma_f32_16x16x32_bf16 v[94:97], v[66:69], v[156:159], v[94:97]
    s_waitcnt vmcnt(10)
    ds_read_b128 v[66:69], v5 offset:31744
    s_waitcnt lgkmcnt(6)
    v_mfma_f32_16x16x32_bf16 v[78:81], v[70:73], v[160:163], v[78:81]
    s_waitcnt lgkmcnt(5)
    ds_read_b128 v[70:73], v5 offset:32768
    buffer_load_dwordx4 v[156:159], v4, s[16:19], s81 offen offset:1024 sc1
    v_mfma_f32_16x16x32_bf16 v[82:85], v[74:77], v[160:163], v[82:85]
    s_nop 0
    ds_read_b128 v[74:77], v5 offset:33792
    v_mov_b32 v10, 4
    s_mov_b64 exec, 1
    ds_write_b32 v11, v10 offset:0
    s_mov_b64 exec, -1
    s_waitcnt lgkmcnt(7)
    v_mfma_f32_16x16x32_bf16 v[86:89], v[50:53], v[160:163], v[86:89]
    s_waitcnt lgkmcnt(6)
    ds_read_b128 v[50:53], v5 offset:34816
    v_mfma_f32_16x16x32_bf16 v[90:93], v[54:57], v[160:163], v[90:93]
    s_waitcnt lgkmcnt(6)
    ds_read_b128 v[54:57], v5 offset:35840
    v_mfma_f32_16x16x32_bf16 v[94:97], v[58:61], v[160:163], v[94:97]
    s_waitcnt vmcnt(10)
    ds_read_b128 v[58:61], v5 offset:36864
    s_waitcnt lgkmcnt(7)
    v_mfma_f32_16x16x32_bf16 v[78:81], v[62:65], v[164:167], v[78:81]
    s_waitcnt lgkmcnt(6)
    ds_read_b128 v[62:65], v5 offset:37888
    s_add_u32 s64, s64, 3072
    buffer_load_dwordx4 v[200:203], v5, s[16:19], s64 offen offset:0 sc1
    v_mfma_f32_16x16x32_bf16 v[82:85], v[66:69], v[164:167], v[82:85]
    s_waitcnt lgkmcnt(6)
    ds_read_b128 v[66:69], v5 offset:38912
    v_mfma_f32_16x16x32_bf16 v[86:89], v[70:73], v[164:167], v[86:89]
    s_waitcnt lgkmcnt(6)
    ds_read_b128 v[70:73], v5 offset:39936
    s_add_u32 s64, s64, 3072
    buffer_load_dwordx4 v[204:207], v5, s[16:19], s64 offen offset:0 sc1
    v_mfma_f32_16x16x32_bf16 v[90:93], v[74:77], v[164:167], v[90:93]
    s_waitcnt lgkmcnt(5)
    ds_read_b128 v[74:77], v5 offset:40960
    v_mfma_f32_16x16x32_bf16 v[94:97], v[50:53], v[164:167], v[94:97]
    s_waitcnt vmcnt(11)
    ds_read_b128 v[50:53], v5 offset:41984
    s_waitcnt lgkmcnt(6)
    v_mfma_f32_16x16x32_bf16 v[78:81], v[54:57], v[168:171], v[78:81]
    s_waitcnt lgkmcnt(5)
    ds_read_b128 v[54:57], v5 offset:43008
    s_add_u32 s64, s64, 3072
    buffer_load_dwordx4 v[208:211], v5, s[16:19], s64 offen offset:0 sc1
    v_mfma_f32_16x16x32_bf16 v[82:85], v[58:61], v[168:171], v[82:85]
    s_waitcnt lgkmcnt(5)
    ds_read_b128 v[58:61], v5 offset:44032
    v_mfma_f32_16x16x32_bf16 v[86:89], v[62:65], v[168:171], v[86:89]
    s_waitcnt lgkmcnt(5)
    ds_read_b128 v[62:65], v5 offset:45056
    s_add_u32 s64, s64, 3072
    buffer_load_dwordx4 v[212:215], v5, s[16:19], s64 offen offset:0 sc1
    v_mfma_f32_16x16x32_bf16 v[90:93], v[66:69], v[168:171], v[90:93]
    s_waitcnt lgkmcnt(5)
    ds_read_b128 v[66:69], v47 offset:0
    v_mfma_f32_16x16x32_bf16 v[94:97], v[70:73], v[168:171], v[94:97]
    s_waitcnt vmcnt(12)
    ds_read_b128 v[70:73], v47 offset:1024
    s_waitcnt lgkmcnt(6)
    v_mfma_f32_16x16x32_bf16 v[78:81], v[74:77], v[172:175], v[78:81]
    s_waitcnt lgkmcnt(5)
    ds_read_b128 v[74:77], v47 offset:2048
    s_add_u32 s64, s64, 3072
    buffer_load_dwordx4 v[216:219], v5, s[16:19], s64 offen offset:0 sc1
    v_mfma_f32_16x16x32_bf16 v[82:85], v[50:53], v[172:175], v[82:85]
    s_waitcnt lgkmcnt(5)
    ds_read_b128 v[50:53], v47 offset:3072
    v_mfma_f32_16x16x32_bf16 v[86:89], v[54:57], v[172:175], v[86:89]
    s_waitcnt lgkmcnt(5)
    ds_read_b128 v[54:57], v47 offset:4096
    s_add_u32 s64, s64, 3072
    buffer_load_dwordx4 v[220:223], v5, s[16:19], s64 offen offset:0 sc1
    v_mfma_f32_16x16x32_bf16 v[90:93], v[58:61], v[172:175], v[90:93]
    s_waitcnt lgkmcnt(5)
    ds_read_b128 v[58:61], v47 offset:5120
    v_mfma_f32_16x16x32_bf16 v[94:97], v[62:65], v[172:175], v[94:97]
    s_waitcnt vmcnt(13)
    ds_read_b128 v[62:65], v47 offset:6144
    s_waitcnt lgkmcnt(6)
    v_mfma_f32_16x16x32_bf16 v[78:81], v[66:69], v[128:131], v[78:81]
    s_waitcnt lgkmcnt(5)
    ds_read_b128 v[66:69], v47 offset:7168
    s_add_u32 s64, s64, 3072
    buffer_load_dwordx4 v[224:227], v5, s[16:19], s64 offen offset:0 sc1
    v_mfma_f32_16x16x32_bf16 v[82:85], v[70:73], v[128:131], v[82:85]
    s_waitcnt lgkmcnt(5)
    ds_read_b128 v[70:73], v47 offset:8192
    v_mfma_f32_16x16x32_bf16 v[86:89], v[74:77], v[128:131], v[86:89]
    s_waitcnt lgkmcnt(5)
    ds_read_b128 v[74:77], v47 offset:9216
    s_add_u32 s64, s64, 3072
    buffer_load_dwordx4 v[228:231], v5, s[16:19], s64 offen offset:0 sc1
    v_mfma_f32_16x16x32_bf16 v[90:93], v[50:53], v[128:131], v[90:93]
    s_waitcnt lgkmcnt(5)
    ds_read_b128 v[50:53], v47 offset:10240
    v_mfma_f32_16x16x32_bf16 v[94:97], v[54:57], v[128:131], v[94:97]
    s_waitcnt vmcnt(14)
    ds_read_b128 v[54:57], v47 offset:11264
    s_waitcnt lgkmcnt(6)
    v_mfma_f32_16x16x32_bf16 v[78:81], v[58:61], v[132:135], v[78:81]
    s_waitcnt lgkmcnt(5)
    ds_read_b128 v[58:61], v47 offset:12288
    s_add_u32 s64, s64, 3072
    buffer_load_dwordx4 v[232:235], v5, s[16:19], s64 offen offset:0 sc1
    v_mfma_f32_16x16x32_bf16 v[82:85], v[62:65], v[132:135], v[82:85]
    s_waitcnt lgkmcnt(5)
    ds_read_b128 v[62:65], v47 offset:13312
    v_mfma_f32_16x16x32_bf16 v[86:89], v[66:69], v[132:135], v[86:89]
    s_waitcnt lgkmcnt(5)
    ds_read_b128 v[66:69], v47 offset:14336
    s_add_u32 s64, s64, 3072
    buffer_load_dwordx4 v[236:239], v5, s[16:19], s64 offen offset:0 sc1
    v_mfma_f32_16x16x32_bf16 v[90:93], v[70:73], v[132:135], v[90:93]
    s_waitcnt lgkmcnt(5)
    ds_read_b128 v[70:73], v47 offset:15360
    v_mfma_f32_16x16x32_bf16 v[94:97], v[74:77], v[132:135], v[94:97]
    s_waitcnt vmcnt(15)
    ds_read_b128 v[74:77], v47 offset:16384
    s_waitcnt lgkmcnt(6)
    v_mfma_f32_16x16x32_bf16 v[78:81], v[50:53], v[136:139], v[78:81]
    s_waitcnt lgkmcnt(5)
    ds_read_b128 v[50:53], v47 offset:17408
    s_add_u32 s64, s64, 3072
    buffer_load_dwordx4 v[240:243], v5, s[16:19], s64 offen offset:0 sc1
    v_mfma_f32_16x16x32_bf16 v[82:85], v[54:57], v[136:139], v[82:85]
    s_waitcnt lgkmcnt(5)
    ds_read_b128 v[54:57], v47 offset:18432
    v_mfma_f32_16x16x32_bf16 v[86:89], v[58:61], v[136:139], v[86:89]
    s_waitcnt lgkmcnt(5)
    ds_read_b128 v[58:61], v47 offset:19456
    s_add_u32 s64, s64, 3072
    buffer_load_dwordx4 v[244:247], v5, s[16:19], s64 offen offset:0 sc1
    v_mfma_f32_16x16x32_bf16 v[90:93], v[62:65], v[136:139], v[90:93]
    s_waitcnt lgkmcnt(5)
    ds_read_b128 v[62:65], v47 offset:25600
    v_mfma_f32_16x16x32_bf16 v[94:97], v[66:69], v[136:139], v[94:97]
    s_waitcnt vmcnt(16)
    ds_read_b128 v[66:69], v47 offset:26624
    s_waitcnt lgkmcnt(6)
    v_mfma_f32_16x16x32_bf16 v[78:81], v[70:73], v[140:143], v[78:81]
    s_waitcnt lgkmcnt(5)
    ds_read_b128 v[70:73], v47 offset:27648
    v_mfma_f32_16x16x32_bf16 v[82:85], v[74:77], v[140:143], v[82:85]
    s_waitcnt lgkmcnt(5)
    ds_read_b128 v[74:77], v47 offset:28672
    v_mfma_f32_16x16x32_bf16 v[86:89], v[50:53], v[140:143], v[86:89]
    s_waitcnt lgkmcnt(5)
    ds_read_b128 v[50:53], v47 offset:29696
    v_mfma_f32_16x16x32_bf16 v[90:93], v[54:57], v[140:143], v[90:93]
    s_waitcnt lgkmcnt(5)
    ds_read_b128 v[54:57], v47 offset:30720
    v_mfma_f32_16x16x32_bf16 v[94:97], v[58:61], v[140:143], v[94:97]
    s_waitcnt vmcnt(15)
    ds_read_b128 v[58:61], v47 offset:31744
    s_waitcnt lgkmcnt(6)
    v_mfma_f32_16x16x32_bf16 v[78:81], v[62:65], v[144:147], v[78:81]
    s_waitcnt lgkmcnt(5)
    ds_read_b128 v[62:65], v47 offset:32768
    v_mfma_f32_16x16x32_bf16 v[82:85], v[66:69], v[144:147], v[82:85]
    s_waitcnt lgkmcnt(5)
    ds_read_b128 v[66:69], v47 offset:33792
    v_mfma_f32_16x16x32_bf16 v[86:89], v[70:73], v[144:147], v[86:89]
    s_waitcnt lgkmcnt(5)
    ds_read_b128 v[70:73], v47 offset:34816
    v_mfma_f32_16x16x32_bf16 v[90:93], v[74:77], v[144:147], v[90:93]
    s_waitcnt lgkmcnt(5)
    ds_read_b128 v[74:77], v47 offset:35840
    v_mfma_f32_16x16x32_bf16 v[94:97], v[50:53], v[144:147], v[94:97]
    s_waitcnt vmcnt(14)
    ds_read_b128 v[50:53], v47 offset:36864
    s_waitcnt lgkmcnt(6)
    v_mfma_f32_16x16x32_bf16 v[78:81], v[54:57], v[148:151], v[78:81]
    s_waitcnt lgkmcnt(5)
    ds_read_b128 v[54:57], v47 offset:37888
    v_mfma_f32_16x16x32_bf16 v[82:85], v[58:61], v[148:151], v[82:85]
    s_waitcnt lgkmcnt(5)
    ds_read_b128 v[58:61], v47 offset:38912
    v_mfma_f32_16x16x32_bf16 v[86:89], v[62:65], v[148:151], v[86:89]
    s_waitcnt lgkmcnt(5)
    ds_read_b128 v[62:65], v47 offset:39936
    v_mfma_f32_16x16x32_bf16 v[90:93], v[66:69], v[148:151], v[90:93]
    s_waitcnt lgkmcnt(5)
    ds_read_b128 v[66:69], v47 offset:40960
    v_mfma_f32_16x16x32_bf16 v[94:97], v[70:73], v[148:151], v[94:97]
    s_waitcnt vmcnt(13)
    ds_read_b128 v[70:73], v47 offset:41984
    s_waitcnt lgkmcnt(6)
    v_mfma_f32_16x16x32_bf16 v[78:81], v[74:77], v[152:155], v[78:81]
    s_waitcnt lgkmcnt(5)
    ds_read_b128 v[74:77], v47 offset:43008
    v_mfma_f32_16x16x32_bf16 v[82:85], v[50:53], v[152:155], v[82:85]
    s_waitcnt lgkmcnt(5)
    ds_read_b128 v[50:53], v47 offset:44032
    v_mfma_f32_16x16x32_bf16 v[86:89], v[54:57], v[152:155], v[86:89]
    s_waitcnt lgkmcnt(5)
    ds_read_b128 v[54:57], v47 offset:45056
    v_mfma_f32_16x16x32_bf16 v[90:93], v[58:61], v[152:155], v[90:93]
    s_waitcnt lgkmcnt(5)
    v_mfma_f32_16x16x32_bf16 v[94:97], v[62:65], v[152:155], v[94:97]
    s_waitcnt vmcnt(12)
    s_waitcnt lgkmcnt(4)
    v_mfma_f32_16x16x32_bf16 v[78:81], v[66:69], v[156:159], v[78:81]
    s_waitcnt lgkmcnt(3)
    v_mfma_f32_16x16x32_bf16 v[82:85], v[70:73], v[156:159], v[82:85]
    s_waitcnt lgkmcnt(2)
    v_mfma_f32_16x16x32_bf16 v[86:89], v[74:77], v[156:159], v[86:89]
    s_waitcnt lgkmcnt(0)
    v_mfma_f32_16x16x32_bf16 v[90:93], v[50:53], v[156:159], v[90:93]
    v_mov_b32 v10, 5
    s_mov_b64 exec, 1
    ds_write_b32 v11, v10 offset:0
    s_mov_b64 exec, -1
    v_mfma_f32_16x16x32_bf16 v[94:97], v[54:57], v[156:159], v[94:97]
.p2align 3
    v_cvt_pk_bf16_f32 v98, v78, v79
    v_cvt_pk_bf16_f32 v99, v80, v81
    v_cvt_pk_bf16_f32 v100, v82, v83
    v_cvt_pk_bf16_f32 v101, v84, v85
    buffer_store_dwordx4 v[98:101], v5, s[16:19], s77 offen offset:0 sc1
    v_cvt_pk_bf16_f32 v102, v86, v87
    v_cvt_pk_bf16_f32 v103, v88, v89
    v_cvt_pk_bf16_f32 v104, v90, v91
    v_cvt_pk_bf16_f32 v105, v92, v93
    buffer_store_dwordx4 v[102:105], v5, s[16:19], s77 offen offset:1024 sc1
    v_cvt_pk_bf16_f32 v106, v94, v95
    v_cvt_pk_bf16_f32 v107, v96, v97
    v_mov_b32 v108, v106
    v_mov_b32 v109, v107
    v_mov_b32 v110, v106
    v_mov_b32 v111, v107
    v_permlane32_swap_b32 v106, v108
    v_permlane32_swap_b32 v107, v109
    s_mov_b32 exec_hi, 0
    buffer_store_dwordx4 v[106:109], v5, s[16:19], s77 offen offset:2048 sc1
    s_mov_b32 exec_hi, -1
    s_add_u32 s64, s64, 3072
    buffer_load_dwordx4 v[248:251], v5, s[16:19], s64 offen offset:0 sc1
    s_add_u32 s64, s64, 3072
    buffer_load_dwordx4 v[252:255], v5, s[16:19], s64 offen offset:0 sc1
    v_dot2c_f32_bf16 v112, v98, v2
    v_dot2c_f32_bf16 v113, v98, v98
    v_dot2c_f32_bf16 v112, v99, v2
    v_dot2c_f32_bf16 v113, v99, v99
    v_dot2c_f32_bf16 v112, v100, v2
    v_dot2c_f32_bf16 v113, v100, v100
    v_dot2c_f32_bf16 v112, v101, v2
    v_dot2c_f32_bf16 v113, v101, v101
    v_dot2c_f32_bf16 v112, v102, v2
    v_dot2c_f32_bf16 v113, v102, v102
    v_dot2c_f32_bf16 v112, v103, v2
    v_dot2c_f32_bf16 v113, v103, v103
    v_dot2c_f32_bf16 v112, v104, v2
    v_dot2c_f32_bf16 v113, v104, v104
    v_dot2c_f32_bf16 v112, v105, v2
    v_dot2c_f32_bf16 v113, v105, v105
    v_dot2c_f32_bf16 v112, v110, v2
    v_dot2c_f32_bf16 v113, v110, v110
    v_dot2c_f32_bf16 v112, v111, v2
    v_dot2c_f32_bf16 v113, v111, v111
s_nop 1
    v_mov_b32 v7, v112
    v_mov_b32 v8, v113
s_nop 0
    v_permlane32_swap_b32 v112, v7
    v_permlane32_swap_b32 v113, v8
    v_add_f32 v112, v112, v7
    v_add_f32 v113, v113, v8
    v_mov_b32 v7, v112
    v_mov_b32 v8, v113
s_nop 0
    v_permlane16_swap_b32 v112, v7
    v_permlane16_swap_b32 v113, v8
    v_add_f32 v112, v112, v7
    v_add_f32 v113, v113, v8
    v_or_b32 v113, 1, v113
    v_lshlrev_b32 v114, 16, v98
    v_and_b32 v115, s55, v98
    v_lshlrev_b32 v78, 16, v24
    v_and_b32 v79, s55, v24
    v_pk_add_f32 v[78:79], v[78:79], v[114:115]
    v_lshlrev_b32 v116, 16, v99
    v_and_b32 v117, s55, v99
    v_lshlrev_b32 v80, 16, v25
    v_and_b32 v81, s55, v25
    v_pk_add_f32 v[80:81], v[80:81], v[116:117]
    v_lshlrev_b32 v114, 16, v100
    v_and_b32 v115, s55, v100
    v_lshlrev_b32 v82, 16, v26
    v_and_b32 v83, s55, v26
    v_pk_add_f32 v[82:83], v[82:83], v[114:115]
    v_lshlrev_b32 v116, 16, v101
    v_and_b32 v117, s55, v101
    v_lshlrev_b32 v84, 16, v27
    v_and_b32 v85, s55, v27
    v_pk_add_f32 v[84:85], v[84:85], v[116:117]
    v_lshlrev_b32 v114, 16, v102
    v_and_b32 v115, s55, v102
    v_lshlrev_b32 v86, 16, v28
    v_and_b32 v87, s55, v28
    v_pk_add_f32 v[86:87], v[86:87], v[114:115]
    v_lshlrev_b32 v116, 16, v103
    v_and_b32 v117, s55, v103
    v_lshlrev_b32 v88, 16, v29
    v_and_b32 v89, s55, v29
    v_pk_add_f32 v[88:89], v[88:89], v[116:117]
    v_lshlrev_b32 v114, 16, v104
    v_and_b32 v115, s55, v104
    v_lshlrev_b32 v90, 16, v30
    v_and_b32 v91, s55, v30
    v_pk_add_f32 v[90:91], v[90:91], v[114:115]
    v_lshlrev_b32 v116, 16, v105
    v_and_b32 v117, s55, v105
    v_lshlrev_b32 v92, 16, v31
    v_and_b32 v93, s55, v31
    v_pk_add_f32 v[92:93], v[92:93], v[116:117]
    v_lshlrev_b32 v114, 16, v110
    v_and_b32 v115, s55, v110
    v_lshlrev_b32 v94, 16, v32
    v_and_b32 v95, s55, v32
    v_pk_add_f32 v[94:95], v[94:95], v[114:115]
    v_lshlrev_b32 v116, 16, v111
    v_and_b32 v117, s55, v111
    v_lshlrev_b32 v96, 16, v33
    v_and_b32 v97, s55, v33
    v_pk_add_f32 v[96:97], v[96:97], v[116:117]
    s_waitcnt vmcnt(2)
    s_mov_b64 exec, 0xffff
    s_cmp_eq_u32 s54, 0
    s_cbranch_scc1 L_slow_24
    buffer_store_dwordx2 v[112:113], v9, s[16:19], s75 offen
L_back_25:
    s_mov_b64 exec, -1
    v_and_b32 v116, 15, v1
    v_mul_u32_u24 v116, 160, v116
    s_mul_i32 s49, s3, 5120
    s_add_u32 s49, s49, 141312
    v_add_u32 v116, s49, v116
    v_lshrrev_b32 v117, 4, v1
    v_mul_u32_u24 v117, 5, v117
    v_and_b32 v114, 1, v117
    v_mul_u32_u24 v114, 2552, v114
    v_lshl_add_u32 v114, v117, 3, v114
    v_add_u32 v114, v114, v116
    v_add_u32 v117, 1, v117
    v_and_b32 v115, 1, v117
    v_mul_u32_u24 v115, 2552, v115
    v_lshl_add_u32 v115, v117, 3, v115
    v_add_u32 v115, v115, v116
    ds_write_b128 v114, v[78:81] offset:0
    ds_write_b128 v115, v[82:85] offset:0
    ds_write_b128 v114, v[86:89] offset:16
    ds_write_b128 v115, v[90:93] offset:16
    ds_write_b128 v114, v[94:97] offset:32
    s_lshr_b32 s49, s4, 1
    s_add_u32 s49, s49, s3
    s_and_b32 s49, s49, 3
    s_mul_i32 s72, s49, 49152
    s_add_u32 s50, s63, 14336
    s_add_u32 s72, s72, s50
    s_lshl2_add_u32 s49, s5, s49
    s_lshl_b32 s49, s49, 10
    s_add_u32 s49, s49, 262144
    s_mul_i32 s73, s3, 5120
    v_bfe_u32 v9, v1, 3, 2
    v_mul_u32_u24 v9, 21376, v9
    v_lshrrev_b32 v8, 5, v1
    v_mul_u32_u24 v8, 384, v8
    v_sub_u32 v9, v9, v8
    s_lshl_b32 s50, s3, 8
    v_add3_u32 v9, v9, v5, s50
    s_mov_b32 s7, 4194304
L_lsp_26:
    ds_read_b32 v7, v12 offset:0
    s_sub_u32 s7, s7, 1
    s_waitcnt lgkmcnt(0)
    s_cbranch_scc1 L_lok_27
    v_cmp_gt_u32 vcc, 5, v7
    s_cbranch_vccnz L_lsp_26
L_lok_27:
    s_mov_b32 s53, 262144
L_poll_28:
    buffer_load_dwordx4 v[54:57], v5, s[16:19], s49 offen sc1
    s_sub_u32 s53, s53, 1
    s_waitcnt vmcnt(0)
    s_cbranch_scc1 L_pollx_29
    v_min_u32 v7, v55, v57
    v_cmp_eq_u32 vcc, 0, v7
    s_cbranch_vccnz L_poll_28
L_pollx_29:
    s_cmp_eq_u32 s54, 0
    s_cbranch_scc1 L_slow_30
L_back_31:
    s_add_u32 m0, s73, 0
s_nop 0
    buffer_load_dwordx4 v3, s[16:19], s72 offen offset:0 sc1 lds
    buffer_load_dwordx4 v3, s[16:19], s72 offen offset:1024 sc1 lds
    s_add_u32 m0, s73, 2048
s_nop 0
    buffer_load_dwordx4 v4, s[16:19], s72 offen offset:0 sc1 lds
    buffer_load_dwordx4 v4, s[16:19], s72 offen offset:1024 sc1 lds
    s_add_u32 m0, s73, 4096
s_nop 0
    buffer_load_dwordx4 v36, s[16:19], s72 offen offset:0 sc1 lds
    s_add_u32 s72, s72, 2560
    s_add_u32 m0, s73, 21504
s_nop 0
    buffer_load_dwordx4 v3, s[16:19], s72 offen offset:0 sc1 lds
    buffer_load_dwordx4 v3, s[16:19], s72 offen offset:1024 sc1 lds
    s_add_u32 m0, s73, 23552
s_nop 0
    buffer_load_dwordx4 v4, s[16:19], s72 offen offset:0 sc1 lds
    buffer_load_dwordx4 v4, s[16:19], s72 offen offset:1024 sc1 lds
    s_add_u32 m0, s73, 25600
s_nop 0
    buffer_load_dwordx4 v36, s[16:19], s72 offen offset:0 sc1 lds
    s_add_u32 s72, s72, 2560
    ds_write_b128 v9, v[54:57] offset:20480
    v_mov_b32 v50, v2
    v_mov_b32 v51, v2
    v_mov_b32 v52, v2
    v_mov_b32 v53, v2
s_nop 1
    v_mfma_f32_16x16x32_bf16 v[14:17], v[176:179], v[50:53], 0
    v_mfma_f32_16x16x32_bf16 v[14:17], v[180:183], v[50:53], v[14:17]
    v_mfma_f32_16x16x32_bf16 v[14:17], v[184:187], v[50:53], v[14:17]
    v_mfma_f32_16x16x32_bf16 v[14:17], v[188:191], v[50:53], v[14:17]
    v_mfma_f32_16x16x32_bf16 v[14:17], v[192:195], v[50:53], v[14:17]
    v_mfma_f32_16x16x32_bf16 v[14:17], v[196:199], v[50:53], v[14:17]
    v_mfma_f32_16x16x32_bf16 v[14:17], v[200:203], v[50:53], v[14:17]
    v_mfma_f32_16x16x32_bf16 v[14:17], v[204:207], v[50:53], v[14:17]
    v_mfma_f32_16x16x32_bf16 v[14:17], v[208:211], v[50:53], v[14:17]
    v_mfma_f32_16x16x32_bf16 v[14:17], v[212:215], v[50:53], v[14:17]
    v_mfma_f32_16x16x32_bf16 v[14:17], v[216:219], v[50:53], v[14:17]
    v_mfma_f32_16x16x32_bf16 v[14:17], v[220:223], v[50:53], v[14:17]
    v_mfma_f32_16x16x32_bf16 v[14:17], v[224:227], v[50:53], v[14:17]
    v_mfma_f32_16x16x32_bf16 v[14:17], v[228:231], v[50:53], v[14:17]
    v_mfma_f32_16x16x32_bf16 v[14:17], v[232:235], v[50:53], v[14:17]
    v_mfma_f32_16x16x32_bf16 v[14:17], v[236:239], v[50:53], v[14:17]
    v_mfma_f32_16x16x32_bf16 v[14:17], v[240:243], v[50:53], v[14:17]
    v_mfma_f32_16x16x32_bf16 v[14:17], v[244:247], v[50:53], v[14:17]
    v_mfma_f32_16x16x32_bf16 v[14:17], v[248:251], v[50:53], v[14:17]
    v_mfma_f32_16x16x32_bf16 v[14:17], v[252:255], v[50:53], v[14:17]
    v_lshlrev_b32 v18, 16, v34
    v_and_b32 v19, s55, v34
    v_lshlrev_b32 v20, 16, v35
    v_and_b32 v21, s55, v35
    s_waitcnt lgkmcnt(0)
    s_lshl_b32 s49, s3, 10
    s_add_u32 s49, s49, 86016
    v_add_u32 v9, s49, v5
    v_mov_b32 v0, 0xbdd2d3e8
    v_add_u32 v47, 43008, v5
    s_waitcnt vmcnt(5)
    s_barrier
    ds_read_b128 v[50:53], v5 offset:0
    ds_read_b128 v[54:57], v5 offset:1024
    ds_read_b128 v[58:61], v5 offset:2048
    ds_read_b128 v[62:65], v5 offset:3072
    ds_read_b128 v[66:69], v5 offset:4096
    s_waitcnt lgkmcnt(4)
    v_mfma_f32_16x16x32_bf16 v[70:73], v[176:179], v[50:53], 0
    s_waitcnt lgkmcnt(3)
    ds_read_b64 v[74:75], v46 offset:20480
    ds_read_b64 v[76:77], v46 offset:20608
    ds_read_b64 v[78:79], v46 offset:20736
    ds_read_b128 v[50:53], v5 offset:5120
    v_mfma_f32_16x16x32_bf16 v[70:73], v[180:183], v[54:57], v[70:73]
    s_waitcnt lgkmcnt(6)
    ds_read_b64 v[80:81], v46 offset:20864
    ds_read_b64 v[82:83], v46 offset:20992
    ds_read_b64 v[84:85], v46 offset:21120
    ds_read_b128 v[54:57], v5 offset:6144
    s_add_u32 m0, s73, 43008
s_nop 0
    buffer_load_dwordx4 v3, s[16:19], s72 offen offset:0 sc1 lds
    v_mfma_f32_16x16x32_bf16 v[70:73], v[184:187], v[58:61], v[70:73]
    s_waitcnt lgkmcnt(9)
    ds_read_b64 v[86:87], v46 offset:21248
    ds_read_b64 v[88:89], v46 offset:21376
    ds_read_b128 v[58:61], v5 offset:7168
    v_mfma_f32_16x16x32_bf16 v[70:73], v[188:191], v[62:65], v[70:73]
    s_waitcnt lgkmcnt(11)
    ds_read_b128 v[62:65], v5 offset:8192
    buffer_load_dwordx4 v3, s[16:19], s72 offen offset:1024 sc1 lds
    v_mfma_f32_16x16x32_bf16 v[70:73], v[192:195], v[66:69], v[70:73]
    s_waitcnt lgkmcnt(2)
    ds_read_b128 v[66:69], v5 offset:9216
    v_mfma_f32_16x16x32_bf16 v[70:73], v[196:199], v[50:53], v[70:73]
    s_nop 0
    ds_read_b128 v[50:53], v5 offset:10240
    s_add_u32 m0, s73, 45056
s_nop 0
    buffer_load_dwordx4 v4, s[16:19], s72 offen offset:0 sc1 lds
    v_add_f32 v74, v74, v76
    v_add_f32 v75, v75, v77
    v_add_f32 v74, v74, v78
    v_mfma_f32_16x16x32_bf16 v[70:73], v[200:203], v[54:57], v[70:73]
    s_waitcnt lgkmcnt(3)
    ds_read_b128 v[54:57], v5 offset:11264
    v_add_f32 v75, v75, v79
    v_add_f32 v74, v74, v80
    v_add_f32 v75, v75, v81
    v_mfma_f32_16x16x32_bf16 v[70:73], v[204:207], v[58:61], v[70:73]
    s_waitcnt lgkmcnt(3)
    ds_read_b128 v[58:61], v5 offset:12288
    buffer_load_dwordx4 v4, s[16:19], s72 offen offset:1024 sc1 lds
    v_add_f32 v74, v74, v82
    v_add_f32 v75, v75, v83
    v_mfma_f32_16x16x32_bf16 v[70:73], v[208:211], v[62:65], v[70:73]
    s_waitcnt lgkmcnt(3)
    ds_read_b128 v[62:65], v5 offset:13312
    v_add_f32 v74, v74, v84
    v_add_f32 v75, v75, v85
    v_add_f32 v74, v74, v86
    v_mfma_f32_16x16x32_bf16 v[70:73], v[212:215], v[66:69], v[70:73]
    s_waitcnt lgkmcnt(3)
    ds_read_b128 v[66:69], v5 offset:14336
    s_add_u32 m0, s73, 47104
s_nop 0
    buffer_load_dwordx4 v36, s[16:19], s72 offen offset:0 sc1 lds
    s_add_u32 s72, s72, 2560
    v_add_f32 v75, v75, v87
    v_add_f32 v74, v74, v88
    v_mfma_f32_16x16x32_bf16 v[70:73], v[216:219], v[50:53], v[70:73]
    s_waitcnt lgkmcnt(3)
    ds_read_b128 v[50:53], v5 offset:15360
    s_add_u32 m0, s73, 64512
s_nop 0
    buffer_load_dwordx4 v3, s[16:19], s72 offen offset:0 sc1 lds
    v_add_f32 v75, v75, v89
    v_mul_f32 v74, 0x3acccccd, v74
    v_mul_f32 v75, 0x3acccccd, v75
    v_mfma_f32_16x16x32_bf16 v[70:73], v[220:223], v[54:57], v[70:73]
    s_waitcnt lgkmcnt(3)
    ds_read_b128 v[54:57], v5 offset:16384
    v_fma_f32 v75, -v74, v74, v75
    v_max_f32 v75, 0, v75
    v_mfma_f32_16x16x32_bf16 v[70:73], v[224:227], v[58:61], v[70:73]
    s_waitcnt lgkmcnt(3)
    ds_read_b128 v[58:61], v5 offset:17408
    buffer_load_dwordx4 v3, s[16:19], s72 offen offset:1024 sc1 lds
    v_add_f32 v76, 0x3727c5ac, v75
    v_mul_f32 v76, 0x3727c5ac, v76
    v_add_f32 v75, v75, v76
    v_mfma_f32_16x16x32_bf16 v[70:73], v[228:231], v[62:65], v[70:73]
    s_waitcnt lgkmcnt(3)
    ds_read_b128 v[62:65], v5 offset:18432
    v_rsq_f32 v98, v75
s_nop 0
    v_mul_f32 v74, v74, v98
    v_sub_f32 v102, 0, v74
    v_mfma_f32_16x16x32_bf16 v[70:73], v[232:235], v[66:69], v[70:73]
    s_waitcnt lgkmcnt(3)
    ds_read_b128 v[66:69], v5 offset:19456
    s_add_u32 m0, s73, 66560
s_nop 0
    buffer_load_dwordx4 v4, s[16:19], s72 offen offset:0 sc1 lds
    v_mov_b32 v100, v98
    v_mov_b32 v104, v102
    v_mfma_f32_16x16x32_bf16 v[70:73], v[236:239], v[50:53], v[70:73]
    s_waitcnt vmcnt(8)
    s_barrier
    ds_read_b128 v[50:53], v5 offset:21504
    s_waitcnt lgkmcnt(4)
    v_permlane32_swap_b32 v98, v100
    v_permlane32_swap_b32 v102, v104
    v_mov_b32 v99, v98
    v_mfma_f32_16x16x32_bf16 v[70:73], v[240:243], v[54:57], v[70:73]
    s_waitcnt lgkmcnt(3)
    ds_read_b128 v[54:57], v5 offset:22528
    buffer_load_dwordx4 v4, s[16:19], s72 offen offset:1024 sc1 lds
    v_mov_b32 v101, v100
    v_mov_b32 v103, v102
    v_mfma_f32_16x16x32_bf16 v[70:73], v[244:247], v[58:61], v[70:73]
    s_waitcnt lgkmcnt(3)
    ds_read_b128 v[58:61], v5 offset:23552
    v_mov_b32 v105, v104
    v_permlane16_swap_b32 v98, v99
    v_permlane16_swap_b32 v100, v101
    v_mfma_f32_16x16x32_bf16 v[70:73], v[248:251], v[62:65], v[70:73]
    s_waitcnt lgkmcnt(3)
    ds_read_b128 v[62:65], v5 offset:24576
    s_add_u32 m0, s73, 68608
s_nop 0
    buffer_load_dwordx4 v36, s[16:19], s72 offen offset:0 sc1 lds
    s_add_u32 s72, s72, 2560
    v_permlane16_swap_b32 v102, v103
    v_permlane16_swap_b32 v104, v105
    v_mfma_f32_16x16x32_bf16 v[70:73], v[252:255], v[66:69], v[70:73]
    s_waitcnt lgkmcnt(3)
    ds_read_b128 v[66:69], v5 offset:25600
    buffer_load_dwordx4 v[128:131], v5, s[16:19], s65 offen offset:0 sc1
    v_mfma_f32_16x16x32_bf16 v[74:77], v[176:179], v[50:53], 0
    s_waitcnt lgkmcnt(3)
    ds_read_b128 v[50:53], v5 offset:26624
    v_fma_f32 v86, v14, v102, v18
    v_fma_f32 v87, v15, v102, v19
    v_fma_f32 v88, v16, v102, v20
    v_mfma_f32_16x16x32_bf16 v[74:77], v[180:183], v[54:57], v[74:77]
    s_waitcnt lgkmcnt(3)
    ds_read_b128 v[54:57], v5 offset:27648
    buffer_load_dwordx4 v[132:135], v5, s[16:19], s65 offen offset:1024 sc1
    v_fma_f32 v89, v17, v102, v21
    v_fmac_f32 v86, v70, v98
    v_fmac_f32 v87, v71, v98
    v_mfma_f32_16x16x32_bf16 v[74:77], v[184:187], v[58:61], v[74:77]
    s_waitcnt lgkmcnt(3)
    ds_read_b128 v[58:61], v5 offset:28672
    v_fmac_f32 v88, v72, v98
    v_fmac_f32 v89, v73, v98
    v_mul_f32 v90, v86, v86
    v_mfma_f32_16x16x32_bf16 v[74:77], v[188:191], v[62:65], v[74:77]
    s_waitcnt lgkmcnt(3)
    ds_read_b128 v[62:65], v5 offset:29696
    buffer_load_dwordx4 v[136:139], v5, s[16:19], s65 offen offset:2048 sc1
    v_mul_f32 v91, v87, v87
    v_mul_f32 v92, v88, v88
    v_mfma_f32_16x16x32_bf16 v[74:77], v[192:195], v[66:69], v[74:77]
    s_waitcnt lgkmcnt(3)
    ds_read_b128 v[66:69], v5 offset:30720
    v_mul_f32 v93, v89, v89
    v_fmaak_f32 v90, v0, v90, 0xc0135761
    v_fmaak_f32 v91, v0, v91, 0xc0135761
    v_mfma_f32_16x16x32_bf16 v[74:77], v[196:199], v[50:53], v[74:77]
    s_waitcnt lgkmcnt(3)
    ds_read_b128 v[50:53], v5 offset:31744
    buffer_load_dwordx4 v[140:143], v5, s[16:19], s65 offen offset:3072 sc1
    v_fmaak_f32 v92, v0, v92, 0xc0135761
    v_fmaak_f32 v93, v0, v93, 0xc0135761
    v_mul_f32 v90, v90, v86
    v_mfma_f32_16x16x32_bf16 v[74:77], v[200:203], v[54:57], v[74:77]
    s_waitcnt lgkmcnt(3)
    ds_read_b128 v[54:57], v5 offset:32768
    v_mul_f32 v91, v91, v87
    v_mul_f32 v92, v92, v88
    v_mul_f32 v93, v93, v89
    v_mfma_f32_16x16x32_bf16 v[74:77], v[204:207], v[58:61], v[74:77]
    s_waitcnt lgkmcnt(3)
    ds_read_b128 v[58:61], v5 offset:33792
    s_add_u32 s65, s65, 4096
    buffer_load_dwordx4 v[144:147], v5, s[16:19], s65 offen offset:0 sc1
    v_exp_f32 v90, v90
    v_mfma_f32_16x16x32_bf16 v[74:77], v[208:211], v[62:65], v[74:77]
    s_waitcnt lgkmcnt(3)
    ds_read_b128 v[62:65], v5 offset:34816
    v_exp_f32 v91, v91
    v_exp_f32 v92, v92
    v_mfma_f32_16x16x32_bf16 v[74:77], v[212:215], v[66:69], v[74:77]
    s_waitcnt lgkmcnt(3)
    ds_read_b128 v[66:69], v5 offset:35840
    buffer_load_dwordx4 v[148:151], v5, s[16:19], s65 offen offset:1024 sc1
    v_exp_f32 v93, v93
    v_mfma_f32_16x16x32_bf16 v[74:77], v[216:219], v[50:53], v[74:77]
    s_waitcnt lgkmcnt(3)
    ds_read_b128 v[50:53], v5 offset:36864
    buffer_load_dwordx4 v[152:155], v5, s[16:19], s65 offen offset:2048 sc1
    v_add_f32 v90, 1.0, v90
    v_add_f32 v91, 1.0, v91
    v_add_f32 v92, 1.0, v92
    v_mfma_f32_16x16x32_bf16 v[74:77], v[220:223], v[54:57], v[74:77]
    s_waitcnt lgkmcnt(3)
    ds_read_b128 v[54:57], v5 offset:37888
    v_add_f32 v93, 1.0, v93
    v_rcp_f32 v90, v90
    v_mfma_f32_16x16x32_bf16 v[74:77], v[224:227], v[58:61], v[74:77]
    s_waitcnt lgkmcnt(3)
    ds_read_b128 v[58:61], v5 offset:38912
    buffer_load_dwordx4 v[156:159], v5, s[16:19], s65 offen offset:3072 sc1
    v_rcp_f32 v91, v91
    v_mfma_f32_16x16x32_bf16 v[74:77], v[228:231], v[62:65], v[74:77]
    s_waitcnt lgkmcnt(3)
    ds_read_b128 v[62:65], v5 offset:39936
    v_rcp_f32 v92, v92
    v_rcp_f32 v93, v93
    v_mfma_f32_16x16x32_bf16 v[74:77], v[232:235], v[66:69], v[74:77]
    s_waitcnt lgkmcnt(3)
    ds_read_b128 v[66:69], v5 offset:40960
    s_add_u32 s65, s65, 4096
    buffer_load_dwordx4 v[160:163], v5, s[16:19], s65 offen offset:0 sc1
    v_mul_f32 v86, v86, v90
    v_mul_f32 v87, v87, v91
    v_mfma_f32_16x16x32_bf16 v[74:77], v[236:239], v[50:53], v[74:77]
    s_waitcnt vmcnt(9)
    s_barrier
    ds_read_b128 v[50:53], v47 offset:0
    s_waitcnt lgkmcnt(4)
    v_mul_f32 v88, v88, v92
    v_mul_f32 v89, v89, v93
    v_mfma_f32_16x16x32_bf16 v[74:77], v[240:243], v[54:57], v[74:77]
    s_waitcnt lgkmcnt(3)
    ds_read_b128 v[54:57], v47 offset:1024
    buffer_load_dwordx4 v[164:167], v5, s[16:19], s65 offen offset:1024 sc1
    v_cvt_pk_bf16_f32 v94, v86, v87
    v_cvt_pk_bf16_f32 v95, v88, v89
    v_mfma_f32_16x16x32_bf16 v[74:77], v[244:247], v[58:61], v[74:77]
    s_waitcnt lgkmcnt(3)
    ds_read_b128 v[58:61], v47 offset:2048
    v_mov_b32 v96, v94
    v_mov_b32 v97, v95
s_nop 0
    v_permlane32_swap_b32 v94, v96
    v_mfma_f32_16x16x32_bf16 v[74:77], v[248:251], v[62:65], v[74:77]
    v_permlane32_swap_b32 v95, v97
    s_mov_b32 exec_hi, 0
    buffer_store_dwordx4 v[94:97], v5, s[16:19], s67 offen nt
    s_mov_b32 exec_hi, -1
    s_add_u32 s67, s67, 6144
    ds_read_b128 v[62:65], v47 offset:3072
    buffer_load_dwordx4 v[168:171], v5, s[16:19], s65 offen offset:2048 sc1
    s_waitcnt lgkmcnt(4)
    v_mfma_f32_16x16x32_bf16 v[74:77], v[252:255], v[66:69], v[74:77]
    s_waitcnt lgkmcnt(3)
    ds_read_b128 v[66:69], v47 offset:4096
    buffer_load_dwordx4 v[172:175], v5, s[16:19], s65 offen offset:3072 sc1
    v_mfma_f32_16x16x32_bf16 v[70:73], v[176:179], v[50:53], 0
    s_waitcnt lgkmcnt(3)
    ds_read_b128 v[50:53], v47 offset:5120
    v_fma_f32 v86, v14, v103, v18
    v_fma_f32 v87, v15, v103, v19
    v_fma_f32 v88, v16, v103, v20
    v_mfma_f32_16x16x32_bf16 v[70:73], v[180:183], v[54:57], v[70:73]
    s_waitcnt lgkmcnt(3)
    ds_read_b128 v[54:57], v47 offset:6144
    s_add_u32 s65, s65, 4096
    buffer_load_dwordx4 v[22:25], v5, s[16:19], s65 offen offset:0 sc1
    v_fma_f32 v89, v17, v103, v21
    v_fmac_f32 v86, v74, v99
    v_fmac_f32 v87, v75, v99
    v_mfma_f32_16x16x32_bf16 v[70:73], v[184:187], v[58:61], v[70:73]
    s_waitcnt lgkmcnt(3)
    ds_read_b128 v[58:61], v47 offset:7168
    v_fmac_f32 v88, v76, v99
    v_fmac_f32 v89, v77, v99
    v_mul_f32 v90, v86, v86
    v_mfma_f32_16x16x32_bf16 v[70:73], v[188:191], v[62:65], v[70:73]
    s_waitcnt lgkmcnt(3)
    ds_read_b128 v[62:65], v47 offset:8192
    buffer_load_dwordx4 v[26:29], v5, s[16:19], s65 offen offset:1024 sc1
    v_mul_f32 v91, v87, v87
    v_mul_f32 v92, v88, v88
    v_mfma_f32_16x16x32_bf16 v[70:73], v[192:195], v[66:69], v[70:73]
    s_waitcnt lgkmcnt(3)
    ds_read_b128 v[66:69], v47 offset:9216
    v_mul_f32 v93, v89, v89
    v_fmaak_f32 v90, v0, v90, 0xc0135761
    v_fmaak_f32 v91, v0, v91, 0xc0135761
    v_mfma_f32_16x16x32_bf16 v[70:73], v[196:199], v[50:53], v[70:73]
    s_waitcnt lgkmcnt(3)
    ds_read_b128 v[50:53], v47 offset:10240
    buffer_load_dwordx4 v[30:33], v5, s[16:19], s65 offen offset:2048 sc1
    v_fmaak_f32 v92, v0, v92, 0xc0135761
    v_fmaak_f32 v93, v0, v93, 0xc0135761
    v_mul_f32 v90, v90, v86
    v_mfma_f32_16x16x32_bf16 v[70:73], v[200:203], v[54:57], v[70:73]
    s_waitcnt lgkmcnt(3)
    ds_read_b128 v[54:57], v47 offset:11264
    v_mul_f32 v91, v91, v87
    v_mul_f32 v92, v92, v88
    v_mul_f32 v93, v93, v89
    v_mfma_f32_16x16x32_bf16 v[70:73], v[204:207], v[58:61], v[70:73]
    s_waitcnt lgkmcnt(3)
    ds_read_b128 v[58:61], v47 offset:12288
    buffer_load_dwordx4 v[38:41], v5, s[16:19], s65 offen offset:3072 sc1
    v_exp_f32 v90, v90
    v_mfma_f32_16x16x32_bf16 v[70:73], v[208:211], v[62:65], v[70:73]
    s_waitcnt lgkmcnt(3)
    ds_read_b128 v[62:65], v47 offset:13312
    v_exp_f32 v91, v91
    v_exp_f32 v92, v92
    v_mfma_f32_16x16x32_bf16 v[70:73], v[212:215], v[66:69], v[70:73]
    s_waitcnt lgkmcnt(3)
    ds_read_b128 v[66:69], v47 offset:14336
    s_add_u32 s65, s65, 4096
    buffer_load_dwordx4 v[106:109], v5, s[16:19], s65 offen offset:0 sc1
    v_exp_f32 v93, v93
    v_mfma_f32_16x16x32_bf16 v[70:73], v[216:219], v[50:53], v[70:73]
    s_waitcnt lgkmcnt(3)
    ds_read_b128 v[50:53], v47 offset:15360
    buffer_load_dwordx4 v[110:113], v5, s[16:19], s65 offen offset:1024 sc1
    v_add_f32 v90, 1.0, v90
    v_add_f32 v91, 1.0, v91
    v_add_f32 v92, 1.0, v92
    v_mfma_f32_16x16x32_bf16 v[70:73], v[220:223], v[54:57], v[70:73]
    s_waitcnt lgkmcnt(3)
    ds_read_b128 v[54:57], v47 offset:16384
    v_add_f32 v93, 1.0, v93
    v_rcp_f32 v90, v90
    v_mfma_f32_16x16x32_bf16 v[70:73], v[224:227], v[58:61], v[70:73]
    v_rcp_f32 v91, v91
    ds_read_b128 v[58:61], v47 offset:17408
    buffer_load_dwordx4 v[114:117], v5, s[16:19], s65 offen offset:2048 sc1
    s_waitcnt vmcnt(9)
    v_mov_b32 v7, 1
    s_mov_b64 exec, 1
    s_cmp_eq_u32 s54, 0
    s_cbranch_scc1 L_slow_32
    buffer_store_dword v7, v6, s[16:19], s68 offen
L_back_33:
    s_mov_b64 exec, -1
    s_waitcnt lgkmcnt(4)
    v_mfma_f32_16x16x32_bf16 v[70:73], v[228:231], v[62:65], v[70:73]
    s_waitcnt lgkmcnt(3)
    ds_read_b128 v[62:65], v47 offset:18432
    v_rcp_f32 v92, v92
    v_rcp_f32 v93, v93
    v_mfma_f32_16x16x32_bf16 v[70:73], v[232:235], v[66:69], v[70:73]
    s_waitcnt lgkmcnt(3)
    ds_read_b128 v[66:69], v47 offset:19456
    buffer_load_dwordx4 v[118:121], v5, s[16:19], s65 offen offset:3072 sc1
    v_mul_f32 v86, v86, v90
    v_mul_f32 v87, v87, v91
    v_mfma_f32_16x16x32_bf16 v[70:73], v[236:239], v[50:53], v[70:73]
    s_waitcnt lgkmcnt(3)
    ds_read_b128 v[50:53], v47 offset:21504
    v_mul_f32 v88, v88, v92
    v_mul_f32 v89, v89, v93
    v_mfma_f32_16x16x32_bf16 v[70:73], v[240:243], v[54:57], v[70:73]
    s_waitcnt lgkmcnt(3)
    ds_read_b128 v[54:57], v47 offset:22528
    s_add_u32 s65, s65, 4096
    buffer_load_dwordx4 v[122:125], v5, s[16:19], s65 offen offset:0 sc1
    v_cvt_pk_bf16_f32 v94, v86, v87
    v_cvt_pk_bf16_f32 v95, v88, v89
    v_mfma_f32_16x16x32_bf16 v[70:73], v[244:247], v[58:61], v[70:73]
    s_waitcnt lgkmcnt(3)
    ds_read_b128 v[58:61], v47 offset:23552
    v_mov_b32 v96, v94
    v_mov_b32 v97, v95
s_nop 0
    v_permlane32_swap_b32 v94, v96
    v_mfma_f32_16x16x32_bf16 v[70:73], v[248:251], v[62:65], v[70:73]
    v_permlane32_swap_b32 v95, v97
    s_mov_b32 exec_hi, 0
    buffer_store_dwordx4 v[94:97], v5, s[16:19], s67 offen nt
    s_mov_b32 exec_hi, -1
    s_add_u32 s67, s67, 6144
    ds_read_b128 v[62:65], v47 offset:24576
    s_waitcnt lgkmcnt(4)
    v_mfma_f32_16x16x32_bf16 v[70:73], v[252:255], v[66:69], v[70:73]
    s_waitcnt lgkmcnt(3)
    ds_read_b128 v[66:69], v47 offset:25600
    v_mfma_f32_16x16x32_bf16 v[74:77], v[176:179], v[50:53], 0
    s_waitcnt lgkmcnt(3)
    ds_read_b128 v[50:53], v47 offset:26624
    buffer_load_dwordx4 v[176:179], v5, s[16:19], s65 offen offset:1024 sc1
    v_fma_f32 v86, v14, v104, v18
    v_fma_f32 v87, v15, v104, v19
    v_fma_f32 v88, v16, v104, v20
    v_mfma_f32_16x16x32_bf16 v[74:77], v[180:183], v[54:57], v[74:77]
    s_waitcnt lgkmcnt(3)
    ds_read_b128 v[54:57], v47 offset:27648
    buffer_load_dwordx4 v[180:183], v5, s[16:19], s65 offen offset:2048 sc1
    v_fma_f32 v89, v17, v104, v21
    v_fmac_f32 v86, v70, v100
    v_fmac_f32 v87, v71, v100
    v_mfma_f32_16x16x32_bf16 v[74:77], v[184:187], v[58:61], v[74:77]
    s_waitcnt lgkmcnt(3)
    ds_read_b128 v[58:61], v47 offset:28672
    buffer_load_dwordx4 v[184:187], v5, s[16:19], s65 offen offset:3072 sc1
    v_fmac_f32 v88, v72, v100
    v_fmac_f32 v89, v73, v100
    v_mul_f32 v90, v86, v86
    v_mfma_f32_16x16x32_bf16 v[74:77], v[188:191], v[62:65], v[74:77]
    s_waitcnt lgkmcnt(3)
    ds_read_b128 v[62:65], v47 offset:29696
    s_add_u32 s65, s65, 4096
    buffer_load_dwordx4 v[188:191], v5, s[16:19], s65 offen offset:0 sc1
    v_mul_f32 v91, v87, v87
    v_mul_f32 v92, v88, v88
    v_mfma_f32_16x16x32_bf16 v[74:77], v[192:195], v[66:69], v[74:77]
    s_waitcnt lgkmcnt(3)
    ds_read_b128 v[66:69], v47 offset:30720
    buffer_load_dwordx4 v[192:195], v5, s[16:19], s65 offen offset:1024 sc1
    v_mul_f32 v93, v89, v89
    v_fmaak_f32 v90, v0, v90, 0xc0135761
    v_fmaak_f32 v91, v0, v91, 0xc0135761
    v_mfma_f32_16x16x32_bf16 v[74:77], v[196:199], v[50:53], v[74:77]
    s_waitcnt lgkmcnt(3)
    ds_read_b128 v[50:53], v47 offset:31744
    buffer_load_dwordx4 v[196:199], v5, s[16:19], s65 offen offset:2048 sc1
    v_fmaak_f32 v92, v0, v92, 0xc0135761
    v_fmaak_f32 v93, v0, v93, 0xc0135761
    v_mul_f32 v90, v90, v86
    v_mfma_f32_16x16x32_bf16 v[74:77], v[200:203], v[54:57], v[74:77]
    s_waitcnt lgkmcnt(3)
    ds_read_b128 v[54:57], v47 offset:32768
    buffer_load_dwordx4 v[200:203], v5, s[16:19], s65 offen offset:3072 sc1
    v_mul_f32 v91, v91, v87
    v_mul_f32 v92, v92, v88
    v_mul_f32 v93, v93, v89
    v_mfma_f32_16x16x32_bf16 v[74:77], v[204:207], v[58:61], v[74:77]
    s_waitcnt lgkmcnt(3)
    ds_read_b128 v[58:61], v47 offset:33792
    s_add_u32 s65, s65, 4096
    buffer_load_dwordx4 v[204:207], v5, s[16:19], s65 offen offset:0 sc1
    v_exp_f32 v90, v90
    v_mfma_f32_16x16x32_bf16 v[74:77], v[208:211], v[62:65], v[74:77]
    s_waitcnt lgkmcnt(3)
    ds_read_b128 v[62:65], v47 offset:34816
    buffer_load_dwordx4 v[208:211], v5, s[16:19], s65 offen offset:1024 sc1
    v_exp_f32 v91, v91
    v_exp_f32 v92, v92
    v_mfma_f32_16x16x32_bf16 v[74:77], v[212:215], v[66:69], v[74:77]
    s_waitcnt lgkmcnt(3)
    ds_read_b128 v[66:69], v47 offset:35840
    v_exp_f32 v93, v93
    v_mfma_f32_16x16x32_bf16 v[74:77], v[216:219], v[50:53], v[74:77]
    s_waitcnt lgkmcnt(3)
    ds_read_b128 v[50:53], v47 offset:36864
    v_add_f32 v90, 1.0, v90
    v_add_f32 v91, 1.0, v91
    v_add_f32 v92, 1.0, v92
    v_mfma_f32_16x16x32_bf16 v[74:77], v[220:223], v[54:57], v[74:77]
    s_waitcnt lgkmcnt(3)
    ds_read_b128 v[54:57], v47 offset:37888
    v_add_f32 v93, 1.0, v93
    v_rcp_f32 v90, v90
    v_mfma_f32_16x16x32_bf16 v[74:77], v[224:227], v[58:61], v[74:77]
    s_nop 0
    ds_read_b128 v[58:61], v47 offset:38912
    s_and_b32 s49, s69, 0xfffffc00
    v_rcp_f32 v91, v91
    v_lshrrev_b32 v7, 3, v1
    v_lshl_add_u32 v46, v7, 7, v44
    buffer_load_dword v2, v46, s[16:19], s49 offen sc1
    s_waitcnt lgkmcnt(4)
    v_mfma_f32_16x16x32_bf16 v[74:77], v[228:231], v[62:65], v[74:77]
    s_waitcnt lgkmcnt(3)
    ds_read_b128 v[62:65], v47 offset:39936
    v_rcp_f32 v92, v92
    v_rcp_f32 v93, v93
    v_mfma_f32_16x16x32_bf16 v[74:77], v[232:235], v[66:69], v[74:77]
    s_waitcnt lgkmcnt(3)
    ds_read_b128 v[66:69], v47 offset:40960
    v_mul_f32 v86, v86, v90
    v_mul_f32 v87, v87, v91
    v_mfma_f32_16x16x32_bf16 v[74:77], v[236:239], v[50:53], v[74:77]
    v_mul_f32 v88, v88, v92
    v_mul_f32 v89, v89, v93
    s_waitcnt vmcnt(0)
    v_cmp_gt_u32 vcc, 1, v2
    s_cbranch_vccnz L_spin_34
L_ok_35:
    s_cmp_eq_u32 s54, 0
    s_cbranch_scc1 L_slow_37
L_back_38:
    s_waitcnt lgkmcnt(3)
    v_mfma_f32_16x16x32_bf16 v[74:77], v[240:243], v[54:57], v[74:77]
    v_cvt_pk_bf16_f32 v94, v86, v87
    v_cvt_pk_bf16_f32 v95, v88, v89
    v_mov_b32 v7, 2
    s_mov_b64 exec, 1
    s_cmp_eq_u32 s54, 0
    s_cbranch_scc1 L_slow_39
    buffer_store_dword v7, v6, s[16:19], s68 offen
L_back_40:
    s_mov_b64 exec, -1
    s_waitcnt lgkmcnt(2)
    v_mfma_f32_16x16x32_bf16 v[74:77], v[244:247], v[58:61], v[74:77]
    s_add_u32 s74, s66, 0
    buffer_load_dwordx4 v[212:215], v5, s[16:19], s74 offen offset:0 sc1
    s_waitcnt lgkmcnt(1)
    v_mov_b32 v96, v94
    v_mov_b32 v97, v95
s_nop 0
    v_permlane32_swap_b32 v94, v96
    v_mfma_f32_16x16x32_bf16 v[74:77], v[248:251], v[62:65], v[74:77]
    v_permlane32_swap_b32 v95, v97
    s_mov_b32 exec_hi, 0
    buffer_store_dwordx4 v[94:97], v5, s[16:19], s67 offen nt
    s_mov_b32 exec_hi, -1
    s_add_u32 s67, s67, 6144
    buffer_load_dwordx4 v[216:219], v5, s[16:19], s74 offen offset:1024 sc1
    buffer_load_dwordx4 v[220:223], v5, s[16:19], s74 offen offset:2048 sc1
    s_waitcnt lgkmcnt(0)
    v_mfma_f32_16x16x32_bf16 v[74:77], v[252:255], v[66:69], v[74:77]
    s_nop 0
    buffer_load_dwordx4 v[224:227], v5, s[16:19], s74 offen offset:3072 sc1
    v_mov_b32 v10, 6
    s_mov_b64 exec, 1
    ds_write_b32 v11, v10 offset:0
    s_mov_b64 exec, -1
    v_fma_f32 v86, v14, v105, v18
    v_fma_f32 v87, v15, v105, v19
    v_fma_f32 v88, v16, v105, v20
    v_fma_f32 v89, v17, v105, v21
    v_fmac_f32 v86, v74, v101
    v_fmac_f32 v87, v75, v101
    v_fmac_f32 v88, v76, v101
    v_fmac_f32 v89, v77, v101
    v_mul_f32 v90, v86, v86
    v_mul_f32 v91, v87, v87
    v_mul_f32 v92, v88, v88
    v_mul_f32 v93, v89, v89
    v_fmaak_f32 v90, v0, v90, 0xc0135761
    v_fmaak_f32 v91, v0, v91, 0xc0135761
    v_fmaak_f32 v92, v0, v92, 0xc0135761
    v_fmaak_f32 v93, v0, v93, 0xc0135761
    v_mul_f32 v90, v90, v86
    v_mul_f32 v91, v91, v87
    v_mul_f32 v92, v92, v88
    v_mul_f32 v93, v93, v89
    v_exp_f32 v90, v90
    v_exp_f32 v91, v91
    v_exp_f32 v92, v92
    v_exp_f32 v93, v93
    v_add_f32 v90, 1.0, v90
    v_add_f32 v91, 1.0, v91
    v_add_f32 v92, 1.0, v92
    v_add_f32 v93, 1.0, v93
    v_rcp_f32 v90, v90
    v_rcp_f32 v91, v91
    v_rcp_f32 v92, v92
    v_rcp_f32 v93, v93
    v_mul_f32 v86, v86, v90
    v_mul_f32 v87, v87, v91
    v_mul_f32 v88, v88, v92
    v_mul_f32 v89, v89, v93
    v_cvt_pk_bf16_f32 v94, v86, v87
    v_cvt_pk_bf16_f32 v95, v88, v89
    v_mov_b32 v96, v94
    v_mov_b32 v97, v95
s_nop 0
    v_permlane32_swap_b32 v94, v96
    v_permlane32_swap_b32 v95, v97
    s_mov_b32 exec_hi, 0
    buffer_store_dwordx4 v[94:97], v5, s[16:19], s67 offen nt
    s_mov_b32 exec_hi, -1
    s_add_u32 s67, s67, 6144
    s_waitcnt lgkmcnt(0)
    v_add_u32 v90, 40960, v45
    v_add_u32 v104, 141312, v48
    v_add_u32 v105, 40960, v48
    s_add_u32 s74, s66, 4096
    buffer_load_dwordx4 v[228:231], v5, s[16:19], s74 offen offset:0 sc1
    buffer_load_dwordx4 v[232:235], v5, s[16:19], s74 offen offset:1024 sc1
    s_waitcnt vmcnt(7)
    v_mfma_f32_16x16x32_bf16 v[50:53], v[128:131], v[212:215], 0
    v_mfma_f32_16x16x32_bf16 v[54:57], v[132:135], v[212:215], 0
    v_mfma_f32_16x16x32_bf16 v[58:61], v[136:139], v[212:215], 0
    v_mfma_f32_16x16x32_bf16 v[62:65], v[140:143], v[212:215], 0
    v_mfma_f32_16x16x32_bf16 v[66:69], v[144:147], v[212:215], 0
    s_waitcnt vmcnt(5)
    buffer_load_dword v2, v44, s[16:19], s69 offen sc1
    v_mfma_f32_16x16x32_bf16 v[50:53], v[148:151], v[216:219], v[50:53]
    v_mfma_f32_16x16x32_bf16 v[54:57], v[152:155], v[216:219], v[54:57]
    v_mfma_f32_16x16x32_bf16 v[58:61], v[156:159], v[216:219], v[58:61]
    v_mfma_f32_16x16x32_bf16 v[62:65], v[160:163], v[216:219], v[62:65]
    v_mfma_f32_16x16x32_bf16 v[66:69], v[164:167], v[216:219], v[66:69]
    s_waitcnt vmcnt(5)
    v_mfma_f32_16x16x32_bf16 v[50:53], v[168:171], v[220:223], v[50:53]
    v_mfma_f32_16x16x32_bf16 v[54:57], v[172:175], v[220:223], v[54:57]
    v_mfma_f32_16x16x32_bf16 v[58:61], v[22:25], v[220:223], v[58:61]
    v_mfma_f32_16x16x32_bf16 v[62:65], v[26:29], v[220:223], v[62:65]
    v_mfma_f32_16x16x32_bf16 v[66:69], v[30:33], v[220:223], v[66:69]
    s_waitcnt vmcnt(3)
    v_mov_b32 v7, 4
    s_mov_b64 exec, 1
    s_cmp_eq_u32 s54, 0
    s_cbranch_scc1 L_slow_41
    buffer_store_dword v7, v6, s[16:19], s68 offen
L_back_42:
    s_mov_b64 exec, -1
    v_mfma_f32_16x16x32_bf16 v[50:53], v[38:41], v[224:227], v[50:53]
    v_mfma_f32_16x16x32_bf16 v[54:57], v[106:109], v[224:227], v[54:57]
    v_mfma_f32_16x16x32_bf16 v[58:61], v[110:113], v[224:227], v[58:61]
    v_mfma_f32_16x16x32_bf16 v[62:65], v[114:117], v[224:227], v[62:65]
    ds_read_b32 v0, v12 offset:0
    v_mfma_f32_16x16x32_bf16 v[66:69], v[118:121], v[224:227], v[66:69]
    s_waitcnt vmcnt(3)
    v_mfma_f32_16x16x32_bf16 v[50:53], v[122:125], v[228:231], v[50:53]
    v_mfma_f32_16x16x32_bf16 v[54:57], v[176:179], v[228:231], v[54:57]
    v_mfma_f32_16x16x32_bf16 v[58:61], v[180:183], v[228:231], v[58:61]
    s_waitcnt lgkmcnt(0)
    v_cmp_gt_u32 vcc, 6, v0
    s_cbranch_vccnz L_lsp_43
L_lok_44:
    v_mfma_f32_16x16x32_bf16 v[62:65], v[184:187], v[228:231], v[62:65]
    ds_read_b32 v0, v12 offset:16
    v_mfma_f32_16x16x32_bf16 v[66:69], v[188:191], v[228:231], v[66:69]
    s_waitcnt vmcnt(1)
    v_cmp_gt_u32 vcc, 2, v2
    s_cbranch_vccnz L_spin_45
L_ok_46:
    s_cmp_eq_u32 s54, 0
    s_cbranch_scc1 L_slow_48
L_back_49:
    s_add_u32 s74, s66, 6144
    buffer_load_dwordx4 v[236:239], v5, s[16:19], s74 offen offset:0 sc1
    buffer_load_dwordx4 v[240:243], v5, s[16:19], s74 offen offset:1024 sc1
    buffer_load_dwordx4 v[244:247], v5, s[16:19], s74 offen offset:2048 sc1
    buffer_load_dwordx4 v[248:251], v5, s[16:19], s74 offen offset:3072 sc1
    s_add_u32 s74, s66, 10240
    buffer_load_dwordx4 v[252:255], v5, s[16:19], s74 offen offset:0 sc1
    buffer_load_dwordx4 v[212:215], v5, s[16:19], s74 offen offset:1024 sc1
    v_mfma_f32_16x16x32_bf16 v[50:53], v[192:195], v[232:235], v[50:53]
    v_mfma_f32_16x16x32_bf16 v[54:57], v[196:199], v[232:235], v[54:57]
    v_mfma_f32_16x16x32_bf16 v[58:61], v[200:203], v[232:235], v[58:61]
    s_waitcnt lgkmcnt(0)
    v_cmp_gt_u32 vcc, 4, v0
    s_cbranch_vccnz L_lsp_50
L_lok_51:
    v_mfma_f32_16x16x32_bf16 v[62:65], v[204:207], v[232:235], v[62:65]
    v_mfma_f32_16x16x32_bf16 v[66:69], v[208:211], v[232:235], v[66:69]
    s_waitcnt vmcnt(5)
    v_mfma_f32_16x16x32_bf16 v[70:73], v[128:131], v[236:239], 0
    v_mfma_f32_16x16x32_bf16 v[74:77], v[132:135], v[236:239], 0
    v_mfma_f32_16x16x32_bf16 v[78:81], v[136:139], v[236:239], 0
    ds_write_b128 v45, v[50:53] offset:0
    v_mfma_f32_16x16x32_bf16 v[82:85], v[140:143], v[236:239], 0
    v_mfma_f32_16x16x32_bf16 v[86:89], v[144:147], v[236:239], 0
    s_waitcnt vmcnt(4)
    v_mfma_f32_16x16x32_bf16 v[70:73], v[148:151], v[240:243], v[70:73]
    v_mfma_f32_16x16x32_bf16 v[74:77], v[152:155], v[240:243], v[74:77]
    ds_write_b128 v45, v[54:57] offset:1024
    v_mfma_f32_16x16x32_bf16 v[78:81], v[156:159], v[240:243], v[78:81]
    v_mfma_f32_16x16x32_bf16 v[82:85], v[160:163], v[240:243], v[82:85]
    v_mfma_f32_16x16x32_bf16 v[86:89], v[164:167], v[240:243], v[86:89]
    s_waitcnt vmcnt(3)
    buffer_load_dword v2, v44, s[16:19], s69 offen sc1
    v_mfma_f32_16x16x32_bf16 v[70:73], v[168:171], v[244:247], v[70:73]
    ds_write_b128 v45, v[58:61] offset:2048
    v_mfma_f32_16x16x32_bf16 v[74:77], v[172:175], v[244:247], v[74:77]
    v_mfma_f32_16x16x32_bf16 v[78:81], v[22:25], v[244:247], v[78:81]
    v_mfma_f32_16x16x32_bf16 v[82:85], v[26:29], v[244:247], v[82:85]
    v_mfma_f32_16x16x32_bf16 v[86:89], v[30:33], v[244:247], v[86:89]
    s_waitcnt vmcnt(3)
    ds_write_b128 v45, v[62:65] offset:3072
    v_mfma_f32_16x16x32_bf16 v[70:73], v[38:41], v[248:251], v[70:73]
    v_mfma_f32_16x16x32_bf16 v[74:77], v[106:109], v[248:251], v[74:77]
    v_mfma_f32_16x16x32_bf16 v[78:81], v[110:113], v[248:251], v[78:81]
    v_mfma_f32_16x16x32_bf16 v[82:85], v[114:117], v[248:251], v[82:85]
    ds_write_b128 v45, v[66:69] offset:4096
    v_mfma_f32_16x16x32_bf16 v[86:89], v[118:121], v[248:251], v[86:89]
    v_mov_b32 v10, 7
    s_mov_b64 exec, 1
    ds_write_b32 v11, v10 offset:0
    s_mov_b64 exec, -1
    s_waitcnt vmcnt(2)
    v_mfma_f32_16x16x32_bf16 v[70:73], v[122:125], v[252:255], v[70:73]
    v_mfma_f32_16x16x32_bf16 v[74:77], v[176:179], v[252:255], v[74:77]
    v_mfma_f32_16x16x32_bf16 v[78:81], v[180:183], v[252:255], v[78:81]
    v_mfma_f32_16x16x32_bf16 v[82:85], v[184:187], v[252:255], v[82:85]
    v_mfma_f32_16x16x32_bf16 v[86:89], v[188:191], v[252:255], v[86:89]
    s_waitcnt vmcnt(1)
    v_mfma_f32_16x16x32_bf16 v[70:73], v[192:195], v[212:215], v[70:73]
    v_mfma_f32_16x16x32_bf16 v[74:77], v[196:199], v[212:215], v[74:77]
    v_mfma_f32_16x16x32_bf16 v[78:81], v[200:203], v[212:215], v[78:81]
    v_mfma_f32_16x16x32_bf16 v[82:85], v[204:207], v[212:215], v[82:85]
    v_mfma_f32_16x16x32_bf16 v[86:89], v[208:211], v[212:215], v[86:89]
    s_nop 0
s_nop 2
    ds_write_b128 v45, v[70:73] offset:20480
    ds_write_b128 v45, v[74:77] offset:21504
    ds_write_b128 v45, v[78:81] offset:22528
    ds_write_b128 v45, v[82:85] offset:23552
    ds_write_b128 v45, v[86:89] offset:24576
    v_mov_b32 v10, 8
    s_mov_b64 exec, 1
    ds_write_b32 v11, v10 offset:0
    s_mov_b64 exec, -1
    s_waitcnt vmcnt(0)
    v_cmp_gt_u32 vcc, 4, v2
    s_cbranch_vccnz L_spin_52
L_ok_53:
    s_cmp_eq_u32 s54, 0
    s_cbranch_scc1 L_slow_55
L_back_56:
    s_add_u32 s74, s66, 12288
    buffer_load_dwordx4 v[216:219], v5, s[16:19], s74 offen offset:0 sc1
    buffer_load_dwordx4 v[220:223], v5, s[16:19], s74 offen offset:1024 sc1
    buffer_load_dwordx4 v[224:227], v5, s[16:19], s74 offen offset:2048 sc1
    buffer_load_dwordx4 v[228:231], v5, s[16:19], s74 offen offset:3072 sc1
    s_add_u32 s74, s66, 16384
    buffer_load_dwordx4 v[232:235], v5, s[16:19], s74 offen offset:0 sc1
    buffer_load_dwordx4 v[236:239], v5, s[16:19], s74 offen offset:1024 sc1
    s_add_u32 s74, s66, 18432
    buffer_load_dwordx4 v[240:243], v5, s[16:19], s74 offen offset:0 sc1
    buffer_load_dwordx4 v[244:247], v5, s[16:19], s74 offen offset:1024 sc1
    s_waitcnt vmcnt(7)
    s_waitcnt lgkmcnt(7)
    v_mfma_f32_16x16x32_bf16 v[50:53], v[128:131], v[216:219], 0
    v_mfma_f32_16x16x32_bf16 v[54:57], v[132:135], v[216:219], 0
    v_mfma_f32_16x16x32_bf16 v[58:61], v[136:139], v[216:219], 0
    v_mfma_f32_16x16x32_bf16 v[62:65], v[140:143], v[216:219], 0
    v_mfma_f32_16x16x32_bf16 v[66:69], v[144:147], v[216:219], 0
    s_waitcnt vmcnt(6)
    buffer_load_dwordx4 v[248:251], v5, s[16:19], s74 offen offset:2048 sc1
    v_mfma_f32_16x16x32_bf16 v[50:53], v[148:151], v[220:223], v[50:53]
    v_mfma_f32_16x16x32_bf16 v[54:57], v[152:155], v[220:223], v[54:57]
    v_mfma_f32_16x16x32_bf16 v[58:61], v[156:159], v[220:223], v[58:61]
    v_mfma_f32_16x16x32_bf16 v[62:65], v[160:163], v[220:223], v[62:65]
    v_mfma_f32_16x16x32_bf16 v[66:69], v[164:167], v[220:223], v[66:69]
    s_waitcnt vmcnt(6)
    buffer_load_dwordx4 v[252:255], v5, s[16:19], s74 offen offset:3072 sc1
    v_mfma_f32_16x16x32_bf16 v[50:53], v[168:171], v[224:227], v[50:53]
    v_mfma_f32_16x16x32_bf16 v[54:57], v[172:175], v[224:227], v[54:57]
    v_mfma_f32_16x16x32_bf16 v[58:61], v[22:25], v[224:227], v[58:61]
    v_mfma_f32_16x16x32_bf16 v[62:65], v[26:29], v[224:227], v[62:65]
    v_mfma_f32_16x16x32_bf16 v[66:69], v[30:33], v[224:227], v[66:69]
    s_add_u32 s74, s66, 22528
    buffer_load_dwordx4 v[212:215], v5, s[16:19], s74 offen offset:0 sc1
    s_waitcnt vmcnt(7)
    v_mfma_f32_16x16x32_bf16 v[50:53], v[38:41], v[228:231], v[50:53]
    v_mfma_f32_16x16x32_bf16 v[54:57], v[106:109], v[228:231], v[54:57]
    v_mfma_f32_16x16x32_bf16 v[58:61], v[110:113], v[228:231], v[58:61]
    v_mfma_f32_16x16x32_bf16 v[62:65], v[114:117], v[228:231], v[62:65]
    v_mfma_f32_16x16x32_bf16 v[66:69], v[118:121], v[228:231], v[66:69]
    s_waitcnt vmcnt(6)
    buffer_load_dwordx4 v[216:219], v5, s[16:19], s74 offen offset:1024 sc1
    v_mfma_f32_16x16x32_bf16 v[50:53], v[122:125], v[232:235], v[50:53]
    v_mfma_f32_16x16x32_bf16 v[54:57], v[176:179], v[232:235], v[54:57]
    v_mfma_f32_16x16x32_bf16 v[58:61], v[180:183], v[232:235], v[58:61]
    v_mfma_f32_16x16x32_bf16 v[62:65], v[184:187], v[232:235], v[62:65]
    v_mfma_f32_16x16x32_bf16 v[66:69], v[188:191], v[232:235], v[66:69]
    s_waitcnt vmcnt(6)
    v_mfma_f32_16x16x32_bf16 v[50:53], v[192:195], v[236:239], v[50:53]
    v_mfma_f32_16x16x32_bf16 v[54:57], v[196:199], v[236:239], v[54:57]
    v_mfma_f32_16x16x32_bf16 v[58:61], v[200:203], v[236:239], v[58:61]
    v_mfma_f32_16x16x32_bf16 v[62:65], v[204:207], v[236:239], v[62:65]
    v_mfma_f32_16x16x32_bf16 v[66:69], v[208:211], v[236:239], v[66:69]
    s_waitcnt vmcnt(5)
    s_waitcnt lgkmcnt(1)
    v_mfma_f32_16x16x32_bf16 v[70:73], v[128:131], v[240:243], 0
    s_waitcnt vmcnt(4)
    v_mfma_f32_16x16x32_bf16 v[70:73], v[148:151], v[244:247], v[70:73]
    s_waitcnt vmcnt(3)
    v_mfma_f32_16x16x32_bf16 v[70:73], v[168:171], v[248:251], v[70:73]
    s_waitcnt vmcnt(2)
    ds_write_b128 v90, v[50:53] offset:0
    v_mfma_f32_16x16x32_bf16 v[70:73], v[38:41], v[252:255], v[70:73]
    s_waitcnt vmcnt(1)
    v_mfma_f32_16x16x32_bf16 v[70:73], v[122:125], v[212:215], v[70:73]
    s_waitcnt vmcnt(0)
    v_mfma_f32_16x16x32_bf16 v[70:73], v[192:195], v[216:219], v[70:73]
    v_mfma_f32_16x16x32_bf16 v[74:77], v[132:135], v[240:243], 0
    ds_write_b128 v90, v[54:57] offset:1024
    v_mfma_f32_16x16x32_bf16 v[74:77], v[152:155], v[244:247], v[74:77]
    v_mfma_f32_16x16x32_bf16 v[74:77], v[172:175], v[248:251], v[74:77]
    v_mfma_f32_16x16x32_bf16 v[74:77], v[106:109], v[252:255], v[74:77]
    v_mfma_f32_16x16x32_bf16 v[74:77], v[176:179], v[212:215], v[74:77]
    s_nop 0
    ds_write_b128 v90, v[58:61] offset:2048
    ds_write_b128 v90, v[70:73] offset:20480
    v_mfma_f32_16x16x32_bf16 v[74:77], v[196:199], v[216:219], v[74:77]
    v_mfma_f32_16x16x32_bf16 v[78:81], v[136:139], v[240:243], 0
    v_mfma_f32_16x16x32_bf16 v[78:81], v[156:159], v[244:247], v[78:81]
    v_mfma_f32_16x16x32_bf16 v[78:81], v[22:25], v[248:251], v[78:81]
    ds_write_b128 v90, v[62:65] offset:3072
    v_mfma_f32_16x16x32_bf16 v[78:81], v[110:113], v[252:255], v[78:81]
    v_mfma_f32_16x16x32_bf16 v[78:81], v[180:183], v[212:215], v[78:81]
s_nop 1
    ds_write_b128 v90, v[74:77] offset:21504
    v_mfma_f32_16x16x32_bf16 v[78:81], v[200:203], v[216:219], v[78:81]
    v_mfma_f32_16x16x32_bf16 v[82:85], v[140:143], v[240:243], 0
    ds_write_b128 v90, v[66:69] offset:4096
    v_mfma_f32_16x16x32_bf16 v[82:85], v[160:163], v[244:247], v[82:85]
    v_mov_b32 v10, 9
    s_mov_b64 exec, 1
    ds_write_b32 v11, v10 offset:0
    s_mov_b64 exec, -1
    v_mfma_f32_16x16x32_bf16 v[82:85], v[26:29], v[248:251], v[82:85]
    v_mfma_f32_16x16x32_bf16 v[82:85], v[114:117], v[252:255], v[82:85]
    v_mfma_f32_16x16x32_bf16 v[82:85], v[184:187], v[212:215], v[82:85]
    ds_write_b128 v90, v[78:81] offset:22528
    v_mfma_f32_16x16x32_bf16 v[82:85], v[204:207], v[216:219], v[82:85]
    v_mfma_f32_16x16x32_bf16 v[86:89], v[144:147], v[240:243], 0
    v_mfma_f32_16x16x32_bf16 v[86:89], v[164:167], v[244:247], v[86:89]
    v_mfma_f32_16x16x32_bf16 v[86:89], v[30:33], v[248:251], v[86:89]
    v_mfma_f32_16x16x32_bf16 v[86:89], v[118:121], v[252:255], v[86:89]
    v_mfma_f32_16x16x32_bf16 v[86:89], v[188:191], v[212:215], v[86:89]
s_nop 2
    ds_write_b128 v90, v[82:85] offset:23552
    v_mfma_f32_16x16x32_bf16 v[86:89], v[208:211], v[216:219], v[86:89]
    s_nop 0
s_nop 6
    ds_write_b128 v90, v[86:89] offset:24576
    v_mov_b32 v10, 10
    s_mov_b64 exec, 1
    ds_write_b32 v11, v10 offset:0
    s_mov_b64 exec, -1
    ds_read_b128 v[176:179], v104 offset:0
    ds_read_b128 v[180:183], v104 offset:2560
    s_mov_b32 s7, 4194304
L_lsp_57:
    ds_read_b32 v0, v12 offset:16
    s_sub_u32 s7, s7, 1
    s_waitcnt lgkmcnt(0)
    s_cbranch_scc1 L_lok_58
    v_cmp_gt_u32 vcc, 5, v0
    s_cbranch_vccz L_lok_58
    s_sleep 1
    s_branch L_lsp_57
L_lok_58:
.p2align 3
    ds_read_b128 v[184:187], v48 offset:0
    ds_read_b128 v[188:191], v48 offset:2560
    ds_read_b128 v[192:195], v48 offset:5120
    ds_read_b128 v[196:199], v48 offset:7680
    ds_read_b128 v[200:203], v48 offset:10240
    ds_read_b128 v[204:207], v48 offset:12800
    ds_read_b128 v[208:211], v48 offset:15360
    ds_read_b128 v[212:215], v48 offset:17920
    s_waitcnt lgkmcnt(6)
    v_add_f32 v176, v176, v184
    v_add_f32 v177, v177, v185
    v_add_f32 v178, v178, v186
    v_add_f32 v179, v179, v187
    v_add_f32 v180, v180, v188
    v_add_f32 v181, v181, v189
    v_add_f32 v182, v182, v190
    v_add_f32 v183, v183, v191
    s_waitcnt lgkmcnt(4)
    v_add_f32 v176, v176, v192
    v_add_f32 v177, v177, v193
    v_add_f32 v178, v178, v194
    v_add_f32 v179, v179, v195
    v_add_f32 v180, v180, v196
    v_add_f32 v181, v181, v197
    v_add_f32 v182, v182, v198
    v_add_f32 v183, v183, v199
    s_waitcnt lgkmcnt(2)
    v_add_f32 v176, v176, v200
    v_add_f32 v177, v177, v201
    v_add_f32 v178, v178, v202
    v_add_f32 v179, v179, v203
    v_add_f32 v180, v180, v204
    v_add_f32 v181, v181, v205
    v_add_f32 v182, v182, v206
    v_add_f32 v183, v183, v207
    s_waitcnt lgkmcnt(0)
    v_add_f32 v176, v176, v208
    v_add_f32 v177, v177, v209
    v_add_f32 v178, v178, v210
    v_add_f32 v179, v179, v211
    v_add_f32 v180, v180, v212
    v_add_f32 v181, v181, v213
    v_add_f32 v182, v182, v214
    v_add_f32 v183, v183, v215
    v_cvt_pk_bf16_f32 v184, v176, v177
    v_cvt_pk_bf16_f32 v185, v178, v179
    v_cvt_pk_bf16_f32 v186, v180, v181
    v_cvt_pk_bf16_f32 v187, v182, v183
    s_mov_b32 exec_hi, 0xff
    buffer_store_dwordx4 v[184:187], v49, s[20:23], s70 offen nt
    s_mov_b32 exec_hi, -1
    ds_read_b128 v[216:219], v104 offset:5120
    ds_read_b128 v[220:223], v104 offset:7680
    s_mov_b32 s7, 4194304
L_lsp_59:
    ds_read_b32 v0, v12 offset:16
    s_sub_u32 s7, s7, 1
    s_waitcnt lgkmcnt(0)
    s_cbranch_scc1 L_lok_60
    v_cmp_gt_u32 vcc, 6, v0
    s_cbranch_vccz L_lok_60
    s_sleep 1
    s_branch L_lsp_59
L_lok_60:
.p2align 3
    ds_read_b128 v[224:227], v48 offset:20480
    ds_read_b128 v[228:231], v48 offset:23040
    ds_read_b128 v[232:235], v48 offset:25600
    ds_read_b128 v[236:239], v48 offset:28160
    ds_read_b128 v[240:243], v48 offset:30720
    ds_read_b128 v[244:247], v48 offset:33280
    ds_read_b128 v[248:251], v48 offset:35840
    ds_read_b128 v[252:255], v48 offset:38400
    s_add_u32 s70, s70, 20480
    s_waitcnt lgkmcnt(6)
    v_add_f32 v216, v216, v224
    v_add_f32 v217, v217, v225
    v_add_f32 v218, v218, v226
    v_add_f32 v219, v219, v227
    v_add_f32 v220, v220, v228
    v_add_f32 v221, v221, v229
    v_add_f32 v222, v222, v230
    v_add_f32 v223, v223, v231
    s_waitcnt lgkmcnt(4)
    v_add_f32 v216, v216, v232
    v_add_f32 v217, v217, v233
    v_add_f32 v218, v218, v234
    v_add_f32 v219, v219, v235
    v_add_f32 v220, v220, v236
    v_add_f32 v221, v221, v237
    v_add_f32 v222, v222, v238
    v_add_f32 v223, v223, v239
    s_waitcnt lgkmcnt(2)
    v_add_f32 v216, v216, v240
    v_add_f32 v217, v217, v241
    v_add_f32 v218, v218, v242
    v_add_f32 v219, v219, v243
    v_add_f32 v220, v220, v244
    v_add_f32 v221, v221, v245
    v_add_f32 v222, v222, v246
    v_add_f32 v223, v223, v247
    s_waitcnt lgkmcnt(0)
    v_add_f32 v216, v216, v248
    v_add_f32 v217, v217, v249
    v_add_f32 v218, v218, v250
    v_add_f32 v219, v219, v251
    v_add_f32 v220, v220, v252
    v_add_f32 v221, v221, v253
    v_add_f32 v222, v222, v254
    v_add_f32 v223, v223, v255
    v_cvt_pk_bf16_f32 v224, v216, v217
    v_cvt_pk_bf16_f32 v225, v218, v219
    v_cvt_pk_bf16_f32 v226, v220, v221
    v_cvt_pk_bf16_f32 v227, v222, v223
    s_mov_b32 exec_hi, 0xff
    buffer_store_dwordx4 v[224:227], v49, s[20:23], s70 offen nt
    s_mov_b32 exec_hi, -1
    ds_read_b128 v[176:179], v104 offset:10240
    ds_read_b128 v[180:183], v104 offset:12800
    s_mov_b32 s7, 4194304
L_lsp_61:
    ds_read_b32 v0, v12 offset:16
    s_sub_u32 s7, s7, 1
    s_waitcnt lgkmcnt(0)
    s_cbranch_scc1 L_lok_62
    v_cmp_gt_u32 vcc, 7, v0
    s_cbranch_vccnz L_lsp_61
L_lok_62:
.p2align 3
    ds_read_b128 v[184:187], v105 offset:0
    ds_read_b128 v[188:191], v105 offset:2560
    ds_read_b128 v[192:195], v105 offset:5120
    ds_read_b128 v[196:199], v105 offset:7680
    ds_read_b128 v[200:203], v105 offset:10240
    ds_read_b128 v[204:207], v105 offset:12800
    ds_read_b128 v[208:211], v105 offset:15360
    ds_read_b128 v[212:215], v105 offset:17920
    s_add_u32 s70, s70, 20480
    s_waitcnt lgkmcnt(6)
    v_add_f32 v176, v176, v184
    v_add_f32 v177, v177, v185
    v_add_f32 v178, v178, v186
    v_add_f32 v179, v179, v187
    v_add_f32 v180, v180, v188
    v_add_f32 v181, v181, v189
    v_add_f32 v182, v182, v190
    v_add_f32 v183, v183, v191
    s_waitcnt lgkmcnt(4)
    v_add_f32 v176, v176, v192
    v_add_f32 v177, v177, v193
    v_add_f32 v178, v178, v194
    v_add_f32 v179, v179, v195
    v_add_f32 v180, v180, v196
    v_add_f32 v181, v181, v197
    v_add_f32 v182, v182, v198
    v_add_f32 v183, v183, v199
    s_waitcnt lgkmcnt(2)
    v_add_f32 v176, v176, v200
    v_add_f32 v177, v177, v201
    v_add_f32 v178, v178, v202
    v_add_f32 v179, v179, v203
    v_add_f32 v180, v180, v204
    v_add_f32 v181, v181, v205
    v_add_f32 v182, v182, v206
    v_add_f32 v183, v183, v207
    s_waitcnt lgkmcnt(0)
    v_add_f32 v176, v176, v208
    v_add_f32 v177, v177, v209
    v_add_f32 v178, v178, v210
    v_add_f32 v179, v179, v211
    v_add_f32 v180, v180, v212
    v_add_f32 v181, v181, v213
    v_add_f32 v182, v182, v214
    v_add_f32 v183, v183, v215
    v_cvt_pk_bf16_f32 v184, v176, v177
    v_cvt_pk_bf16_f32 v185, v178, v179
    v_cvt_pk_bf16_f32 v186, v180, v181
    v_cvt_pk_bf16_f32 v187, v182, v183
    s_mov_b32 exec_hi, 0xff
    buffer_store_dwordx4 v[184:187], v49, s[20:23], s70 offen nt
    s_mov_b32 exec_hi, -1
    s_endpgm
L_lsp_7:
    s_mov_b32 s7, 4194304
L_lsp_7l:
    ds_read_b32 v7, v12 offset:16
    s_sub_u32 s7, s7, 1
    s_waitcnt lgkmcnt(0)
    s_cbranch_scc1 L_lok_8
    v_cmp_gt_u32 vcc, 2, v7
    s_cbranch_vccnz L_lsp_7l
    s_branch L_lok_8
L_hbr_11:
    s_sub_u32 s53, s53, 1
    s_cbranch_scc1 L_hbx_12
    buffer_load_dwordx4 v[128:131], v5, s[16:19], s73 offen offset:0 sc1
    buffer_load_dwordx4 v[132:135], v5, s[16:19], s73 offen offset:1024 sc1
    s_waitcnt vmcnt(0)
    s_branch L_hbf_13
L_slow_16:
    s_waitcnt vmcnt(0)
    buffer_wbl2 sc1
    s_waitcnt vmcnt(0)
    buffer_store_dwordx4 v[136:139], v5, s[16:19], s75 offen sc1
    s_branch L_back_17
L_slow_22:
    buffer_inv sc1
    s_waitcnt vmcnt(0)
    s_branch L_back_23
L_slow_24:
    s_waitcnt vmcnt(0)
    buffer_wbl2 sc1
    s_waitcnt vmcnt(0)
    buffer_store_dwordx2 v[112:113], v9, s[16:19], s75 offen sc1
    s_branch L_back_25
L_slow_30:
    buffer_inv sc1
    s_waitcnt vmcnt(0)
    s_branch L_back_31
L_slow_32:
    buffer_wbl2 sc1
    s_waitcnt vmcnt(0)
    buffer_store_dword v7, v6, s[16:19], s68 offen sc1
    s_branch L_back_33
L_spin_34:
    s_mov_b32 s53, 262144
L_poll_36:
    buffer_load_dword v2, v46, s[16:19], s49 offen sc1
    s_sub_u32 s53, s53, 1
    s_waitcnt vmcnt(0)
    s_cbranch_scc1 L_ok_35
    v_cmp_gt_u32 vcc, 1, v2
    s_cbranch_vccnz L_poll_36
    s_branch L_ok_35
L_slow_37:
    buffer_inv sc1
    s_waitcnt vmcnt(0)
    s_branch L_back_38
L_slow_39:
    buffer_wbl2 sc1
    s_waitcnt vmcnt(0)
    buffer_store_dword v7, v6, s[16:19], s68 offen sc1
    s_branch L_back_40
L_slow_41:
    buffer_wbl2 sc1
    s_waitcnt vmcnt(0)
    buffer_store_dword v7, v6, s[16:19], s68 offen sc1
    s_branch L_back_42
L_lsp_43:
    s_mov_b32 s7, 4194304
L_lsp_43l:
    ds_read_b32 v0, v12 offset:0
    s_sub_u32 s7, s7, 1
    s_waitcnt lgkmcnt(0)
    s_cbranch_scc1 L_lok_44
    v_cmp_gt_u32 vcc, 6, v0
    s_cbranch_vccz L_lok_44
    s_sleep 1
    s_branch L_lsp_43l
    s_branch L_lok_44
L_spin_45:
    s_mov_b32 s53, 262144
L_poll_47:
    buffer_load_dword v2, v44, s[16:19], s69 offen sc1
    s_sub_u32 s53, s53, 1
    s_waitcnt vmcnt(0)
    s_cbranch_scc1 L_ok_46
    v_cmp_gt_u32 vcc, 2, v2
    s_cbranch_vccnz L_poll_47
    s_branch L_ok_46
L_slow_48:
    buffer_inv sc1
    s_waitcnt vmcnt(0)
    s_branch L_back_49
L_lsp_50:
    s_mov_b32 s7, 4194304
L_lsp_50l:
    ds_read_b32 v0, v12 offset:16
    s_sub_u32 s7, s7, 1
    s_waitcnt lgkmcnt(0)
    s_cbranch_scc1 L_lok_51
    v_cmp_gt_u32 vcc, 4, v0
    s_cbranch_vccz L_lok_51
    s_sleep 1
    s_branch L_lsp_50l
    s_branch L_lok_51
L_spin_52:
    s_mov_b32 s53, 262144
L_poll_54:
    buffer_load_dword v2, v44, s[16:19], s69 offen sc1
    s_sub_u32 s53, s53, 1
    s_waitcnt vmcnt(0)
    s_cbranch_scc1 L_ok_53
    v_cmp_gt_u32 vcc, 4, v2
    s_cbranch_vccnz L_poll_54
    s_branch L_ok_53
L_slow_55:
    buffer_inv sc1
    s_waitcnt vmcnt(0)
    s_branch L_back_56
L_z_5006:
    v_lshlrev_b32 v22, 7, v1
    v_mov_b32 v24, 0
    v_mov_b32 v25, 0
    s_mov_b32 exec_hi, 1
    buffer_store_dwordx2 v[24:25], v22, s[16:19], 0 offen sc1
    s_mov_b32 exec_hi, -1
    s_branch L_z_5007
L_z_5008:
    s_atomic_add s54, s[40:41], 0
    s_branch L_z_5009
L_spin_5015:
    s_mov_b32 s53, 262144
L_poll_5017:
    buffer_load_dword v23, v6, s[40:43], 0 offen sc1
    s_sub_u32 s53, s53, 1
    s_waitcnt vmcnt(0)
    s_cbranch_scc1 L_ok_5016
    v_cmp_gt_u32 vcc, 1, v23
    s_cbranch_vccnz L_poll_5017
    s_branch L_ok_5016
L_spin_5020:
    s_mov_b32 s53, 262144
L_poll_5022:
    s_sleep 12
    buffer_load_dwordx2 v[24:25], v22, s[16:19], 0 offen sc1
    s_sub_u32 s53, s53, 1
    s_waitcnt vmcnt(0)
    s_cbranch_scc1 L_spx_5023
    v_cmp_gt_u32 vcc, 8, v25
    s_cbranch_vccnz L_poll_5022
    s_branch L_spx_5023
L_ha_5026:
.p2align 3
    buffer_load_dwordx4 v[40:43], v5, s[16:19], s80 offen offset:0 sc1
    buffer_load_dwordx4 v[44:47], v5, s[16:19], s80 offen offset:1024 sc1
    buffer_load_dwordx4 v[48:51], v5, s[16:19], s80 offen offset:2048 sc1
    buffer_load_dwordx4 v[52:55], v5, s[16:19], s80 offen offset:3072 sc1
    buffer_load_dwordx4 v[56:59], v5, s[16:19], s81 offen offset:0 sc1
    buffer_load_dwordx4 v[60:63], v5, s[16:19], s81 offen offset:1024 sc1
    buffer_load_dwordx4 v[64:67], v5, s[16:19], s81 offen offset:2048 sc1
    buffer_load_dwordx4 v[68:71], v5, s[16:19], s81 offen offset:3072 sc1
    s_branch L_hab_5027
L_ht_5028:
    s_waitcnt vmcnt(4)
L_htf_5031:
    v_mfma_f32_16x16x32_bf16 v[76:79], v[72:75], v[40:43], 0
    v_mfma_f32_16x16x32_bf16 v[76:79], v[72:75], v[44:47], v[76:79]
    v_mfma_f32_16x16x32_bf16 v[76:79], v[72:75], v[48:51], v[76:79]
    v_mfma_f32_16x16x32_bf16 v[76:79], v[72:75], v[52:55], v[76:79]
    v_mfma_f32_16x16x32_bf16 v[76:79], v[72:75], v[56:59], v[76:79]
    v_mfma_f32_16x16x32_bf16 v[76:79], v[72:75], v[60:63], v[76:79]
    v_mfma_f32_16x16x32_bf16 v[76:79], v[72:75], v[64:67], v[76:79]
    v_mfma_f32_16x16x32_bf16 v[76:79], v[72:75], v[68:71], v[76:79]
s_nop 7
    v_cmp_u_f32 vcc, v76, v76
    s_cbranch_vccnz L_htr_5030
L_htp_5032:
    v_cvt_pk_bf16_f32 v80, v76, v77
    v_cvt_pk_bf16_f32 v81, v78, v79
    v_mov_b32 v82, v80
    v_mov_b32 v83, v81
s_nop 0
    v_permlane16_swap_b32 v80, v82
    v_permlane16_swap_b32 v81, v83
    s_mov_b64 exec, 0xffff
    buffer_store_dwordx4 v[80:83], v5, s[16:19], s82 offen sc1
    s_mov_b64 exec, -1
    s_mov_b32 s83, 4
    s_branch L_htb_5029
L_htr_5030:
    s_sub_u32 s53, s53, 1
    s_cbranch_scc1 L_htp_5032
.p2align 3
    buffer_load_dwordx4 v[40:43], v5, s[16:19], s80 offen offset:0 sc1
    buffer_load_dwordx4 v[44:47], v5, s[16:19], s80 offen offset:1024 sc1
    buffer_load_dwordx4 v[48:51], v5, s[16:19], s80 offen offset:2048 sc1
    buffer_load_dwordx4 v[52:55], v5, s[16:19], s80 offen offset:3072 sc1
    buffer_load_dwordx4 v[56:59], v5, s[16:19], s81 offen offset:0 sc1
    buffer_load_dwordx4 v[60:63], v5, s[16:19], s81 offen offset:1024 sc1
    buffer_load_dwordx4 v[64:67], v5, s[16:19], s81 offen offset:2048 sc1
    buffer_load_dwordx4 v[68:71], v5, s[16:19], s81 offen offset:3072 sc1
    s_waitcnt vmcnt(0)
    s_branch L_htf_5031
L_slow_5043:
    buffer_wbl2 sc1
    s_waitcnt vmcnt(0)
    buffer_store_dword v7, v6, s[16:19], s76 offen sc1
    s_branch L_back_5044
L_spin_5045:
    s_mov_b32 s53, 262144
L_poll_5047:
    buffer_load_dword v4, v13, s[16:19], s49 offen sc1
    s_sub_u32 s53, s53, 1
    s_waitcnt vmcnt(0)
    s_cbranch_scc1 L_ok_5046
    v_cmp_gt_u32 vcc, 1, v4
    s_cbranch_vccnz L_poll_5047
    s_branch L_ok_5046
L_slow_5048:
    buffer_inv sc1
    s_waitcnt vmcnt(0)
    s_branch L_back_5049
L_slow_5050:
    buffer_wbl2 sc1
    s_waitcnt vmcnt(0)
    buffer_store_dword v7, v6, s[16:19], s76 offen sc1
    s_branch L_back_5051
L_slow_5052:
    buffer_wbl2 sc1
    s_waitcnt vmcnt(0)
    buffer_store_dword v7, v6, s[16:19], s76 offen sc1
    s_branch L_back_5053
L_spin_5054:
    s_mov_b32 s53, 262144
L_poll_5056:
    buffer_load_dword v4, v0, s[16:19], s77 offen sc1
    s_sub_u32 s53, s53, 1
    s_waitcnt vmcnt(0)
    s_cbranch_scc1 L_ok_5055
    v_cmp_gt_u32 vcc, 2, v4
    s_cbranch_vccnz L_poll_5056
    s_branch L_ok_5055
L_slow_5057:
    buffer_inv sc1
    s_waitcnt vmcnt(0)
    s_branch L_back_5058
L_lsp_5061:
    s_mov_b32 s7, 4194304
L_lsp_5061l:
    ds_read_b32 v3, v11 offset:0
    s_sub_u32 s7, s7, 1
    s_waitcnt lgkmcnt(0)
    s_cbranch_scc1 L_lok_5062
    v_cmp_gt_u32 vcc, 8, v3
    s_cbranch_vccz L_lok_5062
    s_sleep 1
    s_branch L_lsp_5061l
    s_branch L_lok_5062
L_spin_5063:
    s_mov_b32 s53, 262144
L_poll_5065:
    buffer_load_dword v4, v0, s[16:19], s77 offen sc1
    s_sub_u32 s53, s53, 1
    s_waitcnt vmcnt(0)
    s_cbranch_scc1 L_ok_5064
    v_cmp_gt_u32 vcc, 4, v4
    s_cbranch_vccnz L_poll_5065
    s_branch L_ok_5064
L_slow_5066:
    buffer_inv sc1
    s_waitcnt vmcnt(0)
    s_branch L_back_5067
L_lsp_5068:
    s_mov_b32 s7, 4194304
L_lsp_5068l:
    ds_read_b32 v3, v11 offset:0
    s_sub_u32 s7, s7, 1
    s_waitcnt lgkmcnt(0)
    s_cbranch_scc1 L_lok_5069
    v_cmp_gt_u32 vcc, 9, v3
    s_cbranch_vccz L_lok_5069
    s_sleep 1
    s_branch L_lsp_5068l
    s_branch L_lok_5069
L_lsp_5070:
    s_mov_b32 s7, 4194304
L_lsp_5070l:
    ds_read_b32 v3, v11 offset:0
    s_sub_u32 s7, s7, 1
    s_waitcnt lgkmcnt(0)
    s_cbranch_scc1 L_lok_5071
    v_cmp_gt_u32 vcc, 10, v3
    s_cbranch_vccz L_lok_5071
    s_sleep 1
    s_branch L_lsp_5070l
    s_branch L_lok_5071
L_done:
    s_endpgm
L_end:
.section .rodata,"a"
.p2align 6
.amdhsa_kernel sequential_preLN__linear_kernel_hedgehog__mixer_channel_mlp__prompt_kernel
  .amdhsa_next_free_vgpr 256
  .amdhsa_next_free_sgpr 102
  .amdhsa_accum_offset 256
  .amdhsa_group_segment_fixed_size 0
  .amdhsa_kernarg_size 96
  .amdhsa_user_sgpr_count 2
  .amdhsa_user_sgpr_kernarg_segment_ptr 1
  .amdhsa_system_sgpr_workgroup_id_x 1
.end_amdhsa_kernel
```
